```python
import torch

def _softmax(x, axis=-1):
    return torch.softmax(x, dim=axis)
def _gelu(x):
    return torch.nn.functional.gelu(x, approximate="tanh")
def _silu(x):
    return torch.nn.functional.silu(x)
def _sigmoid(x):
    return torch.sigmoid(x)
def _layernorm(x, axis=-1, eps=1e-5):
    m = x.mean(dim=axis, keepdim=True)
    v = x.var(dim=axis, keepdim=True, unbiased=False)
    return (x - m) / torch.sqrt(v + eps)
def _scatter_add(tgt, idx, src, axis=0):
    return tgt.clone().index_add_(axis, idx, src)
def _segment_sum(src, seg, n):
    out = torch.zeros((n,) + src.shape[1:], dtype=src.dtype)
    return out.index_add_(0, seg, src)
def _pad(x, pw):
    flat = tuple(v for pair in reversed(pw) for v in pair)
    return torch.nn.functional.pad(x, flat)

kernel_name = 'interleave_layers__spectral_gfnet__glu_gated_geglu__prompt'

def setup_inputs():

    _w = (lambda a: (lambda t: t.to(torch.bfloat16) if t.is_floating_point() else t)(torch.as_tensor(a)))
    def _A_setup():
        B, S, D = 1, 2048, 512
        Df = D // 2 + 1
        return {
            "x": _w((lambda *s: torch.randn(*s, dtype=torch.bfloat16) * 0.05)(B, S, D)),
            "w_r": _w((lambda *s: torch.randn(*s, dtype=torch.bfloat16) * 0.4)(S, Df) * 0.02),
            "w_i": _w((lambda *s: torch.randn(*s, dtype=torch.bfloat16) * 0.4)(S, Df) * 0.02),
        }
    _A_in = _A_setup()

    def _B_setup():
        B, S, Dm, Df = 1, 2048, 512, 1376
        return {
            "x": _w((lambda *s: torch.randn(*s, dtype=torch.bfloat16) * 0.05)(B, S, Dm)),
            "w_gate": _w((lambda *s: torch.randn(*s, dtype=torch.bfloat16) * 0.4)(Dm, Df) * (Dm ** -0.5)),
            "w_up": _w((lambda *s: torch.randn(*s, dtype=torch.bfloat16) * 0.4)(Dm, Df) * (Dm ** -0.5)),
            "w_down": _w((lambda *s: torch.randn(*s, dtype=torch.bfloat16) * 0.4)(Df, Dm) * (Df ** -0.5)),
        }
    _B_in = _B_setup()

    return {
        "A_x": _A_in["x"],
        "A_w_r": _A_in["w_r"],
        "A_w_i": _A_in["w_i"],
        "B_x": _B_in["x"],
        "B_w_gate": _B_in["w_gate"],
        "B_w_up": _B_in["w_up"],
        "B_w_down": _B_in["w_down"],
    }

def reference(A_x, A_w_r, A_w_i, B_x, B_w_gate, B_w_up, B_w_down):
    def _A_ref(x, w_r, w_i):
        B, S, D = x.shape
        X = (lambda x, axes=(-2,-1): torch.fft.rfft2(x.float(), dim=axes))(x, axes=(-2, -1))
        W = w_r + 1j * w_i
        X = X * W
        y = (lambda x, s, axes=(-2,-1): torch.fft.irfft2(x, s=s, dim=axes).to(torch.bfloat16))(X, (S, D), axes=(-2, -1))
        return y

    def _B_ref(x, w_gate, w_up, w_down):
        g = torch.einsum("bsd,df->bsf", x, w_gate)
        u = torch.einsum("bsd,df->bsf", x, w_up)
        h = _gelu(g) * u
        return torch.einsum("bsf,fd->bsd", h, w_down)

    x = A_x
    x = x + _A_ref(_layernorm(x, axis=-1), A_w_r, A_w_i)
    x = x + _B_ref(_layernorm(x, axis=-1), B_w_gate, B_w_up, B_w_down)
    x = x + _A_ref(_layernorm(x, axis=-1), A_w_r, A_w_i)
    x = x + _B_ref(_layernorm(x, axis=-1), B_w_gate, B_w_up, B_w_down)
    return x
```

```asm
; @launch grid=(256,1,1) block=(256,1,1) lds=163840
.amdgcn_target "amdgcn-amd-amdhsa--gfx950"
.text
.globl interleave_layers__spectral_gfnet__glu_gated_geglu__prompt_kernel
.p2align 8
.type interleave_layers__spectral_gfnet__glu_gated_geglu__prompt_kernel,@function
interleave_layers__spectral_gfnet__glu_gated_geglu__prompt_kernel:
    s_cmp_ge_u32 s2, 256
    s_cbranch_scc1 L_end
    s_load_dwordx16 s[64:79], s[0:1], 0
    s_load_dwordx4 s[80:83], s[0:1], 64
    s_waitcnt lgkmcnt(0)
    v_lshrrev_b32 v4, 6, v0
    v_and_b32 v1, 63, v0
    v_readfirstlane_b32 s20, v4
    v_and_b32 v2, 31, v0
    v_lshrrev_b32 v3, 5, v1
    s_and_b32 s21, s2, 7
    s_lshr_b32 s22, s2, 3
    s_cmp_ge_u32 s2, 20
    s_cbranch_scc1 L_noinit_1
    s_cmp_lg_u32 s20, 0
    s_cbranch_scc1 L_noinit_1
    s_add_u32 s8, s82, 0x1f00000
    s_addc_u32 s9, s83, 0
    s_mov_b32 s10, 0x5000
    s_mov_b32 s11, 0x00020000
    v_mov_b32 v8, 0
    v_mov_b32 v9, 0
    v_mov_b32 v10, 0
    v_mov_b32 v11, 0
    v_lshlrev_b32 v4, 4, v1
    s_lshl_b32 s24, s2, 10
    buffer_store_dwordx4 v[8:11], v4, s[8:11], s24 offen sc0 sc1
    s_nop 1
L_noinit_1:
    s_getpc_b64 s[26:27]
L_pc_2:
    s_sub_u32 s26, s26, L_pc_2-interleave_layers__spectral_gfnet__glu_gated_geglu__prompt_kernel
    s_subb_u32 s27, s27, 0
    s_lshl_b32 s24, s22, 12
    v_lshlrev_b32 v4, 4, v0
    v_add_u32 v4, s24, v4
    s_mov_b32 s24, L_end-interleave_layers__spectral_gfnet__glu_gated_geglu__prompt_kernel-16
    v_cmp_gt_u32 vcc, s24, v4
    s_nop 0
    s_and_saveexec_b64 s[28:29], vcc
    s_nop 1
    s_cbranch_execz L_pc_2_skip
    global_load_dwordx4 v[244:247], v4, s[26:27]
L_pc_2_skip:
    s_mov_b64 exec, s[28:29]
    s_lshr_b32 s24, s22, 3
    s_lshl_b32 s44, s21, 2
    s_add_u32 s44, s44, s24
    s_and_b32 s45, s22, 7
    v_mov_b32 v169, 156160
    v_mov_b32 v168, 0
    ds_write_b32 v169, v168
    s_lshl_b32 s62, s44, 1
    s_add_u32 s62, s62, s20
    s_cmp_ge_u32 s20, 2
    s_cbranch_scc1 L_roleW_3
    s_lshl_b32 s47, s44, 10
    s_lshl_b32 s24, s20, 20
    s_add_u32 s47, s47, s24
    v_lshrrev_b32 v4, 3, v2
    s_lshl_b32 s24, s45, 2
    v_add_u32 v4, s24, v4
    v_lshlrev_b32 v4, 15, v4
    v_and_b32 v5, 7, v1
    v_lshl_add_u32 v4, v5, 7, v4
    v_add_u32 v4, s47, v4
    global_load_dword v170, v4, s[64:65]
    s_mov_b32 s52, s64
    s_mov_b32 s53, s65
    s_mov_b32 s54, 0x200000
    s_mov_b32 s55, 0x00020000
    v_lshlrev_b32 v172, 15, v2
    v_lshl_add_u32 v172, v3, 4, v172
    buffer_load_dwordx4 a[128:131], v172, s[52:55], s47 offen offset:0
    buffer_load_dwordx4 a[132:135], v172, s[52:55], s47 offen offset:32
    buffer_load_dwordx4 a[136:139], v172, s[52:55], s47 offen offset:64
    buffer_load_dwordx4 a[140:143], v172, s[52:55], s47 offen offset:96
    buffer_load_dwordx4 a[192:195], v172, s[52:55], s47 offen offset:512
    buffer_load_dwordx4 a[196:199], v172, s[52:55], s47 offen offset:544
    buffer_load_dwordx4 a[200:203], v172, s[52:55], s47 offen offset:576
    buffer_load_dwordx4 a[204:207], v172, s[52:55], s47 offen offset:608
    buffer_load_dwordx4 a[144:147], v172, s[52:55], s47 offen offset:128
    buffer_load_dwordx4 a[148:151], v172, s[52:55], s47 offen offset:160
    buffer_load_dwordx4 a[152:155], v172, s[52:55], s47 offen offset:192
    buffer_load_dwordx4 a[156:159], v172, s[52:55], s47 offen offset:224
    buffer_load_dwordx4 a[208:211], v172, s[52:55], s47 offen offset:640
    buffer_load_dwordx4 a[212:215], v172, s[52:55], s47 offen offset:672
    buffer_load_dwordx4 a[216:219], v172, s[52:55], s47 offen offset:704
    buffer_load_dwordx4 a[220:223], v172, s[52:55], s47 offen offset:736
    v_and_b32 v4, 15, v1
    v_lshrrev_b32 v5, 4, v1
    v_cvt_f32_u32 v107, v4
    v_cvt_f32_u32 v106, v5
    s_lshl_b32 s24, s20, 4
    v_cvt_f32_u32 v6, s24
    v_add_f32 v104, v6, v107
    v_mul_f32 v105, v104, v106
    v_mul_f32 v105, 0x3e000000, v105
    v_fmamk_f32 v88, v104, 0x00000000, v105
    v_fmamk_f32 v89, v104, 0x3c800000, v105
    v_fmamk_f32 v90, v104, 0x3d000000, v105
    v_fmamk_f32 v91, v104, 0x3d400000, v105
    v_fmamk_f32 v92, v104, 0x3d800000, v105
    v_fmamk_f32 v93, v104, 0x3da00000, v105
    v_fmamk_f32 v94, v104, 0x3dc00000, v105
    v_fmamk_f32 v95, v104, 0x3de00000, v105
    v_cos_f32 v96, v88
    v_cos_f32 v97, v89
    v_cos_f32 v98, v90
    v_cos_f32 v99, v91
    v_cos_f32 v100, v92
    v_cos_f32 v101, v93
    v_cos_f32 v102, v94
    v_cos_f32 v103, v95
    v_sin_f32 v88, v88
    v_sin_f32 v89, v89
    v_sin_f32 v90, v90
    v_sin_f32 v91, v91
    v_sin_f32 v92, v92
    v_sin_f32 v93, v93
    v_sin_f32 v94, v94
    v_sin_f32 v95, v95
    v_cvt_pk_bf16_f32 v8, v96, v97
    v_cvt_pk_bf16_f32 v9, v98, v99
    v_cvt_pk_bf16_f32 v10, v100, v101
    v_cvt_pk_bf16_f32 v11, v102, v103
    v_cvt_pk_bf16_f32 v16, v88, v89
    v_cvt_pk_bf16_f32 v17, v90, v91
    v_cvt_pk_bf16_f32 v18, v92, v93
    v_cvt_pk_bf16_f32 v19, v94, v95
    v_xor_b32 v24, 0x80008000, v16
    v_xor_b32 v25, 0x80008000, v17
    v_xor_b32 v26, 0x80008000, v18
    v_xor_b32 v27, 0x80008000, v19
    v_fmamk_f32 v88, v104, 0x3f000000, v105
    v_fmamk_f32 v89, v104, 0x3f040000, v105
    v_fmamk_f32 v90, v104, 0x3f080000, v105
    v_fmamk_f32 v91, v104, 0x3f0c0000, v105
    v_fmamk_f32 v92, v104, 0x3f100000, v105
    v_fmamk_f32 v93, v104, 0x3f140000, v105
    v_fmamk_f32 v94, v104, 0x3f180000, v105
    v_fmamk_f32 v95, v104, 0x3f1c0000, v105
    v_cos_f32 v96, v88
    v_cos_f32 v97, v89
    v_cos_f32 v98, v90
    v_cos_f32 v99, v91
    v_cos_f32 v100, v92
    v_cos_f32 v101, v93
    v_cos_f32 v102, v94
    v_cos_f32 v103, v95
    v_sin_f32 v88, v88
    v_sin_f32 v89, v89
    v_sin_f32 v90, v90
    v_sin_f32 v91, v91
    v_sin_f32 v92, v92
    v_sin_f32 v93, v93
    v_sin_f32 v94, v94
    v_sin_f32 v95, v95
    v_cvt_pk_bf16_f32 v12, v96, v97
    v_cvt_pk_bf16_f32 v13, v98, v99
    v_cvt_pk_bf16_f32 v14, v100, v101
    v_cvt_pk_bf16_f32 v15, v102, v103
    v_cvt_pk_bf16_f32 v20, v88, v89
    v_cvt_pk_bf16_f32 v21, v90, v91
    v_cvt_pk_bf16_f32 v22, v92, v93
    v_cvt_pk_bf16_f32 v23, v94, v95
    v_xor_b32 v28, 0x80008000, v20
    v_xor_b32 v29, 0x80008000, v21
    v_xor_b32 v30, 0x80008000, v22
    v_xor_b32 v31, 0x80008000, v23
    v_mov_b32 v6, v107
    v_mul_f32 v105, v6, v106
    v_mul_f32 v105, 0x3e000000, v105
    v_fmamk_f32 v88, v6, 0x00000000, v105
    v_fmamk_f32 v89, v6, 0x3d000000, v105
    v_fmamk_f32 v90, v6, 0x3d800000, v105
    v_fmamk_f32 v91, v6, 0x3dc00000, v105
    v_fmamk_f32 v92, v6, 0x3f000000, v105
    v_fmamk_f32 v93, v6, 0x3f080000, v105
    v_fmamk_f32 v94, v6, 0x3f100000, v105
    v_fmamk_f32 v95, v6, 0x3f180000, v105
    v_cos_f32 v96, v88
    v_cos_f32 v97, v89
    v_cos_f32 v98, v90
    v_cos_f32 v99, v91
    v_cos_f32 v100, v92
    v_cos_f32 v101, v93
    v_cos_f32 v102, v94
    v_cos_f32 v103, v95
    v_sin_f32 v88, v88
    v_sin_f32 v89, v89
    v_sin_f32 v90, v90
    v_sin_f32 v91, v91
    v_sin_f32 v92, v92
    v_sin_f32 v93, v93
    v_sin_f32 v94, v94
    v_sin_f32 v95, v95
    v_cvt_pk_bf16_f32 v32, v96, v97
    v_cvt_pk_bf16_f32 v33, v98, v99
    v_cvt_pk_bf16_f32 v34, v100, v101
    v_cvt_pk_bf16_f32 v35, v102, v103
    v_cvt_pk_bf16_f32 v40, v88, v89
    v_cvt_pk_bf16_f32 v41, v90, v91
    v_cvt_pk_bf16_f32 v42, v92, v93
    v_cvt_pk_bf16_f32 v43, v94, v95
    v_xor_b32 v48, 0x80008000, v40
    s_cmp_ge_u32 s2, 20
    s_cbranch_scc1 L_noinit2_5
    s_cmp_lg_u32 s20, 0
    s_cbranch_scc1 L_noinit2_5
    s_waitcnt vmcnt(17)
    s_mov_b32 s4, s80
    s_mov_b32 s5, s81
    s_mov_b32 s6, 0x100
    s_mov_b32 s7, 0x00020000
    v_mov_b32 v251, 1
    v_mov_b32 v250, 0
    s_mov_b64 exec, 1
    buffer_atomic_add v251, v250, s[4:7], 0 offen sc1
    s_mov_b64 exec, -1
L_noinit2_5:
    v_xor_b32 v49, 0x80008000, v41
    v_xor_b32 v50, 0x80008000, v42
    v_xor_b32 v51, 0x80008000, v43
    v_add_f32 v6, 0x41800000, v107
    v_mul_f32 v105, v6, v106
    v_mul_f32 v105, 0x3e000000, v105
    v_fmamk_f32 v88, v6, 0x00000000, v105
    v_fmamk_f32 v89, v6, 0x3d000000, v105
    v_fmamk_f32 v90, v6, 0x3d800000, v105
    v_fmamk_f32 v91, v6, 0x3dc00000, v105
    v_fmamk_f32 v92, v6, 0x3f000000, v105
    v_fmamk_f32 v93, v6, 0x3f080000, v105
    v_fmamk_f32 v94, v6, 0x3f100000, v105
    v_fmamk_f32 v95, v6, 0x3f180000, v105
    v_cos_f32 v96, v88
    v_cos_f32 v97, v89
    v_cos_f32 v98, v90
    v_cos_f32 v99, v91
    v_cos_f32 v100, v92
    v_cos_f32 v101, v93
    v_cos_f32 v102, v94
    v_cos_f32 v103, v95
    v_sin_f32 v88, v88
    v_sin_f32 v89, v89
    v_sin_f32 v90, v90
    v_sin_f32 v91, v91
    v_sin_f32 v92, v92
    v_sin_f32 v93, v93
    v_sin_f32 v94, v94
    v_sin_f32 v95, v95
    v_cvt_pk_bf16_f32 v36, v96, v97
    v_cvt_pk_bf16_f32 v37, v98, v99
    v_cvt_pk_bf16_f32 v38, v100, v101
    v_cvt_pk_bf16_f32 v39, v102, v103
    v_cvt_pk_bf16_f32 v44, v88, v89
    v_cvt_pk_bf16_f32 v45, v90, v91
    v_cvt_pk_bf16_f32 v46, v92, v93
    v_cvt_pk_bf16_f32 v47, v94, v95
    v_xor_b32 v52, 0x80008000, v44
    v_xor_b32 v53, 0x80008000, v45
    v_xor_b32 v54, 0x80008000, v46
    v_xor_b32 v55, 0x80008000, v47
    v_mul_f32 v105, v104, v106
    v_mul_f32 v105, 0x3b000000, v105
    v_fmamk_f32 v88, v104, 0x00000000, v105
    v_fmamk_f32 v89, v104, 0x3a000000, v105
    v_fmamk_f32 v90, v104, 0x3a800000, v105
    v_fmamk_f32 v91, v104, 0x3ac00000, v105
    v_fmamk_f32 v92, v104, 0x3c000000, v105
    v_fmamk_f32 v93, v104, 0x3c080000, v105
    v_fmamk_f32 v94, v104, 0x3c100000, v105
    v_fmamk_f32 v95, v104, 0x3c180000, v105
    v_cos_f32 v56, v88
    v_cos_f32 v57, v89
    v_cos_f32 v58, v90
    v_cos_f32 v59, v91
    v_cos_f32 v60, v92
    v_cos_f32 v61, v93
    v_cos_f32 v62, v94
    v_cos_f32 v63, v95
    v_sin_f32 v64, v88
    v_sin_f32 v65, v89
    v_sin_f32 v66, v90
    v_sin_f32 v67, v91
    v_sin_f32 v68, v92
    v_sin_f32 v69, v93
    v_sin_f32 v70, v94
    v_sin_f32 v71, v95
    s_lshl_b32 s24, s20, 4
    v_cvt_f32_u32 v6, s24
    v_fmamk_f32 v6, v106, 0x40800000, v6
    v_mov_b32 v7, v107
    v_mul_f32 v7, 0x3a000000, v7
    v_mul_f32 v105, v7, v6
    v_mov_b32 v88, v105
    v_fmamk_f32 v89, v7, 0x3f800000, v105
    v_fmamk_f32 v90, v7, 0x40000000, v105
    v_fmamk_f32 v91, v7, 0x40400000, v105
    v_add_f32 v7, 0x41800000, v107
    v_mul_f32 v7, 0x3a000000, v7
    v_mul_f32 v105, v7, v6
    v_mov_b32 v92, v105
    v_fmamk_f32 v93, v7, 0x3f800000, v105
    v_fmamk_f32 v94, v7, 0x40000000, v105
    v_fmamk_f32 v95, v7, 0x40400000, v105
    v_cos_f32 v72, v88
    v_cos_f32 v73, v89
    v_cos_f32 v74, v90
    v_cos_f32 v75, v91
    v_cos_f32 v76, v92
    v_cos_f32 v77, v93
    v_cos_f32 v78, v94
    v_cos_f32 v79, v95
    v_sin_f32 v80, v88
    v_sin_f32 v81, v89
    v_sin_f32 v82, v90
    v_sin_f32 v83, v91
    v_sin_f32 v84, v92
    v_sin_f32 v85, v93
    v_sin_f32 v86, v94
    v_sin_f32 v87, v95
    v_mul_f32 v72, 0x3a000000, v72
    v_mul_f32 v73, 0x3a000000, v73
    v_mul_f32 v74, 0x3a000000, v74
    v_mul_f32 v75, 0x3a000000, v75
    v_mul_f32 v76, 0x3a000000, v76
    v_mul_f32 v77, 0x3a000000, v77
    v_mul_f32 v78, 0x3a000000, v78
    v_mul_f32 v79, 0x3a000000, v79
    v_mul_f32 v80, 0x3a000000, v80
    v_mul_f32 v81, 0x3a000000, v81
    v_mul_f32 v82, 0x3a000000, v82
    v_mul_f32 v83, 0x3a000000, v83
    v_mul_f32 v84, 0x3a000000, v84
    v_mul_f32 v85, 0x3a000000, v85
    v_mul_f32 v86, 0x3a000000, v86
    v_mul_f32 v87, 0x3a000000, v87
    s_nop 0
    s_branch L_rolej_4
L_roleW_3:
    s_lshr_b32 s24, s44, 1
    s_lshl_b32 s24, s24, 1
    s_add_u32 s24, s24, s20
    s_sub_u32 s24, s24, 2
    s_lshl_b32 s24, s24, 1
    s_and_b32 s25, s44, 1
    s_add_u32 s46, s24, s25
    s_and_b32 s24, s46, 1
    s_cmp_eq_u32 s24, 0
    s_cselect_b32 s28, s72, s74
    s_cselect_b32 s29, s73, s75
    s_lshl_b32 s24, s45, 6
    v_add_u32 v4, s24, v1
    v_mul_u32_u24 v4, 2752, v4
    s_lshr_b32 s24, s46, 1
    s_lshl_b32 s24, s24, 6
    v_add_u32 v4, s24, v4
    global_load_dword v170, v4, s[28:29]
    s_sub_u32 s47, s62, 2
    s_cmp_ge_u32 s47, 22
    s_cbranch_scc1 L_t2d_6
    s_add_u32 s48, s47, 64
    s_and_b32 s24, s48, 1
    s_cmp_eq_u32 s24, 0
    s_cselect_b32 s28, s72, s74
    s_cselect_b32 s29, s73, s75
    s_lshl_b32 s24, s45, 6
    v_add_u32 v4, s24, v1
    v_mul_u32_u24 v4, 2752, v4
    s_lshr_b32 s24, s48, 1
    s_lshl_b32 s24, s24, 6
    v_add_u32 v4, s24, v4
    global_load_dword v171, v4, s[28:29]
    s_branch L_t2e_7
L_t2d_6:
    s_sub_u32 s25, s47, 22
    s_lshl_b32 s25, s25, 15
    v_lshrrev_b32 v4, 3, v2
    s_lshl_b32 s24, s45, 2
    v_add_u32 v4, s24, v4
    v_lshlrev_b32 v4, 10, v4
    v_and_b32 v5, 7, v1
    v_lshl_add_u32 v4, v5, 7, v4
    v_add_u32 v4, s25, v4
    global_load_dword v171, v4, s[76:77]
    s_nop 0
L_t2e_7:
    v_lshlrev_b32 v179, 3, v3
    v_cvt_f32_u32 v200, v179
    v_lshlrev_b32 v212, 4, v1
    s_sub_u32 s25, s20, 2
    s_lshl_b32 s24, s25, 14
    v_add_u32 v212, s24, v212
    s_lshl_b32 s24, s45, 6
    s_lshl_b32 s25, s25, 5
    s_add_u32 s24, s24, s25
    v_add_u32 v175, s24, v2
    v_lshrrev_b32 v179, 1, v175
    v_and_b32 v180, 1, v175
    v_cmp_eq_u32 vcc, 1, v175
    v_mov_b32 v178, 256
    s_nop 0
    v_cndmask_b32 v179, v179, v178, vcc
    v_mov_b32 v178, 0
    v_cndmask_b32 v180, v180, v178, vcc
    v_cvt_f32_u32 v176, v179
    v_mul_f32 v176, 0x3b000000, v176
    v_cvt_f32_u32 v177, v180
    v_mul_f32 v177, 0x3e800000, v177
    v_fmac_f32 v177, v176, v200
    v_fmamk_f32 v184, v176, 0x00000000, v177
    v_fmamk_f32 v185, v176, 0x3f800000, v177
    v_fmamk_f32 v186, v176, 0x40000000, v177
    v_fmamk_f32 v187, v176, 0x40400000, v177
    v_fmamk_f32 v188, v176, 0x40800000, v177
    v_fmamk_f32 v189, v176, 0x40a00000, v177
    v_fmamk_f32 v190, v176, 0x40c00000, v177
    v_fmamk_f32 v191, v176, 0x40e00000, v177
    v_fract_f32 v184, v184
    v_fract_f32 v185, v185
    v_fract_f32 v186, v186
    v_fract_f32 v187, v187
    v_fract_f32 v188, v188
    v_fract_f32 v189, v189
    v_fract_f32 v190, v190
    v_fract_f32 v191, v191
    v_cos_f32 v184, v184
    v_cos_f32 v185, v185
    v_cos_f32 v186, v186
    v_cos_f32 v187, v187
    v_cos_f32 v188, v188
    v_cos_f32 v189, v189
    v_cos_f32 v190, v190
    v_cos_f32 v191, v191
    v_cvt_pk_bf16_f32 v204, v184, v185
    v_cvt_pk_bf16_f32 v205, v186, v187
    v_cvt_pk_bf16_f32 v206, v188, v189
    v_cvt_pk_bf16_f32 v207, v190, v191
    ds_write_b128 v212, v[204:207] offset:0
    v_fmamk_f32 v192, v176, 0x41800000, v177
    v_fmamk_f32 v193, v176, 0x41880000, v177
    v_fmamk_f32 v194, v176, 0x41900000, v177
    v_fmamk_f32 v195, v176, 0x41980000, v177
    v_fmamk_f32 v196, v176, 0x41a00000, v177
    v_fmamk_f32 v197, v176, 0x41a80000, v177
    v_fmamk_f32 v198, v176, 0x41b00000, v177
    v_fmamk_f32 v199, v176, 0x41b80000, v177
    v_fract_f32 v192, v192
    v_fract_f32 v193, v193
    v_fract_f32 v194, v194
    v_fract_f32 v195, v195
    v_fract_f32 v196, v196
    v_fract_f32 v197, v197
    v_fract_f32 v198, v198
    v_fract_f32 v199, v199
    v_cos_f32 v192, v192
    v_cos_f32 v193, v193
    v_cos_f32 v194, v194
    v_cos_f32 v195, v195
    v_cos_f32 v196, v196
    v_cos_f32 v197, v197
    v_cos_f32 v198, v198
    v_cos_f32 v199, v199
    v_cvt_pk_bf16_f32 v208, v192, v193
    v_cvt_pk_bf16_f32 v209, v194, v195
    v_cvt_pk_bf16_f32 v210, v196, v197
    v_cvt_pk_bf16_f32 v211, v198, v199
    ds_write_b128 v212, v[208:211] offset:1024
    v_fmamk_f32 v184, v176, 0x42000000, v177
    v_fmamk_f32 v185, v176, 0x42040000, v177
    v_fmamk_f32 v186, v176, 0x42080000, v177
    v_fmamk_f32 v187, v176, 0x420c0000, v177
    v_fmamk_f32 v188, v176, 0x42100000, v177
    v_fmamk_f32 v189, v176, 0x42140000, v177
    v_fmamk_f32 v190, v176, 0x42180000, v177
    v_fmamk_f32 v191, v176, 0x421c0000, v177
    v_fract_f32 v184, v184
    v_fract_f32 v185, v185
    v_fract_f32 v186, v186
    v_fract_f32 v187, v187
    v_fract_f32 v188, v188
    v_fract_f32 v189, v189
    v_fract_f32 v190, v190
    v_fract_f32 v191, v191
    v_cos_f32 v184, v184
    v_cos_f32 v185, v185
    v_cos_f32 v186, v186
    v_cos_f32 v187, v187
    v_cos_f32 v188, v188
    v_cos_f32 v189, v189
    v_cos_f32 v190, v190
    v_cos_f32 v191, v191
    v_cvt_pk_bf16_f32 v204, v184, v185
    v_cvt_pk_bf16_f32 v205, v186, v187
    v_cvt_pk_bf16_f32 v206, v188, v189
    v_cvt_pk_bf16_f32 v207, v190, v191
    ds_write_b128 v212, v[204:207] offset:2048
    v_fmamk_f32 v192, v176, 0x42400000, v177
    v_fmamk_f32 v193, v176, 0x42440000, v177
    v_fmamk_f32 v194, v176, 0x42480000, v177
    v_fmamk_f32 v195, v176, 0x424c0000, v177
    v_fmamk_f32 v196, v176, 0x42500000, v177
    v_fmamk_f32 v197, v176, 0x42540000, v177
    v_fmamk_f32 v198, v176, 0x42580000, v177
    v_fmamk_f32 v199, v176, 0x425c0000, v177
    v_fract_f32 v192, v192
    v_fract_f32 v193, v193
    v_fract_f32 v194, v194
    v_fract_f32 v195, v195
    v_fract_f32 v196, v196
    v_fract_f32 v197, v197
    v_fract_f32 v198, v198
    v_fract_f32 v199, v199
    v_cos_f32 v192, v192
    v_cos_f32 v193, v193
    v_cos_f32 v194, v194
    v_cos_f32 v195, v195
    v_cos_f32 v196, v196
    v_cos_f32 v197, v197
    v_cos_f32 v198, v198
    v_cos_f32 v199, v199
    v_cvt_pk_bf16_f32 v208, v192, v193
    v_cvt_pk_bf16_f32 v209, v194, v195
    v_cvt_pk_bf16_f32 v210, v196, v197
    v_cvt_pk_bf16_f32 v211, v198, v199
    ds_write_b128 v212, v[208:211] offset:3072
    v_fmamk_f32 v184, v176, 0x42800000, v177
    v_fmamk_f32 v185, v176, 0x42820000, v177
    v_fmamk_f32 v186, v176, 0x42840000, v177
    v_fmamk_f32 v187, v176, 0x42860000, v177
    v_fmamk_f32 v188, v176, 0x42880000, v177
    v_fmamk_f32 v189, v176, 0x428a0000, v177
    v_fmamk_f32 v190, v176, 0x428c0000, v177
    v_fmamk_f32 v191, v176, 0x428e0000, v177
    v_fract_f32 v184, v184
    v_fract_f32 v185, v185
    v_fract_f32 v186, v186
    v_fract_f32 v187, v187
    v_fract_f32 v188, v188
    v_fract_f32 v189, v189
    v_fract_f32 v190, v190
    v_fract_f32 v191, v191
    v_cos_f32 v184, v184
    v_cos_f32 v185, v185
    v_cos_f32 v186, v186
    v_cos_f32 v187, v187
    v_cos_f32 v188, v188
    v_cos_f32 v189, v189
    v_cos_f32 v190, v190
    v_cos_f32 v191, v191
    v_cvt_pk_bf16_f32 v204, v184, v185
    v_cvt_pk_bf16_f32 v205, v186, v187
    v_cvt_pk_bf16_f32 v206, v188, v189
    v_cvt_pk_bf16_f32 v207, v190, v191
    ds_write_b128 v212, v[204:207] offset:4096
    v_fmamk_f32 v192, v176, 0x42a00000, v177
    v_fmamk_f32 v193, v176, 0x42a20000, v177
    v_fmamk_f32 v194, v176, 0x42a40000, v177
    v_fmamk_f32 v195, v176, 0x42a60000, v177
    v_fmamk_f32 v196, v176, 0x42a80000, v177
    v_fmamk_f32 v197, v176, 0x42aa0000, v177
    v_fmamk_f32 v198, v176, 0x42ac0000, v177
    v_fmamk_f32 v199, v176, 0x42ae0000, v177
    v_fract_f32 v192, v192
    v_fract_f32 v193, v193
    v_fract_f32 v194, v194
    v_fract_f32 v195, v195
    v_fract_f32 v196, v196
    v_fract_f32 v197, v197
    v_fract_f32 v198, v198
    v_fract_f32 v199, v199
    v_cos_f32 v192, v192
    v_cos_f32 v193, v193
    v_cos_f32 v194, v194
    v_cos_f32 v195, v195
    v_cos_f32 v196, v196
    v_cos_f32 v197, v197
    v_cos_f32 v198, v198
    v_cos_f32 v199, v199
    v_cvt_pk_bf16_f32 v208, v192, v193
    v_cvt_pk_bf16_f32 v209, v194, v195
    v_cvt_pk_bf16_f32 v210, v196, v197
    v_cvt_pk_bf16_f32 v211, v198, v199
    ds_write_b128 v212, v[208:211] offset:5120
    v_fmamk_f32 v184, v176, 0x42c00000, v177
    v_fmamk_f32 v185, v176, 0x42c20000, v177
    v_fmamk_f32 v186, v176, 0x42c40000, v177
    v_fmamk_f32 v187, v176, 0x42c60000, v177
    v_fmamk_f32 v188, v176, 0x42c80000, v177
    v_fmamk_f32 v189, v176, 0x42ca0000, v177
    v_fmamk_f32 v190, v176, 0x42cc0000, v177
    v_fmamk_f32 v191, v176, 0x42ce0000, v177
    v_fract_f32 v184, v184
    v_fract_f32 v185, v185
    v_fract_f32 v186, v186
    v_fract_f32 v187, v187
    v_fract_f32 v188, v188
    v_fract_f32 v189, v189
    v_fract_f32 v190, v190
    v_fract_f32 v191, v191
    v_cos_f32 v184, v184
    v_cos_f32 v185, v185
    v_cos_f32 v186, v186
    v_cos_f32 v187, v187
    v_cos_f32 v188, v188
    v_cos_f32 v189, v189
    v_cos_f32 v190, v190
    v_cos_f32 v191, v191
    v_cvt_pk_bf16_f32 v204, v184, v185
    v_cvt_pk_bf16_f32 v205, v186, v187
    v_cvt_pk_bf16_f32 v206, v188, v189
    v_cvt_pk_bf16_f32 v207, v190, v191
    ds_write_b128 v212, v[204:207] offset:6144
    v_fmamk_f32 v192, v176, 0x42e00000, v177
    v_fmamk_f32 v193, v176, 0x42e20000, v177
    v_fmamk_f32 v194, v176, 0x42e40000, v177
    v_fmamk_f32 v195, v176, 0x42e60000, v177
    v_fmamk_f32 v196, v176, 0x42e80000, v177
    v_fmamk_f32 v197, v176, 0x42ea0000, v177
    v_fmamk_f32 v198, v176, 0x42ec0000, v177
    v_fmamk_f32 v199, v176, 0x42ee0000, v177
    v_fract_f32 v192, v192
    v_fract_f32 v193, v193
    v_fract_f32 v194, v194
    v_fract_f32 v195, v195
    v_fract_f32 v196, v196
    v_fract_f32 v197, v197
    v_fract_f32 v198, v198
    v_fract_f32 v199, v199
    v_cos_f32 v192, v192
    v_cos_f32 v193, v193
    v_cos_f32 v194, v194
    v_cos_f32 v195, v195
    v_cos_f32 v196, v196
    v_cos_f32 v197, v197
    v_cos_f32 v198, v198
    v_cos_f32 v199, v199
    v_cvt_pk_bf16_f32 v208, v192, v193
    v_cvt_pk_bf16_f32 v209, v194, v195
    v_cvt_pk_bf16_f32 v210, v196, v197
    v_cvt_pk_bf16_f32 v211, v198, v199
    ds_write_b128 v212, v[208:211] offset:7168
    v_fmamk_f32 v184, v176, 0x43000000, v177
    v_fmamk_f32 v185, v176, 0x43010000, v177
    v_fmamk_f32 v186, v176, 0x43020000, v177
    v_fmamk_f32 v187, v176, 0x43030000, v177
    v_fmamk_f32 v188, v176, 0x43040000, v177
    v_fmamk_f32 v189, v176, 0x43050000, v177
    v_fmamk_f32 v190, v176, 0x43060000, v177
    v_fmamk_f32 v191, v176, 0x43070000, v177
    v_fract_f32 v184, v184
    v_fract_f32 v185, v185
    v_fract_f32 v186, v186
    v_fract_f32 v187, v187
    v_fract_f32 v188, v188
    v_fract_f32 v189, v189
    v_fract_f32 v190, v190
    v_fract_f32 v191, v191
    v_cos_f32 v184, v184
    v_cos_f32 v185, v185
    v_cos_f32 v186, v186
    v_cos_f32 v187, v187
    v_cos_f32 v188, v188
    v_cos_f32 v189, v189
    v_cos_f32 v190, v190
    v_cos_f32 v191, v191
    v_cvt_pk_bf16_f32 v204, v184, v185
    v_cvt_pk_bf16_f32 v205, v186, v187
    v_cvt_pk_bf16_f32 v206, v188, v189
    v_cvt_pk_bf16_f32 v207, v190, v191
    ds_write_b128 v212, v[204:207] offset:8192
    v_fmamk_f32 v192, v176, 0x43100000, v177
    v_fmamk_f32 v193, v176, 0x43110000, v177
    v_fmamk_f32 v194, v176, 0x43120000, v177
    v_fmamk_f32 v195, v176, 0x43130000, v177
    v_fmamk_f32 v196, v176, 0x43140000, v177
    v_fmamk_f32 v197, v176, 0x43150000, v177
    v_fmamk_f32 v198, v176, 0x43160000, v177
    v_fmamk_f32 v199, v176, 0x43170000, v177
    v_fract_f32 v192, v192
    v_fract_f32 v193, v193
    v_fract_f32 v194, v194
    v_fract_f32 v195, v195
    v_fract_f32 v196, v196
    v_fract_f32 v197, v197
    v_fract_f32 v198, v198
    v_fract_f32 v199, v199
    v_cos_f32 v192, v192
    v_cos_f32 v193, v193
    v_cos_f32 v194, v194
    v_cos_f32 v195, v195
    v_cos_f32 v196, v196
    v_cos_f32 v197, v197
    v_cos_f32 v198, v198
    v_cos_f32 v199, v199
    v_cvt_pk_bf16_f32 v208, v192, v193
    v_cvt_pk_bf16_f32 v209, v194, v195
    v_cvt_pk_bf16_f32 v210, v196, v197
    v_cvt_pk_bf16_f32 v211, v198, v199
    ds_write_b128 v212, v[208:211] offset:9216
    v_fmamk_f32 v184, v176, 0x43200000, v177
    v_fmamk_f32 v185, v176, 0x43210000, v177
    v_fmamk_f32 v186, v176, 0x43220000, v177
    v_fmamk_f32 v187, v176, 0x43230000, v177
    v_fmamk_f32 v188, v176, 0x43240000, v177
    v_fmamk_f32 v189, v176, 0x43250000, v177
    v_fmamk_f32 v190, v176, 0x43260000, v177
    v_fmamk_f32 v191, v176, 0x43270000, v177
    v_fract_f32 v184, v184
    v_fract_f32 v185, v185
    v_fract_f32 v186, v186
    v_fract_f32 v187, v187
    v_fract_f32 v188, v188
    v_fract_f32 v189, v189
    v_fract_f32 v190, v190
    v_fract_f32 v191, v191
    v_cos_f32 v184, v184
    v_cos_f32 v185, v185
    v_cos_f32 v186, v186
    v_cos_f32 v187, v187
    v_cos_f32 v188, v188
    v_cos_f32 v189, v189
    v_cos_f32 v190, v190
    v_cos_f32 v191, v191
    v_cvt_pk_bf16_f32 v204, v184, v185
    v_cvt_pk_bf16_f32 v205, v186, v187
    v_cvt_pk_bf16_f32 v206, v188, v189
    v_cvt_pk_bf16_f32 v207, v190, v191
    ds_write_b128 v212, v[204:207] offset:10240
    v_fmamk_f32 v192, v176, 0x43300000, v177
    v_fmamk_f32 v193, v176, 0x43310000, v177
    v_fmamk_f32 v194, v176, 0x43320000, v177
    v_fmamk_f32 v195, v176, 0x43330000, v177
    v_fmamk_f32 v196, v176, 0x43340000, v177
    v_fmamk_f32 v197, v176, 0x43350000, v177
    v_fmamk_f32 v198, v176, 0x43360000, v177
    v_fmamk_f32 v199, v176, 0x43370000, v177
    v_fract_f32 v192, v192
    v_fract_f32 v193, v193
    v_fract_f32 v194, v194
    v_fract_f32 v195, v195
    v_fract_f32 v196, v196
    v_fract_f32 v197, v197
    v_fract_f32 v198, v198
    v_fract_f32 v199, v199
    v_cos_f32 v192, v192
    v_cos_f32 v193, v193
    v_cos_f32 v194, v194
    v_cos_f32 v195, v195
    v_cos_f32 v196, v196
    v_cos_f32 v197, v197
    v_cos_f32 v198, v198
    v_cos_f32 v199, v199
    v_cvt_pk_bf16_f32 v208, v192, v193
    v_cvt_pk_bf16_f32 v209, v194, v195
    v_cvt_pk_bf16_f32 v210, v196, v197
    v_cvt_pk_bf16_f32 v211, v198, v199
    ds_write_b128 v212, v[208:211] offset:11264
    v_fmamk_f32 v184, v176, 0x43400000, v177
    v_fmamk_f32 v185, v176, 0x43410000, v177
    v_fmamk_f32 v186, v176, 0x43420000, v177
    v_fmamk_f32 v187, v176, 0x43430000, v177
    v_fmamk_f32 v188, v176, 0x43440000, v177
    v_fmamk_f32 v189, v176, 0x43450000, v177
    v_fmamk_f32 v190, v176, 0x43460000, v177
    v_fmamk_f32 v191, v176, 0x43470000, v177
    v_fract_f32 v184, v184
    v_fract_f32 v185, v185
    v_fract_f32 v186, v186
    v_fract_f32 v187, v187
    v_fract_f32 v188, v188
    v_fract_f32 v189, v189
    v_fract_f32 v190, v190
    v_fract_f32 v191, v191
    v_cos_f32 v184, v184
    v_cos_f32 v185, v185
    v_cos_f32 v186, v186
    v_cos_f32 v187, v187
    v_cos_f32 v188, v188
    v_cos_f32 v189, v189
    v_cos_f32 v190, v190
    v_cos_f32 v191, v191
    v_cvt_pk_bf16_f32 v204, v184, v185
    v_cvt_pk_bf16_f32 v205, v186, v187
    v_cvt_pk_bf16_f32 v206, v188, v189
    v_cvt_pk_bf16_f32 v207, v190, v191
    ds_write_b128 v212, v[204:207] offset:12288
    v_fmamk_f32 v192, v176, 0x43500000, v177
    v_fmamk_f32 v193, v176, 0x43510000, v177
    v_fmamk_f32 v194, v176, 0x43520000, v177
    v_fmamk_f32 v195, v176, 0x43530000, v177
    v_fmamk_f32 v196, v176, 0x43540000, v177
    v_fmamk_f32 v197, v176, 0x43550000, v177
    v_fmamk_f32 v198, v176, 0x43560000, v177
    v_fmamk_f32 v199, v176, 0x43570000, v177
    v_fract_f32 v192, v192
    v_fract_f32 v193, v193
    v_fract_f32 v194, v194
    v_fract_f32 v195, v195
    v_fract_f32 v196, v196
    v_fract_f32 v197, v197
    v_fract_f32 v198, v198
    v_fract_f32 v199, v199
    v_cos_f32 v192, v192
    v_cos_f32 v193, v193
    v_cos_f32 v194, v194
    v_cos_f32 v195, v195
    v_cos_f32 v196, v196
    v_cos_f32 v197, v197
    v_cos_f32 v198, v198
    v_cos_f32 v199, v199
    v_cvt_pk_bf16_f32 v208, v192, v193
    v_cvt_pk_bf16_f32 v209, v194, v195
    v_cvt_pk_bf16_f32 v210, v196, v197
    v_cvt_pk_bf16_f32 v211, v198, v199
    ds_write_b128 v212, v[208:211] offset:13312
    v_fmamk_f32 v184, v176, 0x43600000, v177
    v_fmamk_f32 v185, v176, 0x43610000, v177
    v_fmamk_f32 v186, v176, 0x43620000, v177
    v_fmamk_f32 v187, v176, 0x43630000, v177
    v_fmamk_f32 v188, v176, 0x43640000, v177
    v_fmamk_f32 v189, v176, 0x43650000, v177
    v_fmamk_f32 v190, v176, 0x43660000, v177
    v_fmamk_f32 v191, v176, 0x43670000, v177
    v_fract_f32 v184, v184
    v_fract_f32 v185, v185
    v_fract_f32 v186, v186
    v_fract_f32 v187, v187
    v_fract_f32 v188, v188
    v_fract_f32 v189, v189
    v_fract_f32 v190, v190
    v_fract_f32 v191, v191
    v_cos_f32 v184, v184
    v_cos_f32 v185, v185
    v_cos_f32 v186, v186
    v_cos_f32 v187, v187
    v_cos_f32 v188, v188
    v_cos_f32 v189, v189
    v_cos_f32 v190, v190
    v_cos_f32 v191, v191
    v_cvt_pk_bf16_f32 v204, v184, v185
    v_cvt_pk_bf16_f32 v205, v186, v187
    v_cvt_pk_bf16_f32 v206, v188, v189
    v_cvt_pk_bf16_f32 v207, v190, v191
    ds_write_b128 v212, v[204:207] offset:14336
    v_fmamk_f32 v192, v176, 0x43700000, v177
    v_fmamk_f32 v193, v176, 0x43710000, v177
    v_fmamk_f32 v194, v176, 0x43720000, v177
    v_fmamk_f32 v195, v176, 0x43730000, v177
    v_fmamk_f32 v196, v176, 0x43740000, v177
    v_fmamk_f32 v197, v176, 0x43750000, v177
    v_fmamk_f32 v198, v176, 0x43760000, v177
    v_fmamk_f32 v199, v176, 0x43770000, v177
    v_fract_f32 v192, v192
    v_fract_f32 v193, v193
    v_fract_f32 v194, v194
    v_fract_f32 v195, v195
    v_fract_f32 v196, v196
    v_fract_f32 v197, v197
    v_fract_f32 v198, v198
    v_fract_f32 v199, v199
    v_cos_f32 v192, v192
    v_cos_f32 v193, v193
    v_cos_f32 v194, v194
    v_cos_f32 v195, v195
    v_cos_f32 v196, v196
    v_cos_f32 v197, v197
    v_cos_f32 v198, v198
    v_cos_f32 v199, v199
    v_cvt_pk_bf16_f32 v208, v192, v193
    v_cvt_pk_bf16_f32 v209, v194, v195
    v_cvt_pk_bf16_f32 v210, v196, v197
    v_cvt_pk_bf16_f32 v211, v198, v199
    ds_write_b128 v212, v[208:211] offset:15360
    s_nop 0
L_rolej_4:
    s_cmp_ge_u32 s20, 2
    s_cbranch_scc1 L_xp1_8
    s_lshl_b32 s47, s44, 10
    s_lshl_b32 s24, s20, 20
    s_add_u32 s47, s47, s24
    s_mov_b32 s52, s64
    s_mov_b32 s53, s65
    s_mov_b32 s54, 0x200000
    s_mov_b32 s55, 0x00020000
    v_lshlrev_b32 v172, 15, v2
    v_lshl_add_u32 v172, v3, 4, v172
    buffer_load_dwordx4 a[160:163], v172, s[52:55], s47 offen offset:256
    buffer_load_dwordx4 a[164:167], v172, s[52:55], s47 offen offset:288
    buffer_load_dwordx4 a[168:171], v172, s[52:55], s47 offen offset:320
    buffer_load_dwordx4 a[172:175], v172, s[52:55], s47 offen offset:352
    buffer_load_dwordx4 a[224:227], v172, s[52:55], s47 offen offset:768
    buffer_load_dwordx4 a[228:231], v172, s[52:55], s47 offen offset:800
    buffer_load_dwordx4 a[232:235], v172, s[52:55], s47 offen offset:832
    buffer_load_dwordx4 a[236:239], v172, s[52:55], s47 offen offset:864
    buffer_load_dwordx4 a[176:179], v172, s[52:55], s47 offen offset:384
    buffer_load_dwordx4 a[180:183], v172, s[52:55], s47 offen offset:416
    buffer_load_dwordx4 a[184:187], v172, s[52:55], s47 offen offset:448
    buffer_load_dwordx4 a[188:191], v172, s[52:55], s47 offen offset:480
    buffer_load_dwordx4 a[240:243], v172, s[52:55], s47 offen offset:896
    buffer_load_dwordx4 a[244:247], v172, s[52:55], s47 offen offset:928
    buffer_load_dwordx4 a[248:251], v172, s[52:55], s47 offen offset:960
    buffer_load_dwordx4 a[252:255], v172, s[52:55], s47 offen offset:992
L_xp1_8:
    s_waitcnt lgkmcnt(0)
    s_barrier
    v_lshlrev_b32 v175, 4, v1
    ds_read_b128 a[0:3], v175 offset:0
    ds_read_b128 a[4:7], v175 offset:1024
    ds_read_b128 a[8:11], v175 offset:2048
    ds_read_b128 a[12:15], v175 offset:3072
    ds_read_b128 a[16:19], v175 offset:4096
    ds_read_b128 a[20:23], v175 offset:5120
    ds_read_b128 a[24:27], v175 offset:6144
    ds_read_b128 a[28:31], v175 offset:7168
    ds_read_b128 a[32:35], v175 offset:8192
    ds_read_b128 a[36:39], v175 offset:9216
    ds_read_b128 a[40:43], v175 offset:10240
    ds_read_b128 a[44:47], v175 offset:11264
    s_waitcnt lgkmcnt(4)
    ds_read_b128 a[48:51], v175 offset:12288
    ds_read_b128 a[52:55], v175 offset:13312
    ds_read_b128 a[56:59], v175 offset:14336
    ds_read_b128 a[60:63], v175 offset:15360
    ds_read_b128 a[64:67], v175 offset:16384
    ds_read_b128 a[68:71], v175 offset:17408
    ds_read_b128 a[72:75], v175 offset:18432
    ds_read_b128 a[76:79], v175 offset:19456
    ds_read_b128 a[80:83], v175 offset:20480
    ds_read_b128 a[84:87], v175 offset:21504
    ds_read_b128 a[88:91], v175 offset:22528
    ds_read_b128 a[92:95], v175 offset:23552
    s_waitcnt lgkmcnt(4)
    ds_read_b128 a[96:99], v175 offset:24576
    ds_read_b128 a[100:103], v175 offset:25600
    ds_read_b128 a[104:107], v175 offset:26624
    ds_read_b128 a[108:111], v175 offset:27648
    ds_read_b128 a[112:115], v175 offset:28672
    ds_read_b128 a[116:119], v175 offset:29696
    ds_read_b128 a[120:123], v175 offset:30720
    ds_read_b128 a[124:127], v175 offset:31744
    s_waitcnt lgkmcnt(0)
    s_barrier
    s_cmp_lg_u32 s20, 0
    s_cbranch_scc1 L_nodbg_9
    s_mov_b32 s4, s80
    s_mov_b32 s5, s81
    s_mov_b32 s6, 0x100
    s_mov_b32 s7, 0x00020000
    v_mov_b32 v169, 0
    buffer_load_dword v168, v169, s[4:7], 0 offen sc0 sc1
    s_nop 0
L_nodbg_9:
    s_cmp_ge_u32 s20, 2
    s_cbranch_scc1 L_roleW2_10
    s_waitcnt vmcnt(24)
    v_mfma_f32_32x32x16_bf16 v[104:119], a[128:131], a[0:3], 0
    v_mfma_f32_32x32x16_bf16 v[120:135], a[128:131], a[64:67], 0
    v_mfma_f32_32x32x16_bf16 v[136:151], a[192:195], a[0:3], 0
    v_mfma_f32_32x32x16_bf16 v[152:167], a[192:195], a[64:67], 0
    v_mfma_f32_32x32x16_bf16 v[104:119], a[132:135], a[4:7], v[104:119]
    v_mfma_f32_32x32x16_bf16 v[120:135], a[132:135], a[68:71], v[120:135]
    v_mfma_f32_32x32x16_bf16 v[136:151], a[196:199], a[4:7], v[136:151]
    v_mfma_f32_32x32x16_bf16 v[152:167], a[196:199], a[68:71], v[152:167]
    v_mfma_f32_32x32x16_bf16 v[104:119], a[136:139], a[8:11], v[104:119]
    v_mfma_f32_32x32x16_bf16 v[120:135], a[136:139], a[72:75], v[120:135]
    v_mfma_f32_32x32x16_bf16 v[136:151], a[200:203], a[8:11], v[136:151]
    v_mfma_f32_32x32x16_bf16 v[152:167], a[200:203], a[72:75], v[152:167]
    v_mfma_f32_32x32x16_bf16 v[104:119], a[140:143], a[12:15], v[104:119]
    v_mfma_f32_32x32x16_bf16 v[120:135], a[140:143], a[76:79], v[120:135]
    v_mfma_f32_32x32x16_bf16 v[136:151], a[204:207], a[12:15], v[136:151]
    v_mfma_f32_32x32x16_bf16 v[152:167], a[204:207], a[76:79], v[152:167]
    s_waitcnt vmcnt(16)
    v_mfma_f32_32x32x16_bf16 v[104:119], a[144:147], a[16:19], v[104:119]
    v_mfma_f32_32x32x16_bf16 v[120:135], a[144:147], a[80:83], v[120:135]
    v_mfma_f32_32x32x16_bf16 v[136:151], a[208:211], a[16:19], v[136:151]
    v_mfma_f32_32x32x16_bf16 v[152:167], a[208:211], a[80:83], v[152:167]
    v_mfma_f32_32x32x16_bf16 v[104:119], a[148:151], a[20:23], v[104:119]
    v_mfma_f32_32x32x16_bf16 v[120:135], a[148:151], a[84:87], v[120:135]
    v_mfma_f32_32x32x16_bf16 v[136:151], a[212:215], a[20:23], v[136:151]
    v_mfma_f32_32x32x16_bf16 v[152:167], a[212:215], a[84:87], v[152:167]
    v_mfma_f32_32x32x16_bf16 v[104:119], a[152:155], a[24:27], v[104:119]
    v_mfma_f32_32x32x16_bf16 v[120:135], a[152:155], a[88:91], v[120:135]
    v_mfma_f32_32x32x16_bf16 v[136:151], a[216:219], a[24:27], v[136:151]
    v_mfma_f32_32x32x16_bf16 v[152:167], a[216:219], a[88:91], v[152:167]
    v_mfma_f32_32x32x16_bf16 v[104:119], a[156:159], a[28:31], v[104:119]
    v_mfma_f32_32x32x16_bf16 v[120:135], a[156:159], a[92:95], v[120:135]
    v_mfma_f32_32x32x16_bf16 v[136:151], a[220:223], a[28:31], v[136:151]
    v_mfma_f32_32x32x16_bf16 v[152:167], a[220:223], a[92:95], v[152:167]
    s_waitcnt vmcnt(8)
    v_mfma_f32_32x32x16_bf16 v[104:119], a[160:163], a[32:35], v[104:119]
    v_mfma_f32_32x32x16_bf16 v[120:135], a[160:163], a[96:99], v[120:135]
    v_mfma_f32_32x32x16_bf16 v[136:151], a[224:227], a[32:35], v[136:151]
    v_mfma_f32_32x32x16_bf16 v[152:167], a[224:227], a[96:99], v[152:167]
    v_mfma_f32_32x32x16_bf16 v[104:119], a[164:167], a[36:39], v[104:119]
    v_mfma_f32_32x32x16_bf16 v[120:135], a[164:167], a[100:103], v[120:135]
    v_mfma_f32_32x32x16_bf16 v[136:151], a[228:231], a[36:39], v[136:151]
    v_mfma_f32_32x32x16_bf16 v[152:167], a[228:231], a[100:103], v[152:167]
    v_mfma_f32_32x32x16_bf16 v[104:119], a[168:171], a[40:43], v[104:119]
    v_mfma_f32_32x32x16_bf16 v[120:135], a[168:171], a[104:107], v[120:135]
    v_mfma_f32_32x32x16_bf16 v[136:151], a[232:235], a[40:43], v[136:151]
    v_mfma_f32_32x32x16_bf16 v[152:167], a[232:235], a[104:107], v[152:167]
    v_mfma_f32_32x32x16_bf16 v[104:119], a[172:175], a[44:47], v[104:119]
    v_mfma_f32_32x32x16_bf16 v[120:135], a[172:175], a[108:111], v[120:135]
    v_mfma_f32_32x32x16_bf16 v[136:151], a[236:239], a[44:47], v[136:151]
    v_mfma_f32_32x32x16_bf16 v[152:167], a[236:239], a[108:111], v[152:167]
    s_waitcnt vmcnt(0)
    v_mfma_f32_32x32x16_bf16 v[104:119], a[176:179], a[48:51], v[104:119]
    v_mfma_f32_32x32x16_bf16 v[120:135], a[176:179], a[112:115], v[120:135]
    v_mfma_f32_32x32x16_bf16 v[136:151], a[240:243], a[48:51], v[136:151]
    v_mfma_f32_32x32x16_bf16 v[152:167], a[240:243], a[112:115], v[152:167]
    v_mfma_f32_32x32x16_bf16 v[104:119], a[180:183], a[52:55], v[104:119]
    v_mfma_f32_32x32x16_bf16 v[120:135], a[180:183], a[116:119], v[120:135]
    v_mfma_f32_32x32x16_bf16 v[136:151], a[244:247], a[52:55], v[136:151]
    v_mfma_f32_32x32x16_bf16 v[152:167], a[244:247], a[116:119], v[152:167]
    v_mfma_f32_32x32x16_bf16 v[104:119], a[184:187], a[56:59], v[104:119]
    v_mfma_f32_32x32x16_bf16 v[120:135], a[184:187], a[120:123], v[120:135]
    v_mfma_f32_32x32x16_bf16 v[136:151], a[248:251], a[56:59], v[136:151]
    v_mfma_f32_32x32x16_bf16 v[152:167], a[248:251], a[120:123], v[152:167]
    v_mfma_f32_32x32x16_bf16 v[104:119], a[188:191], a[60:63], v[104:119]
    v_mfma_f32_32x32x16_bf16 v[120:135], a[188:191], a[124:127], v[120:135]
    v_mfma_f32_32x32x16_bf16 v[136:151], a[252:255], a[60:63], v[136:151]
    v_mfma_f32_32x32x16_bf16 v[152:167], a[252:255], a[124:127], v[152:167]
    s_cmp_lg_u32 s20, 0
    s_nop 9
    s_cbranch_scc1 L_nodbg2_12
    v_readfirstlane_b32 s24, v168
    s_nop 0
    s_cmp_ge_u32 s24, 20
    s_nop 1
    s_cbranch_scc1 L_dbgok_13
    s_mov_b32 s4, s80
    s_mov_b32 s5, s81
    s_mov_b32 s6, 0x100
    s_mov_b32 s7, 0x00020000
    v_mov_b32 v250, 0
    s_mov_b64 exec, 0x1
    s_mov_b32 s31, 0
L_poll_14:
    buffer_load_dword v251, v250, s[4:7], 0 offen sc0 sc1
    s_add_u32 s31, s31, 1
    s_waitcnt vmcnt(0)
    v_cmp_le_u32 vcc, 0x14, v251
    s_nop 0
    s_cmp_eq_u64 vcc, exec
    s_nop 1
    s_cbranch_scc1 L_polld_15
    s_cmp_lt_u32 s31, 1048576
    s_cbranch_scc1 L_poll_14
L_polld_15:
    s_mov_b64 exec, -1
L_dbgok_13:
    v_mov_b32 v169, 156160
    v_mov_b32 v168, 1
    ds_write_b32 v169, v168
    s_nop 0
L_nodbg2_12:
    s_add_u32 s46, s62, 64
    s_sub_u32 s24, s62, 22
    s_cmp_ge_u32 s62, 22
    s_cselect_b32 s46, s24, s46
    s_lshl_b32 s47, s46, 15
    s_mul_i32 s48, s20, 98304
    s_and_b32 s49, s46, 1
    s_cmp_eq_u32 s49, 0
    s_cselect_b32 s56, s72, s74
    s_cselect_b32 s57, s73, s75
    s_mov_b32 s58, 0x158000
    s_mov_b32 s59, 0x00020000
    v_lshrrev_b32 v176, 2, v1
    v_mul_u32_u24 v175, 2752, v176
    v_and_b32 v176, 3, v1
    v_lshl_add_u32 v175, v176, 4, v175
    s_lshr_b32 s50, s46, 1
    s_lshl_b32 s50, s50, 6
    s_mov_b32 s52, s76
    s_mov_b32 s53, s77
    s_mov_b32 s54, 0x158000
    s_mov_b32 s55, 0x00020000
    v_lshlrev_b32 v177, 10, v2
    v_lshl_add_u32 v177, v3, 4, v177
    v_lshlrev_b32 v180, 30, v2
    v_and_b32 v180, 0x80000000, v180
    v_or_b32 v178, 0x3f800000, v180
    v_cmp_gt_u32 vcc, 2, v2
    s_cmp_eq_u32 s45, 0
    s_cselect_b64 s[26:27], vcc, 0
    v_mov_b32 v179, 0x3d800000
    v_mov_b32 v180, 0x3d3504f3
    v_cndmask_b32 v179, v179, v180, s[26:27]
    v_fma_f32 v104, v136, v178, v104
    v_fma_f32 v105, v137, v178, v105
    v_fma_f32 v106, v138, v178, v106
    v_fma_f32 v107, v139, v178, v107
    v_fma_f32 v108, v140, v178, v108
    v_fma_f32 v109, v141, v178, v109
    v_fma_f32 v110, v142, v178, v110
    v_fma_f32 v111, v143, v178, v111
    v_fma_f32 v112, v144, v178, v112
    v_fma_f32 v113, v145, v178, v113
    v_fma_f32 v114, v146, v178, v114
    v_fma_f32 v115, v147, v178, v115
    v_fma_f32 v116, v148, v178, v116
    v_fma_f32 v117, v149, v178, v117
    v_fma_f32 v118, v150, v178, v118
    v_fma_f32 v119, v151, v178, v119
    v_mul_f32 v104, v104, v179
    v_mul_f32 v105, v105, v179
    v_mul_f32 v106, v106, v179
    v_mul_f32 v107, v107, v179
    v_mul_f32 v108, v108, v179
    v_mul_f32 v109, v109, v179
    v_mul_f32 v110, v110, v179
    v_mul_f32 v111, v111, v179
    v_mul_f32 v112, v112, v179
    v_mul_f32 v113, v113, v179
    v_mul_f32 v114, v114, v179
    v_mul_f32 v115, v115, v179
    v_mul_f32 v116, v116, v179
    v_mul_f32 v117, v117, v179
    v_mul_f32 v118, v118, v179
    v_mul_f32 v119, v119, v179
    v_fma_f32 v120, v152, v178, v120
    v_fma_f32 v121, v153, v178, v121
    v_fma_f32 v122, v154, v178, v122
    v_fma_f32 v123, v155, v178, v123
    v_fma_f32 v124, v156, v178, v124
    v_fma_f32 v125, v157, v178, v125
    v_fma_f32 v126, v158, v178, v126
    v_fma_f32 v127, v159, v178, v127
    v_fma_f32 v128, v160, v178, v128
    v_fma_f32 v129, v161, v178, v129
    v_fma_f32 v130, v162, v178, v130
    v_fma_f32 v131, v163, v178, v131
    v_fma_f32 v132, v164, v178, v132
    v_fma_f32 v133, v165, v178, v133
    v_fma_f32 v134, v166, v178, v134
    v_fma_f32 v135, v167, v178, v135
    v_mul_f32 v120, 0x3d800000, v120
    v_mul_f32 v121, 0x3d800000, v121
    v_mul_f32 v122, 0x3d800000, v122
    v_mul_f32 v123, 0x3d800000, v123
    v_mul_f32 v124, 0x3d800000, v124
    v_mul_f32 v125, 0x3d800000, v125
    v_mul_f32 v126, 0x3d800000, v126
    v_mul_f32 v127, 0x3d800000, v127
    v_mul_f32 v128, 0x3d800000, v128
    v_mul_f32 v129, 0x3d800000, v129
    v_mul_f32 v130, 0x3d800000, v130
    v_mul_f32 v131, 0x3d800000, v131
    v_mul_f32 v132, 0x3d800000, v132
    v_mul_f32 v133, 0x3d800000, v133
    v_mul_f32 v134, 0x3d800000, v134
    v_mul_f32 v135, 0x3d800000, v135
    v_cmp_eq_u32 vcc, 0, v2
    s_cmp_eq_u32 s45, 0
    s_cselect_b64 s[26:27], vcc, 0
    v_cndmask_b32 v181, 1.0, 0, s[26:27]
    v_cvt_pk_bf16_f32 v184, v104, v105
    v_cvt_pk_bf16_f32 v185, v106, v107
    v_cvt_pk_bf16_f32 v186, v108, v109
    v_cvt_pk_bf16_f32 v187, v110, v111
    v_cvt_pk_bf16_f32 v188, v112, v113
    v_cvt_pk_bf16_f32 v189, v114, v115
    v_cvt_pk_bf16_f32 v190, v116, v117
    v_cvt_pk_bf16_f32 v191, v118, v119
    v_cvt_pk_bf16_f32 v192, v120, v121
    v_cvt_pk_bf16_f32 v193, v122, v123
    v_cvt_pk_bf16_f32 v194, v124, v125
    v_cvt_pk_bf16_f32 v195, v126, v127
    v_cvt_pk_bf16_f32 v196, v128, v129
    v_cvt_pk_bf16_f32 v197, v130, v131
    v_cvt_pk_bf16_f32 v198, v132, v133
    v_cvt_pk_bf16_f32 v199, v134, v135
    s_mul_i32 s25, s20, 6144
    s_add_u32 s25, s25, 131072
    v_mul_u32_u24 v200, 80, v2
    v_lshl_add_u32 v200, v3, 3, v200
    v_add_u32 v200, s25, v200
    ds_write_b64 v200, v[184:185] offset:0
    ds_write_b64 v200, v[186:187] offset:16
    ds_write_b64 v200, v[188:189] offset:32
    ds_write_b64 v200, v[190:191] offset:48
    ds_write_b64 v200, v[192:193] offset:2560
    ds_write_b64 v200, v[194:195] offset:2576
    ds_write_b64 v200, v[196:197] offset:2592
    ds_write_b64 v200, v[198:199] offset:2608
    v_lshrrev_b32 v220, 2, v1
    v_mul_u32_u24 v201, 80, v220
    v_and_b32 v220, 3, v1
    v_lshl_add_u32 v201, v220, 4, v201
    v_add_u32 v201, s25, v201
    v_mul_f32 v152, v104, v181
    v_mul_f32 v136, v120, v120
    v_mul_f32 v153, v105, v181
    v_mul_f32 v137, v121, v121
    v_mul_f32 v154, v106, v181
    v_mul_f32 v138, v122, v122
    v_mul_f32 v155, v107, v181
    v_mul_f32 v139, v123, v123
    v_mul_f32 v156, v108, v181
    v_mul_f32 v140, v124, v124
    v_mul_f32 v157, v109, v181
    v_mul_f32 v141, v125, v125
    v_mul_f32 v158, v110, v181
    v_mul_f32 v142, v126, v126
    v_mul_f32 v159, v111, v181
    v_mul_f32 v143, v127, v127
    v_mul_f32 v160, v112, v181
    v_mul_f32 v144, v128, v128
    v_mul_f32 v161, v113, v181
    v_mul_f32 v145, v129, v129
    v_mul_f32 v162, v114, v181
    v_mul_f32 v146, v130, v130
    v_mul_f32 v163, v115, v181
    v_mul_f32 v147, v131, v131
    v_mul_f32 v164, v116, v181
    v_mul_f32 v148, v132, v132
    v_mul_f32 v165, v117, v181
    v_mul_f32 v149, v133, v133
    v_mul_f32 v166, v118, v181
    v_mul_f32 v150, v134, v134
    v_mul_f32 v167, v119, v181
    v_mul_f32 v151, v135, v135
    v_fmac_f32 v136, v152, v152
    v_fmac_f32 v137, v153, v153
    v_fmac_f32 v138, v154, v154
    v_fmac_f32 v139, v155, v155
    v_fmac_f32 v140, v156, v156
    v_fmac_f32 v141, v157, v157
    v_fmac_f32 v142, v158, v158
    v_fmac_f32 v143, v159, v159
    v_fmac_f32 v144, v160, v160
    v_fmac_f32 v145, v161, v161
    v_fmac_f32 v146, v162, v162
    v_fmac_f32 v147, v163, v163
    v_fmac_f32 v148, v164, v164
    v_fmac_f32 v149, v165, v165
    v_fmac_f32 v150, v166, v166
    v_fmac_f32 v151, v167, v167
    s_waitcnt lgkmcnt(0)
    ds_read_b128 v[204:207], v201 offset:0
    ds_read_b128 v[208:211], v201 offset:1280
    ds_read_b128 v[212:215], v201 offset:2560
    ds_read_b128 v[216:219], v201 offset:3840
    s_mov_b32 s8, s82
    s_mov_b32 s9, s83
    s_mov_b32 s10, 0x200000
    s_mov_b32 s11, 0x00020000
    v_lshlrev_b32 v220, 4, v1
    s_lshl_b32 s24, s44, 16
    s_lshl_b32 s26, s20, 15
    s_add_u32 s24, s24, s26
    s_lshl_b32 s26, s45, 12
    s_add_u32 s24, s24, s26
    s_waitcnt lgkmcnt(3)
    buffer_store_dwordx4 v[204:207], v220, s[8:11], s24 offen offset:0 sc1
    s_waitcnt lgkmcnt(2)
    buffer_store_dwordx4 v[208:211], v220, s[8:11], s24 offen offset:1024 sc1
    s_waitcnt lgkmcnt(1)
    buffer_store_dwordx4 v[212:215], v220, s[8:11], s24 offen offset:2048 sc1
    s_waitcnt lgkmcnt(0)
    buffer_store_dwordx4 v[216:219], v220, s[8:11], s24 offen offset:3072 sc1
    s_cmp_ge_u32 s62, 22
    s_cbranch_scc1 L_m2d_16
    s_add_u32 m0, s48, 0
    s_add_u32 s49, s50, 0
    buffer_load_dwordx4 v175, s[56:59], s49 offen lds
    s_add_u32 m0, s48, 1024
    s_add_u32 s49, s50, 44032
    buffer_load_dwordx4 v175, s[56:59], s49 offen lds
    s_add_u32 m0, s48, 2048
    s_add_u32 s49, s50, 88064
    buffer_load_dwordx4 v175, s[56:59], s49 offen lds
    s_add_u32 m0, s48, 3072
    s_add_u32 s49, s50, 132096
    buffer_load_dwordx4 v175, s[56:59], s49 offen lds
    s_add_u32 m0, s48, 16384
    s_add_u32 s49, s50, 704512
    buffer_load_dwordx4 v175, s[56:59], s49 offen lds
    s_add_u32 m0, s48, 17408
    s_add_u32 s49, s50, 748544
    buffer_load_dwordx4 v175, s[56:59], s49 offen lds
    s_add_u32 m0, s48, 18432
    s_add_u32 s49, s50, 792576
    buffer_load_dwordx4 v175, s[56:59], s49 offen lds
    s_add_u32 m0, s48, 19456
    s_add_u32 s49, s50, 836608
    buffer_load_dwordx4 v175, s[56:59], s49 offen lds
    s_add_u32 m0, s48, 4096
    s_add_u32 s49, s50, 176128
    buffer_load_dwordx4 v175, s[56:59], s49 offen lds
    s_add_u32 m0, s48, 5120
    s_add_u32 s49, s50, 220160
    buffer_load_dwordx4 v175, s[56:59], s49 offen lds
    s_add_u32 m0, s48, 6144
    s_add_u32 s49, s50, 264192
    buffer_load_dwordx4 v175, s[56:59], s49 offen lds
    s_add_u32 m0, s48, 7168
    s_add_u32 s49, s50, 308224
    buffer_load_dwordx4 v175, s[56:59], s49 offen lds
    s_branch L_m2e_17
L_m2d_16:
    buffer_load_dwordx4 a[128:131], v177, s[52:55], s47 offen offset:0
    buffer_load_dwordx4 a[132:135], v177, s[52:55], s47 offen offset:32
    buffer_load_dwordx4 a[136:139], v177, s[52:55], s47 offen offset:64
    buffer_load_dwordx4 a[140:143], v177, s[52:55], s47 offen offset:96
    buffer_load_dwordx4 a[192:195], v177, s[52:55], s47 offen offset:512
    buffer_load_dwordx4 a[196:199], v177, s[52:55], s47 offen offset:544
    buffer_load_dwordx4 a[200:203], v177, s[52:55], s47 offen offset:576
    buffer_load_dwordx4 a[204:207], v177, s[52:55], s47 offen offset:608
    buffer_load_dwordx4 a[144:147], v177, s[52:55], s47 offen offset:128
    buffer_load_dwordx4 a[148:151], v177, s[52:55], s47 offen offset:160
    buffer_load_dwordx4 a[152:155], v177, s[52:55], s47 offen offset:192
    buffer_load_dwordx4 a[156:159], v177, s[52:55], s47 offen offset:224
L_m2e_17:
    v_add_f32_dpp v136, v136, v136 row_ror:8 row_mask:0xf bank_mask:0xf
    v_add_f32_dpp v137, v137, v137 row_ror:8 row_mask:0xf bank_mask:0xf
    v_add_f32_dpp v138, v138, v138 row_ror:8 row_mask:0xf bank_mask:0xf
    v_add_f32_dpp v139, v139, v139 row_ror:8 row_mask:0xf bank_mask:0xf
    v_add_f32_dpp v140, v140, v140 row_ror:8 row_mask:0xf bank_mask:0xf
    v_add_f32_dpp v141, v141, v141 row_ror:8 row_mask:0xf bank_mask:0xf
    v_add_f32_dpp v142, v142, v142 row_ror:8 row_mask:0xf bank_mask:0xf
    v_add_f32_dpp v143, v143, v143 row_ror:8 row_mask:0xf bank_mask:0xf
    v_add_f32_dpp v144, v144, v144 row_ror:8 row_mask:0xf bank_mask:0xf
    v_add_f32_dpp v145, v145, v145 row_ror:8 row_mask:0xf bank_mask:0xf
    v_add_f32_dpp v146, v146, v146 row_ror:8 row_mask:0xf bank_mask:0xf
    v_add_f32_dpp v147, v147, v147 row_ror:8 row_mask:0xf bank_mask:0xf
    v_add_f32_dpp v148, v148, v148 row_ror:8 row_mask:0xf bank_mask:0xf
    v_add_f32_dpp v149, v149, v149 row_ror:8 row_mask:0xf bank_mask:0xf
    v_add_f32_dpp v150, v150, v150 row_ror:8 row_mask:0xf bank_mask:0xf
    v_add_f32_dpp v151, v151, v151 row_ror:8 row_mask:0xf bank_mask:0xf
    v_add_f32_dpp v136, v136, v136 row_ror:4 row_mask:0xf bank_mask:0xf
    v_add_f32_dpp v137, v137, v137 row_ror:4 row_mask:0xf bank_mask:0xf
    v_add_f32_dpp v138, v138, v138 row_ror:4 row_mask:0xf bank_mask:0xf
    v_add_f32_dpp v139, v139, v139 row_ror:4 row_mask:0xf bank_mask:0xf
    v_add_f32_dpp v140, v140, v140 row_ror:4 row_mask:0xf bank_mask:0xf
    v_add_f32_dpp v141, v141, v141 row_ror:4 row_mask:0xf bank_mask:0xf
    v_add_f32_dpp v142, v142, v142 row_ror:4 row_mask:0xf bank_mask:0xf
    v_add_f32_dpp v143, v143, v143 row_ror:4 row_mask:0xf bank_mask:0xf
    v_add_f32_dpp v144, v144, v144 row_ror:4 row_mask:0xf bank_mask:0xf
    v_add_f32_dpp v145, v145, v145 row_ror:4 row_mask:0xf bank_mask:0xf
    v_add_f32_dpp v146, v146, v146 row_ror:4 row_mask:0xf bank_mask:0xf
    v_add_f32_dpp v147, v147, v147 row_ror:4 row_mask:0xf bank_mask:0xf
    v_add_f32_dpp v148, v148, v148 row_ror:4 row_mask:0xf bank_mask:0xf
    v_add_f32_dpp v149, v149, v149 row_ror:4 row_mask:0xf bank_mask:0xf
    v_add_f32_dpp v150, v150, v150 row_ror:4 row_mask:0xf bank_mask:0xf
    v_add_f32_dpp v151, v151, v151 row_ror:4 row_mask:0xf bank_mask:0xf
    v_add_f32_dpp v136, v136, v136 row_ror:2 row_mask:0xf bank_mask:0xf
    v_add_f32_dpp v137, v137, v137 row_ror:2 row_mask:0xf bank_mask:0xf
    v_add_f32_dpp v138, v138, v138 row_ror:2 row_mask:0xf bank_mask:0xf
    v_add_f32_dpp v139, v139, v139 row_ror:2 row_mask:0xf bank_mask:0xf
    v_add_f32_dpp v140, v140, v140 row_ror:2 row_mask:0xf bank_mask:0xf
    v_add_f32_dpp v141, v141, v141 row_ror:2 row_mask:0xf bank_mask:0xf
    v_add_f32_dpp v142, v142, v142 row_ror:2 row_mask:0xf bank_mask:0xf
    v_add_f32_dpp v143, v143, v143 row_ror:2 row_mask:0xf bank_mask:0xf
    v_add_f32_dpp v144, v144, v144 row_ror:2 row_mask:0xf bank_mask:0xf
    v_add_f32_dpp v145, v145, v145 row_ror:2 row_mask:0xf bank_mask:0xf
    v_add_f32_dpp v146, v146, v146 row_ror:2 row_mask:0xf bank_mask:0xf
    v_add_f32_dpp v147, v147, v147 row_ror:2 row_mask:0xf bank_mask:0xf
    v_add_f32_dpp v148, v148, v148 row_ror:2 row_mask:0xf bank_mask:0xf
    v_add_f32_dpp v149, v149, v149 row_ror:2 row_mask:0xf bank_mask:0xf
    v_add_f32_dpp v150, v150, v150 row_ror:2 row_mask:0xf bank_mask:0xf
    v_add_f32_dpp v151, v151, v151 row_ror:2 row_mask:0xf bank_mask:0xf
    v_add_f32_dpp v136, v136, v136 row_ror:1 row_mask:0xf bank_mask:0xf
    v_add_f32_dpp v137, v137, v137 row_ror:1 row_mask:0xf bank_mask:0xf
    v_add_f32_dpp v138, v138, v138 row_ror:1 row_mask:0xf bank_mask:0xf
    v_add_f32_dpp v139, v139, v139 row_ror:1 row_mask:0xf bank_mask:0xf
    v_add_f32_dpp v140, v140, v140 row_ror:1 row_mask:0xf bank_mask:0xf
    v_add_f32_dpp v141, v141, v141 row_ror:1 row_mask:0xf bank_mask:0xf
    v_add_f32_dpp v142, v142, v142 row_ror:1 row_mask:0xf bank_mask:0xf
    v_add_f32_dpp v143, v143, v143 row_ror:1 row_mask:0xf bank_mask:0xf
    v_add_f32_dpp v144, v144, v144 row_ror:1 row_mask:0xf bank_mask:0xf
    v_add_f32_dpp v145, v145, v145 row_ror:1 row_mask:0xf bank_mask:0xf
    v_add_f32_dpp v146, v146, v146 row_ror:1 row_mask:0xf bank_mask:0xf
    v_add_f32_dpp v147, v147, v147 row_ror:1 row_mask:0xf bank_mask:0xf
    v_add_f32_dpp v148, v148, v148 row_ror:1 row_mask:0xf bank_mask:0xf
    v_add_f32_dpp v149, v149, v149 row_ror:1 row_mask:0xf bank_mask:0xf
    v_add_f32_dpp v150, v150, v150 row_ror:1 row_mask:0xf bank_mask:0xf
    v_add_f32_dpp v151, v151, v151 row_ror:1 row_mask:0xf bank_mask:0xf
    v_mov_b32 v152, v136
    v_mov_b32 v153, v137
    v_mov_b32 v154, v138
    v_mov_b32 v155, v139
    v_mov_b32 v156, v140
    v_mov_b32 v157, v141
    v_mov_b32 v158, v142
    v_mov_b32 v159, v143
    v_mov_b32 v160, v144
    v_mov_b32 v161, v145
    v_mov_b32 v162, v146
    v_mov_b32 v163, v147
    v_mov_b32 v164, v148
    v_mov_b32 v165, v149
    v_mov_b32 v166, v150
    v_mov_b32 v167, v151
    v_permlane16_swap_b32 v136, v152
    v_permlane16_swap_b32 v137, v153
    v_permlane16_swap_b32 v138, v154
    v_permlane16_swap_b32 v139, v155
    v_permlane16_swap_b32 v140, v156
    v_permlane16_swap_b32 v141, v157
    v_permlane16_swap_b32 v142, v158
    v_permlane16_swap_b32 v143, v159
    v_permlane16_swap_b32 v144, v160
    v_permlane16_swap_b32 v145, v161
    v_permlane16_swap_b32 v146, v162
    v_permlane16_swap_b32 v147, v163
    v_permlane16_swap_b32 v148, v164
    v_permlane16_swap_b32 v149, v165
    v_permlane16_swap_b32 v150, v166
    v_permlane16_swap_b32 v151, v167
    v_add_f32 v136, v136, v152
    v_add_f32 v137, v137, v153
    v_add_f32 v138, v138, v154
    v_add_f32 v139, v139, v155
    v_add_f32 v140, v140, v156
    v_add_f32 v141, v141, v157
    v_add_f32 v142, v142, v158
    v_add_f32 v143, v143, v159
    v_add_f32 v144, v144, v160
    v_add_f32 v145, v145, v161
    v_add_f32 v146, v146, v162
    v_add_f32 v147, v147, v163
    v_add_f32 v148, v148, v164
    v_add_f32 v149, v149, v165
    v_add_f32 v150, v150, v166
    v_add_f32 v151, v151, v167
    v_lshlrev_b32 v200, 4, v3
    s_add_u32 s25, s25, 5376
    v_add_u32 v200, s25, v200
    s_mov_b32 s26, 1
    s_mov_b32 s27, 1
    s_mov_b64 exec, s[26:27]
    ds_write_b128 v200, v[136:139] offset:0
    ds_write_b128 v200, v[140:143] offset:32
    ds_write_b128 v200, v[144:147] offset:64
    ds_write_b128 v200, v[148:151] offset:96
    s_mov_b64 exec, -1
    v_lshlrev_b32 v220, 4, v1
    v_add_u32 v201, s25, v220
    s_waitcnt lgkmcnt(0)
    s_mov_b64 exec, 0xff
    ds_read_b128 v[204:207], v201
    s_add_u32 s12, s82, 0x1400000
    s_addc_u32 s13, s83, 0
    s_mov_b32 s14, 0x10000
    s_mov_b32 s15, 0x00020000
    s_lshl_b32 s24, s45, 13
    s_lshl_b32 s26, s44, 8
    s_add_u32 s24, s24, s26
    s_lshl_b32 s26, s20, 7
    s_add_u32 s24, s24, s26
    s_waitcnt lgkmcnt(0)
    buffer_store_dwordx4 v[204:207], v220, s[12:15], s24 offen sc1
    s_mov_b64 exec, -1
    v_mov_b32 v250, 156160
    s_mov_b32 s31, 0
    s_nop 0
L_lfw_18:
    ds_read_b32 v251, v250
    s_add_u32 s31, s31, 1
    s_waitcnt lgkmcnt(0)
    v_readfirstlane_b32 s24, v251
    s_nop 0
    s_cmp_eq_u32 s24, 1
    s_nop 1
    s_cbranch_scc1 L_lfwd_19
    s_cmp_lt_u32 s31, 16777216
    s_cbranch_scc1 L_lfw_18
L_lfwd_19:
    s_waitcnt vmcnt(0)
    s_add_u32 s4, s82, 0x1f00000
    s_addc_u32 s5, s83, 0
    s_mov_b32 s6, 0x5000
    s_mov_b32 s7, 0x00020000
    v_lshlrev_b32 v250, 3, v1
    v_add_u32 v250, s21, v250
    v_lshlrev_b32 v250, 7, v250
    v_mov_b32 v251, 1
    s_mov_b64 exec, 0xffff
    buffer_atomic_add v251, v250, s[4:7], 0 offen offset:0 sc1
    s_mov_b64 exec, -1
    s_cmp_ge_u32 s62, 22
    s_cbranch_scc1 L_r2D_20
    s_add_u32 m0, s48, 20480
    s_add_u32 s49, s50, 880640
    buffer_load_dwordx4 v175, s[56:59], s49 offen lds
    s_add_u32 m0, s48, 21504
    s_add_u32 s49, s50, 924672
    buffer_load_dwordx4 v175, s[56:59], s49 offen lds
    s_add_u32 m0, s48, 22528
    s_add_u32 s49, s50, 968704
    buffer_load_dwordx4 v175, s[56:59], s49 offen lds
    s_add_u32 m0, s48, 23552
    s_add_u32 s49, s50, 1012736
    buffer_load_dwordx4 v175, s[56:59], s49 offen lds
    s_add_u32 m0, s48, 8192
    s_add_u32 s49, s50, 352256
    buffer_load_dwordx4 v175, s[56:59], s49 offen lds
    s_add_u32 m0, s48, 9216
    s_add_u32 s49, s50, 396288
    buffer_load_dwordx4 v175, s[56:59], s49 offen lds
    s_add_u32 m0, s48, 10240
    s_add_u32 s49, s50, 440320
    buffer_load_dwordx4 v175, s[56:59], s49 offen lds
    s_add_u32 m0, s48, 11264
    s_add_u32 s49, s50, 484352
    buffer_load_dwordx4 v175, s[56:59], s49 offen lds
    s_add_u32 m0, s48, 24576
    s_add_u32 s49, s50, 1056768
    buffer_load_dwordx4 v175, s[56:59], s49 offen lds
    s_add_u32 m0, s48, 25600
    s_add_u32 s49, s50, 1100800
    buffer_load_dwordx4 v175, s[56:59], s49 offen lds
    s_add_u32 m0, s48, 26624
    s_add_u32 s49, s50, 1144832
    buffer_load_dwordx4 v175, s[56:59], s49 offen lds
    s_add_u32 m0, s48, 27648
    s_add_u32 s49, s50, 1188864
    buffer_load_dwordx4 v175, s[56:59], s49 offen lds
    s_add_u32 m0, s48, 12288
    s_add_u32 s49, s50, 528384
    buffer_load_dwordx4 v175, s[56:59], s49 offen lds
    s_add_u32 m0, s48, 13312
    s_add_u32 s49, s50, 572416
    buffer_load_dwordx4 v175, s[56:59], s49 offen lds
    s_add_u32 m0, s48, 14336
    s_add_u32 s49, s50, 616448
    buffer_load_dwordx4 v175, s[56:59], s49 offen lds
    s_add_u32 m0, s48, 15360
    s_add_u32 s49, s50, 660480
    buffer_load_dwordx4 v175, s[56:59], s49 offen lds
    s_add_u32 m0, s48, 28672
    s_add_u32 s49, s50, 1232896
    buffer_load_dwordx4 v175, s[56:59], s49 offen lds
    s_add_u32 m0, s48, 29696
    s_add_u32 s49, s50, 1276928
    buffer_load_dwordx4 v175, s[56:59], s49 offen lds
    s_add_u32 m0, s48, 30720
    s_add_u32 s49, s50, 1320960
    buffer_load_dwordx4 v175, s[56:59], s49 offen lds
    s_add_u32 m0, s48, 31744
    s_add_u32 s49, s50, 1364992
    buffer_load_dwordx4 v175, s[56:59], s49 offen lds
    v_and_b32 v213, 15, v1
    v_lshrrev_b32 v212, 2, v213
    v_lshl_add_u32 v212, v3, 3, v212
    v_lshlrev_b32 v212, 6, v212
    v_and_b32 v213, 3, v213
    v_lshl_add_u32 v212, v213, 3, v212
    v_lshrrev_b32 v213, 4, v1
    v_and_b32 v213, 1, v213
    v_lshl_add_u32 v212, v213, 5, v212
    v_add_u32 v212, s48, v212
    s_waitcnt vmcnt(24)
    ds_read_b64_tr_b16 v[180:181], v212 offset:0
    ds_read_b64_tr_b16 v[182:183], v212 offset:256
    ds_read_b64_tr_b16 v[184:185], v212 offset:16384
    ds_read_b64_tr_b16 v[186:187], v212 offset:16640
    ds_read_b64_tr_b16 v[188:189], v212 offset:1024
    ds_read_b64_tr_b16 v[190:191], v212 offset:1280
    ds_read_b64_tr_b16 v[192:193], v212 offset:17408
    ds_read_b64_tr_b16 v[194:195], v212 offset:17664
    ds_read_b64_tr_b16 v[196:197], v212 offset:2048
    ds_read_b64_tr_b16 v[198:199], v212 offset:2304
    ds_read_b64_tr_b16 v[200:201], v212 offset:18432
    ds_read_b64_tr_b16 v[202:203], v212 offset:18688
    ds_read_b64_tr_b16 v[204:205], v212 offset:3072
    ds_read_b64_tr_b16 v[206:207], v212 offset:3328
    ds_read_b64_tr_b16 v[208:209], v212 offset:19456
    ds_read_b64_tr_b16 v[210:211], v212 offset:19712
    s_waitcnt lgkmcnt(14)
    v_mfma_f32_32x32x16_bf16 v[104:119], a[0:3], v[180:183], 0
    v_mfma_f32_32x32x16_bf16 v[120:135], a[64:67], v[180:183], 0
    s_waitcnt lgkmcnt(12)
    v_mfma_f32_32x32x16_bf16 v[136:151], a[0:3], v[184:187], 0
    v_mfma_f32_32x32x16_bf16 v[152:167], a[64:67], v[184:187], 0
    s_waitcnt lgkmcnt(10)
    v_mfma_f32_32x32x16_bf16 v[104:119], a[4:7], v[188:191], v[104:119]
    v_mfma_f32_32x32x16_bf16 v[120:135], a[68:71], v[188:191], v[120:135]
    s_waitcnt lgkmcnt(8)
    v_mfma_f32_32x32x16_bf16 v[136:151], a[4:7], v[192:195], v[136:151]
    v_mfma_f32_32x32x16_bf16 v[152:167], a[68:71], v[192:195], v[152:167]
    s_waitcnt lgkmcnt(6)
    v_mfma_f32_32x32x16_bf16 v[104:119], a[8:11], v[196:199], v[104:119]
    v_mfma_f32_32x32x16_bf16 v[120:135], a[72:75], v[196:199], v[120:135]
    s_waitcnt lgkmcnt(4)
    v_mfma_f32_32x32x16_bf16 v[136:151], a[8:11], v[200:203], v[136:151]
    v_mfma_f32_32x32x16_bf16 v[152:167], a[72:75], v[200:203], v[152:167]
    s_waitcnt lgkmcnt(2)
    v_mfma_f32_32x32x16_bf16 v[104:119], a[12:15], v[204:207], v[104:119]
    v_mfma_f32_32x32x16_bf16 v[120:135], a[76:79], v[204:207], v[120:135]
    s_waitcnt lgkmcnt(0)
    v_mfma_f32_32x32x16_bf16 v[136:151], a[12:15], v[208:211], v[136:151]
    v_mfma_f32_32x32x16_bf16 v[152:167], a[76:79], v[208:211], v[152:167]
    s_waitcnt vmcnt(16)
    ds_read_b64_tr_b16 v[180:181], v212 offset:4096
    ds_read_b64_tr_b16 v[182:183], v212 offset:4352
    ds_read_b64_tr_b16 v[184:185], v212 offset:20480
    ds_read_b64_tr_b16 v[186:187], v212 offset:20736
    ds_read_b64_tr_b16 v[188:189], v212 offset:5120
    ds_read_b64_tr_b16 v[190:191], v212 offset:5376
    ds_read_b64_tr_b16 v[192:193], v212 offset:21504
    ds_read_b64_tr_b16 v[194:195], v212 offset:21760
    ds_read_b64_tr_b16 v[196:197], v212 offset:6144
    ds_read_b64_tr_b16 v[198:199], v212 offset:6400
    ds_read_b64_tr_b16 v[200:201], v212 offset:22528
    ds_read_b64_tr_b16 v[202:203], v212 offset:22784
    ds_read_b64_tr_b16 v[204:205], v212 offset:7168
    ds_read_b64_tr_b16 v[206:207], v212 offset:7424
    ds_read_b64_tr_b16 v[208:209], v212 offset:23552
    ds_read_b64_tr_b16 v[210:211], v212 offset:23808
    s_waitcnt lgkmcnt(14)
    v_mfma_f32_32x32x16_bf16 v[104:119], a[16:19], v[180:183], v[104:119]
    v_mfma_f32_32x32x16_bf16 v[120:135], a[80:83], v[180:183], v[120:135]
    s_waitcnt lgkmcnt(12)
    v_mfma_f32_32x32x16_bf16 v[136:151], a[16:19], v[184:187], v[136:151]
    v_mfma_f32_32x32x16_bf16 v[152:167], a[80:83], v[184:187], v[152:167]
    s_waitcnt lgkmcnt(10)
    v_mfma_f32_32x32x16_bf16 v[104:119], a[20:23], v[188:191], v[104:119]
    v_mfma_f32_32x32x16_bf16 v[120:135], a[84:87], v[188:191], v[120:135]
    s_waitcnt lgkmcnt(8)
    v_mfma_f32_32x32x16_bf16 v[136:151], a[20:23], v[192:195], v[136:151]
    v_mfma_f32_32x32x16_bf16 v[152:167], a[84:87], v[192:195], v[152:167]
    s_waitcnt lgkmcnt(6)
    v_mfma_f32_32x32x16_bf16 v[104:119], a[24:27], v[196:199], v[104:119]
    v_mfma_f32_32x32x16_bf16 v[120:135], a[88:91], v[196:199], v[120:135]
    s_waitcnt lgkmcnt(4)
    v_mfma_f32_32x32x16_bf16 v[136:151], a[24:27], v[200:203], v[136:151]
    v_mfma_f32_32x32x16_bf16 v[152:167], a[88:91], v[200:203], v[152:167]
    s_waitcnt lgkmcnt(2)
    v_mfma_f32_32x32x16_bf16 v[104:119], a[28:31], v[204:207], v[104:119]
    v_mfma_f32_32x32x16_bf16 v[120:135], a[92:95], v[204:207], v[120:135]
    s_waitcnt lgkmcnt(0)
    v_mfma_f32_32x32x16_bf16 v[136:151], a[28:31], v[208:211], v[136:151]
    v_mfma_f32_32x32x16_bf16 v[152:167], a[92:95], v[208:211], v[152:167]
    s_waitcnt vmcnt(8)
    ds_read_b64_tr_b16 v[180:181], v212 offset:8192
    ds_read_b64_tr_b16 v[182:183], v212 offset:8448
    ds_read_b64_tr_b16 v[184:185], v212 offset:24576
    ds_read_b64_tr_b16 v[186:187], v212 offset:24832
    ds_read_b64_tr_b16 v[188:189], v212 offset:9216
    ds_read_b64_tr_b16 v[190:191], v212 offset:9472
    ds_read_b64_tr_b16 v[192:193], v212 offset:25600
    ds_read_b64_tr_b16 v[194:195], v212 offset:25856
    ds_read_b64_tr_b16 v[196:197], v212 offset:10240
    ds_read_b64_tr_b16 v[198:199], v212 offset:10496
    ds_read_b64_tr_b16 v[200:201], v212 offset:26624
    ds_read_b64_tr_b16 v[202:203], v212 offset:26880
    ds_read_b64_tr_b16 v[204:205], v212 offset:11264
    ds_read_b64_tr_b16 v[206:207], v212 offset:11520
    ds_read_b64_tr_b16 v[208:209], v212 offset:27648
    ds_read_b64_tr_b16 v[210:211], v212 offset:27904
    s_waitcnt lgkmcnt(14)
    v_mfma_f32_32x32x16_bf16 v[104:119], a[32:35], v[180:183], v[104:119]
    v_mfma_f32_32x32x16_bf16 v[120:135], a[96:99], v[180:183], v[120:135]
    s_waitcnt lgkmcnt(12)
    v_mfma_f32_32x32x16_bf16 v[136:151], a[32:35], v[184:187], v[136:151]
    v_mfma_f32_32x32x16_bf16 v[152:167], a[96:99], v[184:187], v[152:167]
    s_waitcnt lgkmcnt(10)
    v_mfma_f32_32x32x16_bf16 v[104:119], a[36:39], v[188:191], v[104:119]
    v_mfma_f32_32x32x16_bf16 v[120:135], a[100:103], v[188:191], v[120:135]
    s_waitcnt lgkmcnt(8)
    v_mfma_f32_32x32x16_bf16 v[136:151], a[36:39], v[192:195], v[136:151]
    v_mfma_f32_32x32x16_bf16 v[152:167], a[100:103], v[192:195], v[152:167]
    s_waitcnt lgkmcnt(6)
    v_mfma_f32_32x32x16_bf16 v[104:119], a[40:43], v[196:199], v[104:119]
    v_mfma_f32_32x32x16_bf16 v[120:135], a[104:107], v[196:199], v[120:135]
    s_waitcnt lgkmcnt(4)
    v_mfma_f32_32x32x16_bf16 v[136:151], a[40:43], v[200:203], v[136:151]
    v_mfma_f32_32x32x16_bf16 v[152:167], a[104:107], v[200:203], v[152:167]
    s_waitcnt lgkmcnt(2)
    v_mfma_f32_32x32x16_bf16 v[104:119], a[44:47], v[204:207], v[104:119]
    v_mfma_f32_32x32x16_bf16 v[120:135], a[108:111], v[204:207], v[120:135]
    s_waitcnt lgkmcnt(0)
    v_mfma_f32_32x32x16_bf16 v[136:151], a[44:47], v[208:211], v[136:151]
    v_mfma_f32_32x32x16_bf16 v[152:167], a[108:111], v[208:211], v[152:167]
    s_waitcnt vmcnt(0)
    ds_read_b64_tr_b16 v[180:181], v212 offset:12288
    ds_read_b64_tr_b16 v[182:183], v212 offset:12544
    ds_read_b64_tr_b16 v[184:185], v212 offset:28672
    ds_read_b64_tr_b16 v[186:187], v212 offset:28928
    ds_read_b64_tr_b16 v[188:189], v212 offset:13312
    ds_read_b64_tr_b16 v[190:191], v212 offset:13568
    ds_read_b64_tr_b16 v[192:193], v212 offset:29696
    ds_read_b64_tr_b16 v[194:195], v212 offset:29952
    ds_read_b64_tr_b16 v[196:197], v212 offset:14336
    ds_read_b64_tr_b16 v[198:199], v212 offset:14592
    ds_read_b64_tr_b16 v[200:201], v212 offset:30720
    ds_read_b64_tr_b16 v[202:203], v212 offset:30976
    ds_read_b64_tr_b16 v[204:205], v212 offset:15360
    ds_read_b64_tr_b16 v[206:207], v212 offset:15616
    ds_read_b64_tr_b16 v[208:209], v212 offset:31744
    ds_read_b64_tr_b16 v[210:211], v212 offset:32000
    s_waitcnt lgkmcnt(14)
    v_mfma_f32_32x32x16_bf16 v[104:119], a[48:51], v[180:183], v[104:119]
    v_mfma_f32_32x32x16_bf16 v[120:135], a[112:115], v[180:183], v[120:135]
    s_waitcnt lgkmcnt(12)
    v_mfma_f32_32x32x16_bf16 v[136:151], a[48:51], v[184:187], v[136:151]
    v_mfma_f32_32x32x16_bf16 v[152:167], a[112:115], v[184:187], v[152:167]
    s_waitcnt lgkmcnt(10)
    v_mfma_f32_32x32x16_bf16 v[104:119], a[52:55], v[188:191], v[104:119]
    v_mfma_f32_32x32x16_bf16 v[120:135], a[116:119], v[188:191], v[120:135]
    s_waitcnt lgkmcnt(8)
    v_mfma_f32_32x32x16_bf16 v[136:151], a[52:55], v[192:195], v[136:151]
    v_mfma_f32_32x32x16_bf16 v[152:167], a[116:119], v[192:195], v[152:167]
    s_waitcnt lgkmcnt(6)
    v_mfma_f32_32x32x16_bf16 v[104:119], a[56:59], v[196:199], v[104:119]
    v_mfma_f32_32x32x16_bf16 v[120:135], a[120:123], v[196:199], v[120:135]
    s_waitcnt lgkmcnt(4)
    v_mfma_f32_32x32x16_bf16 v[136:151], a[56:59], v[200:203], v[136:151]
    v_mfma_f32_32x32x16_bf16 v[152:167], a[120:123], v[200:203], v[152:167]
    s_waitcnt lgkmcnt(2)
    v_mfma_f32_32x32x16_bf16 v[104:119], a[60:63], v[204:207], v[104:119]
    v_mfma_f32_32x32x16_bf16 v[120:135], a[124:127], v[204:207], v[120:135]
    s_waitcnt lgkmcnt(0)
    v_mfma_f32_32x32x16_bf16 v[136:151], a[60:63], v[208:211], v[136:151]
    v_mfma_f32_32x32x16_bf16 v[152:167], a[124:127], v[208:211], v[152:167]
    s_nop 10
    v_add_f32 v104, v104, v136
    v_add_f32 v105, v105, v137
    v_sub_f32 v106, v106, v138
    v_sub_f32 v107, v107, v139
    v_add_f32 v108, v108, v140
    v_add_f32 v109, v109, v141
    v_sub_f32 v110, v110, v142
    v_sub_f32 v111, v111, v143
    v_add_f32 v112, v112, v144
    v_add_f32 v113, v113, v145
    v_sub_f32 v114, v114, v146
    v_sub_f32 v115, v115, v147
    v_add_f32 v116, v116, v148
    v_add_f32 v117, v117, v149
    v_sub_f32 v118, v118, v150
    v_sub_f32 v119, v119, v151
    v_add_f32 v120, v120, v152
    v_add_f32 v121, v121, v153
    v_sub_f32 v122, v122, v154
    v_sub_f32 v123, v123, v155
    v_add_f32 v124, v124, v156
    v_add_f32 v125, v125, v157
    v_sub_f32 v126, v126, v158
    v_sub_f32 v127, v127, v159
    v_add_f32 v128, v128, v160
    v_add_f32 v129, v129, v161
    v_sub_f32 v130, v130, v162
    v_sub_f32 v131, v131, v163
    v_add_f32 v132, v132, v164
    v_add_f32 v133, v133, v165
    v_sub_f32 v134, v134, v166
    v_sub_f32 v135, v135, v167
    v_mov_b32 v178, 0x3d800000
    v_mov_b32 v179, 0x3d800000
    v_cmp_eq_u32 vcc, 0, v3
    s_cmp_eq_u32 s45, 0
    s_cselect_b64 s[26:27], vcc, 0
    v_mov_b32 v180, 0
    v_cndmask_b32 v178, v178, v180, s[26:27]
    v_mov_b32 v180, 0x3d3504f3
    v_cndmask_b32 v179, v179, v180, s[26:27]
    v_mul_f32 v104, v104, v178
    v_mul_f32 v105, v105, v179
    v_mul_f32 v106, 0x3d800000, v106
    v_mul_f32 v107, 0x3d800000, v107
    v_mul_f32 v108, 0x3d800000, v108
    v_mul_f32 v109, 0x3d800000, v109
    v_mul_f32 v110, 0x3d800000, v110
    v_mul_f32 v111, 0x3d800000, v111
    v_mul_f32 v112, 0x3d800000, v112
    v_mul_f32 v113, 0x3d800000, v113
    v_mul_f32 v114, 0x3d800000, v114
    v_mul_f32 v115, 0x3d800000, v115
    v_mul_f32 v116, 0x3d800000, v116
    v_mul_f32 v117, 0x3d800000, v117
    v_mul_f32 v118, 0x3d800000, v118
    v_mul_f32 v119, 0x3d800000, v119
    v_mul_f32 v120, 0x3d800000, v120
    v_mul_f32 v121, 0x3d800000, v121
    v_mul_f32 v122, 0x3d800000, v122
    v_mul_f32 v123, 0x3d800000, v123
    v_mul_f32 v124, 0x3d800000, v124
    v_mul_f32 v125, 0x3d800000, v125
    v_mul_f32 v126, 0x3d800000, v126
    v_mul_f32 v127, 0x3d800000, v127
    v_mul_f32 v128, 0x3d800000, v128
    v_mul_f32 v129, 0x3d800000, v129
    v_mul_f32 v130, 0x3d800000, v130
    v_mul_f32 v131, 0x3d800000, v131
    v_mul_f32 v132, 0x3d800000, v132
    v_mul_f32 v133, 0x3d800000, v133
    v_mul_f32 v134, 0x3d800000, v134
    v_mul_f32 v135, 0x3d800000, v135
    v_cvt_pk_bf16_f32 v136, v104, v105
    v_cvt_pk_bf16_f32 v137, v106, v107
    v_cvt_pk_bf16_f32 v138, v108, v109
    v_cvt_pk_bf16_f32 v139, v110, v111
    v_cvt_pk_bf16_f32 v140, v112, v113
    v_cvt_pk_bf16_f32 v141, v114, v115
    v_cvt_pk_bf16_f32 v142, v116, v117
    v_cvt_pk_bf16_f32 v143, v118, v119
    v_cvt_pk_bf16_f32 v144, v120, v121
    v_cvt_pk_bf16_f32 v145, v122, v123
    v_cvt_pk_bf16_f32 v146, v124, v125
    v_cvt_pk_bf16_f32 v147, v126, v127
    v_cvt_pk_bf16_f32 v148, v128, v129
    v_cvt_pk_bf16_f32 v149, v130, v131
    v_cvt_pk_bf16_f32 v150, v132, v133
    v_cvt_pk_bf16_f32 v151, v134, v135
    s_add_u32 s8, s82, 0x1500000
    s_addc_u32 s9, s83, 0
    s_mov_b32 s10, 0x2b0000
    s_mov_b32 s11, 0x00020000
    v_lshlrev_b32 v180, 4, v1
    s_lshl_b32 s24, s46, 15
    s_lshl_b32 s25, s45, 12
    s_add_u32 s24, s24, s25
    buffer_store_dwordx4 v[136:139], v180, s[8:11], s24 offen offset:0 sc1
    buffer_store_dwordx4 v[140:143], v180, s[8:11], s24 offen offset:1024 sc1
    buffer_store_dwordx4 v[144:147], v180, s[8:11], s24 offen offset:2048 sc1
    buffer_store_dwordx4 v[148:151], v180, s[8:11], s24 offen offset:3072 sc1
    s_nop 0
    s_branch L_r2E_21
L_r2D_20:
    buffer_load_dwordx4 a[208:211], v177, s[52:55], s47 offen offset:640
    buffer_load_dwordx4 a[212:215], v177, s[52:55], s47 offen offset:672
    buffer_load_dwordx4 a[216:219], v177, s[52:55], s47 offen offset:704
    buffer_load_dwordx4 a[220:223], v177, s[52:55], s47 offen offset:736
    buffer_load_dwordx4 a[160:163], v177, s[52:55], s47 offen offset:256
    buffer_load_dwordx4 a[164:167], v177, s[52:55], s47 offen offset:288
    buffer_load_dwordx4 a[168:171], v177, s[52:55], s47 offen offset:320
    buffer_load_dwordx4 a[172:175], v177, s[52:55], s47 offen offset:352
    buffer_load_dwordx4 a[224:227], v177, s[52:55], s47 offen offset:768
    buffer_load_dwordx4 a[228:231], v177, s[52:55], s47 offen offset:800
    buffer_load_dwordx4 a[232:235], v177, s[52:55], s47 offen offset:832
    buffer_load_dwordx4 a[236:239], v177, s[52:55], s47 offen offset:864
    buffer_load_dwordx4 a[176:179], v177, s[52:55], s47 offen offset:384
    buffer_load_dwordx4 a[180:183], v177, s[52:55], s47 offen offset:416
    buffer_load_dwordx4 a[184:187], v177, s[52:55], s47 offen offset:448
    buffer_load_dwordx4 a[188:191], v177, s[52:55], s47 offen offset:480
    buffer_load_dwordx4 a[240:243], v177, s[52:55], s47 offen offset:896
    buffer_load_dwordx4 a[244:247], v177, s[52:55], s47 offen offset:928
    buffer_load_dwordx4 a[248:251], v177, s[52:55], s47 offen offset:960
    buffer_load_dwordx4 a[252:255], v177, s[52:55], s47 offen offset:992
    s_waitcnt vmcnt(24)
    v_mfma_f32_32x32x16_bf16 v[104:119], a[128:131], a[0:3], 0
    v_mfma_f32_32x32x16_bf16 v[120:135], a[128:131], a[64:67], 0
    v_mfma_f32_32x32x16_bf16 v[136:151], a[192:195], a[0:3], 0
    v_mfma_f32_32x32x16_bf16 v[152:167], a[192:195], a[64:67], 0
    v_mfma_f32_32x32x16_bf16 v[104:119], a[132:135], a[4:7], v[104:119]
    v_mfma_f32_32x32x16_bf16 v[120:135], a[132:135], a[68:71], v[120:135]
    v_mfma_f32_32x32x16_bf16 v[136:151], a[196:199], a[4:7], v[136:151]
    v_mfma_f32_32x32x16_bf16 v[152:167], a[196:199], a[68:71], v[152:167]
    v_mfma_f32_32x32x16_bf16 v[104:119], a[136:139], a[8:11], v[104:119]
    v_mfma_f32_32x32x16_bf16 v[120:135], a[136:139], a[72:75], v[120:135]
    v_mfma_f32_32x32x16_bf16 v[136:151], a[200:203], a[8:11], v[136:151]
    v_mfma_f32_32x32x16_bf16 v[152:167], a[200:203], a[72:75], v[152:167]
    v_mfma_f32_32x32x16_bf16 v[104:119], a[140:143], a[12:15], v[104:119]
    v_mfma_f32_32x32x16_bf16 v[120:135], a[140:143], a[76:79], v[120:135]
    v_mfma_f32_32x32x16_bf16 v[136:151], a[204:207], a[12:15], v[136:151]
    v_mfma_f32_32x32x16_bf16 v[152:167], a[204:207], a[76:79], v[152:167]
    s_waitcnt vmcnt(16)
    v_mfma_f32_32x32x16_bf16 v[104:119], a[144:147], a[16:19], v[104:119]
    v_mfma_f32_32x32x16_bf16 v[120:135], a[144:147], a[80:83], v[120:135]
    v_mfma_f32_32x32x16_bf16 v[136:151], a[208:211], a[16:19], v[136:151]
    v_mfma_f32_32x32x16_bf16 v[152:167], a[208:211], a[80:83], v[152:167]
    v_mfma_f32_32x32x16_bf16 v[104:119], a[148:151], a[20:23], v[104:119]
    v_mfma_f32_32x32x16_bf16 v[120:135], a[148:151], a[84:87], v[120:135]
    v_mfma_f32_32x32x16_bf16 v[136:151], a[212:215], a[20:23], v[136:151]
    v_mfma_f32_32x32x16_bf16 v[152:167], a[212:215], a[84:87], v[152:167]
    v_mfma_f32_32x32x16_bf16 v[104:119], a[152:155], a[24:27], v[104:119]
    v_mfma_f32_32x32x16_bf16 v[120:135], a[152:155], a[88:91], v[120:135]
    v_mfma_f32_32x32x16_bf16 v[136:151], a[216:219], a[24:27], v[136:151]
    v_mfma_f32_32x32x16_bf16 v[152:167], a[216:219], a[88:91], v[152:167]
    v_mfma_f32_32x32x16_bf16 v[104:119], a[156:159], a[28:31], v[104:119]
    v_mfma_f32_32x32x16_bf16 v[120:135], a[156:159], a[92:95], v[120:135]
    v_mfma_f32_32x32x16_bf16 v[136:151], a[220:223], a[28:31], v[136:151]
    v_mfma_f32_32x32x16_bf16 v[152:167], a[220:223], a[92:95], v[152:167]
    s_waitcnt vmcnt(8)
    v_mfma_f32_32x32x16_bf16 v[104:119], a[160:163], a[32:35], v[104:119]
    v_mfma_f32_32x32x16_bf16 v[120:135], a[160:163], a[96:99], v[120:135]
    v_mfma_f32_32x32x16_bf16 v[136:151], a[224:227], a[32:35], v[136:151]
    v_mfma_f32_32x32x16_bf16 v[152:167], a[224:227], a[96:99], v[152:167]
    v_mfma_f32_32x32x16_bf16 v[104:119], a[164:167], a[36:39], v[104:119]
    v_mfma_f32_32x32x16_bf16 v[120:135], a[164:167], a[100:103], v[120:135]
    v_mfma_f32_32x32x16_bf16 v[136:151], a[228:231], a[36:39], v[136:151]
    v_mfma_f32_32x32x16_bf16 v[152:167], a[228:231], a[100:103], v[152:167]
    v_mfma_f32_32x32x16_bf16 v[104:119], a[168:171], a[40:43], v[104:119]
    v_mfma_f32_32x32x16_bf16 v[120:135], a[168:171], a[104:107], v[120:135]
    v_mfma_f32_32x32x16_bf16 v[136:151], a[232:235], a[40:43], v[136:151]
    v_mfma_f32_32x32x16_bf16 v[152:167], a[232:235], a[104:107], v[152:167]
    v_mfma_f32_32x32x16_bf16 v[104:119], a[172:175], a[44:47], v[104:119]
    v_mfma_f32_32x32x16_bf16 v[120:135], a[172:175], a[108:111], v[120:135]
    v_mfma_f32_32x32x16_bf16 v[136:151], a[236:239], a[44:47], v[136:151]
    v_mfma_f32_32x32x16_bf16 v[152:167], a[236:239], a[108:111], v[152:167]
    s_waitcnt vmcnt(0)
    v_mfma_f32_32x32x16_bf16 v[104:119], a[176:179], a[48:51], v[104:119]
    v_mfma_f32_32x32x16_bf16 v[120:135], a[176:179], a[112:115], v[120:135]
    v_mfma_f32_32x32x16_bf16 v[136:151], a[240:243], a[48:51], v[136:151]
    v_mfma_f32_32x32x16_bf16 v[152:167], a[240:243], a[112:115], v[152:167]
    v_mfma_f32_32x32x16_bf16 v[104:119], a[180:183], a[52:55], v[104:119]
    v_mfma_f32_32x32x16_bf16 v[120:135], a[180:183], a[116:119], v[120:135]
    v_mfma_f32_32x32x16_bf16 v[136:151], a[244:247], a[52:55], v[136:151]
    v_mfma_f32_32x32x16_bf16 v[152:167], a[244:247], a[116:119], v[152:167]
    v_mfma_f32_32x32x16_bf16 v[104:119], a[184:187], a[56:59], v[104:119]
    v_mfma_f32_32x32x16_bf16 v[120:135], a[184:187], a[120:123], v[120:135]
    v_mfma_f32_32x32x16_bf16 v[136:151], a[248:251], a[56:59], v[136:151]
    v_mfma_f32_32x32x16_bf16 v[152:167], a[248:251], a[120:123], v[152:167]
    v_mfma_f32_32x32x16_bf16 v[104:119], a[188:191], a[60:63], v[104:119]
    v_mfma_f32_32x32x16_bf16 v[120:135], a[188:191], a[124:127], v[120:135]
    v_mfma_f32_32x32x16_bf16 v[136:151], a[252:255], a[60:63], v[136:151]
    v_mfma_f32_32x32x16_bf16 v[152:167], a[252:255], a[124:127], v[152:167]
    v_lshlrev_b32 v177, 30, v2
    v_and_b32 v177, 0x80000000, v177
    v_or_b32 v175, 0x3f800000, v177
    v_cmp_gt_u32 vcc, 2, v2
    s_cmp_eq_u32 s45, 0
    s_cselect_b64 s[26:27], vcc, 0
    v_mov_b32 v176, 0x3d800000
    v_mov_b32 v177, 0x3d3504f3
    v_cndmask_b32 v176, v176, v177, s[26:27]
    s_nop 1
    v_fma_f32 v104, v136, v175, v104
    v_fma_f32 v105, v137, v175, v105
    v_fma_f32 v106, v138, v175, v106
    v_fma_f32 v107, v139, v175, v107
    v_fma_f32 v108, v140, v175, v108
    v_fma_f32 v109, v141, v175, v109
    v_fma_f32 v110, v142, v175, v110
    v_fma_f32 v111, v143, v175, v111
    v_fma_f32 v112, v144, v175, v112
    v_fma_f32 v113, v145, v175, v113
    v_fma_f32 v114, v146, v175, v114
    v_fma_f32 v115, v147, v175, v115
    v_fma_f32 v116, v148, v175, v116
    v_fma_f32 v117, v149, v175, v117
    v_fma_f32 v118, v150, v175, v118
    v_fma_f32 v119, v151, v175, v119
    v_mul_f32 v104, v104, v176
    v_mul_f32 v105, v105, v176
    v_mul_f32 v106, v106, v176
    v_mul_f32 v107, v107, v176
    v_mul_f32 v108, v108, v176
    v_mul_f32 v109, v109, v176
    v_mul_f32 v110, v110, v176
    v_mul_f32 v111, v111, v176
    v_mul_f32 v112, v112, v176
    v_mul_f32 v113, v113, v176
    v_mul_f32 v114, v114, v176
    v_mul_f32 v115, v115, v176
    v_mul_f32 v116, v116, v176
    v_mul_f32 v117, v117, v176
    v_mul_f32 v118, v118, v176
    v_mul_f32 v119, v119, v176
    v_fma_f32 v120, v152, v175, v120
    v_fma_f32 v121, v153, v175, v121
    v_fma_f32 v122, v154, v175, v122
    v_fma_f32 v123, v155, v175, v123
    v_fma_f32 v124, v156, v175, v124
    v_fma_f32 v125, v157, v175, v125
    v_fma_f32 v126, v158, v175, v126
    v_fma_f32 v127, v159, v175, v127
    v_fma_f32 v128, v160, v175, v128
    v_fma_f32 v129, v161, v175, v129
    v_fma_f32 v130, v162, v175, v130
    v_fma_f32 v131, v163, v175, v131
    v_fma_f32 v132, v164, v175, v132
    v_fma_f32 v133, v165, v175, v133
    v_fma_f32 v134, v166, v175, v134
    v_fma_f32 v135, v167, v175, v135
    v_mul_f32 v120, 0x3d800000, v120
    v_mul_f32 v121, 0x3d800000, v121
    v_mul_f32 v122, 0x3d800000, v122
    v_mul_f32 v123, 0x3d800000, v123
    v_mul_f32 v124, 0x3d800000, v124
    v_mul_f32 v125, 0x3d800000, v125
    v_mul_f32 v126, 0x3d800000, v126
    v_mul_f32 v127, 0x3d800000, v127
    v_mul_f32 v128, 0x3d800000, v128
    v_mul_f32 v129, 0x3d800000, v129
    v_mul_f32 v130, 0x3d800000, v130
    v_mul_f32 v131, 0x3d800000, v131
    v_mul_f32 v132, 0x3d800000, v132
    v_mul_f32 v133, 0x3d800000, v133
    v_mul_f32 v134, 0x3d800000, v134
    v_mul_f32 v135, 0x3d800000, v135
    v_cvt_pk_bf16_f32 v136, v104, v105
    v_cvt_pk_bf16_f32 v137, v106, v107
    v_cvt_pk_bf16_f32 v138, v108, v109
    v_cvt_pk_bf16_f32 v139, v110, v111
    v_cvt_pk_bf16_f32 v140, v112, v113
    v_cvt_pk_bf16_f32 v141, v114, v115
    v_cvt_pk_bf16_f32 v142, v116, v117
    v_cvt_pk_bf16_f32 v143, v118, v119
    v_cvt_pk_bf16_f32 v144, v120, v121
    v_cvt_pk_bf16_f32 v145, v122, v123
    v_cvt_pk_bf16_f32 v146, v124, v125
    v_cvt_pk_bf16_f32 v147, v126, v127
    v_cvt_pk_bf16_f32 v148, v128, v129
    v_cvt_pk_bf16_f32 v149, v130, v131
    v_cvt_pk_bf16_f32 v150, v132, v133
    v_cvt_pk_bf16_f32 v151, v134, v135
    s_add_u32 s8, s82, 0x1800000
    s_addc_u32 s9, s83, 0
    s_mov_b32 s10, 0x158000
    s_mov_b32 s11, 0x00020000
    v_lshlrev_b32 v178, 4, v1
    s_mul_i32 s24, s45, 176128
    s_lshl_b32 s25, s46, 11
    s_add_u32 s24, s24, s25
    s_add_u32 s25, s24, 0
    buffer_store_dwordx4 v[136:139], v178, s[8:11], s25 offen offset:0 sc1
    buffer_store_dwordx4 v[140:143], v178, s[8:11], s25 offen offset:1024 sc1
    s_add_u32 s25, s24, 88064
    buffer_store_dwordx4 v[144:147], v178, s[8:11], s25 offen offset:0 sc1
    buffer_store_dwordx4 v[148:151], v178, s[8:11], s25 offen offset:1024 sc1
    s_nop 1
L_r2E_21:
    s_branch L_rolej2_11
L_roleW2_10:
    s_mov_b32 s91, 0
    s_cmp_lg_u32 s44, 0
    s_cbranch_scc1 L_r2x0_22
    s_cmp_lg_u32 s20, 2
    s_cbranch_scc1 L_r2x0_22
    s_mov_b32 s91, 1
    s_mov_b32 s47, 1376256
    s_mov_b32 s52, s76
    s_mov_b32 s53, s77
    s_mov_b32 s54, 0x158000
    s_mov_b32 s55, 0x00020000
    v_lshlrev_b32 v175, 10, v2
    v_lshl_add_u32 v175, v3, 4, v175
    buffer_load_dwordx4 a[128:131], v175, s[52:55], s47 offen offset:0
    buffer_load_dwordx4 a[132:135], v175, s[52:55], s47 offen offset:32
    buffer_load_dwordx4 a[136:139], v175, s[52:55], s47 offen offset:64
    buffer_load_dwordx4 a[140:143], v175, s[52:55], s47 offen offset:96
    buffer_load_dwordx4 a[192:195], v175, s[52:55], s47 offen offset:512
    buffer_load_dwordx4 a[196:199], v175, s[52:55], s47 offen offset:544
    buffer_load_dwordx4 a[200:203], v175, s[52:55], s47 offen offset:576
    buffer_load_dwordx4 a[204:207], v175, s[52:55], s47 offen offset:608
    buffer_load_dwordx4 a[144:147], v175, s[52:55], s47 offen offset:128
    buffer_load_dwordx4 a[148:151], v175, s[52:55], s47 offen offset:160
    buffer_load_dwordx4 a[152:155], v175, s[52:55], s47 offen offset:192
    buffer_load_dwordx4 a[156:159], v175, s[52:55], s47 offen offset:224
    buffer_load_dwordx4 a[208:211], v175, s[52:55], s47 offen offset:640
    buffer_load_dwordx4 a[212:215], v175, s[52:55], s47 offen offset:672
    buffer_load_dwordx4 a[216:219], v175, s[52:55], s47 offen offset:704
    buffer_load_dwordx4 a[220:223], v175, s[52:55], s47 offen offset:736
    buffer_load_dwordx4 a[160:163], v175, s[52:55], s47 offen offset:256
    buffer_load_dwordx4 a[164:167], v175, s[52:55], s47 offen offset:288
    buffer_load_dwordx4 a[168:171], v175, s[52:55], s47 offen offset:320
    buffer_load_dwordx4 a[172:175], v175, s[52:55], s47 offen offset:352
    buffer_load_dwordx4 a[224:227], v175, s[52:55], s47 offen offset:768
    buffer_load_dwordx4 a[228:231], v175, s[52:55], s47 offen offset:800
    buffer_load_dwordx4 a[232:235], v175, s[52:55], s47 offen offset:832
    buffer_load_dwordx4 a[236:239], v175, s[52:55], s47 offen offset:864
    buffer_load_dwordx4 a[176:179], v175, s[52:55], s47 offen offset:384
    buffer_load_dwordx4 a[180:183], v175, s[52:55], s47 offen offset:416
    buffer_load_dwordx4 a[184:187], v175, s[52:55], s47 offen offset:448
    buffer_load_dwordx4 a[188:191], v175, s[52:55], s47 offen offset:480
    buffer_load_dwordx4 a[240:243], v175, s[52:55], s47 offen offset:896
    buffer_load_dwordx4 a[244:247], v175, s[52:55], s47 offen offset:928
    buffer_load_dwordx4 a[248:251], v175, s[52:55], s47 offen offset:960
    buffer_load_dwordx4 a[252:255], v175, s[52:55], s47 offen offset:992
L_r2x0_22:
    s_mov_b32 s52, s66
    s_mov_b32 s53, s67
    s_mov_b32 s54, 0x101000
    s_mov_b32 s55, 0x00020000
    s_mov_b32 s56, s68
    s_mov_b32 s57, s69
    s_mov_b32 s58, 0x101000
    s_mov_b32 s59, 0x00020000
    s_and_b32 s49, s2, 3
    s_lshl_b32 s49, s49, 6
    s_sub_u32 s51, s20, 2
    s_lshl_b32 s51, s51, 5
    s_add_u32 s49, s49, s51
    v_add_u32 v174, s49, v2
    v_cmp_eq_u32 vcc, 0, v174
    v_mov_b32 v173, 256
    s_nop 0
    v_cndmask_b32 v173, v174, v173, vcc
    v_lshlrev_b32 v173, 1, v173
    v_mul_u32_u24 v174, 263168, v3
    v_add_u32 v173, v173, v174
    s_lshr_b32 s50, s2, 2
    s_mul_i32 s50, s50, 514
    s_add_u32 s49, s50, 0
    buffer_load_ushort v176, v173, s[52:55], s49 offen
    buffer_load_ushort v184, v173, s[56:59], s49 offen
    s_add_u32 s49, s50, 32896
    buffer_load_ushort v177, v173, s[52:55], s49 offen
    buffer_load_ushort v185, v173, s[56:59], s49 offen
    s_add_u32 s49, s50, 65792
    buffer_load_ushort v178, v173, s[52:55], s49 offen
    buffer_load_ushort v186, v173, s[56:59], s49 offen
    s_add_u32 s49, s50, 98688
    buffer_load_ushort v179, v173, s[52:55], s49 offen
    buffer_load_ushort v187, v173, s[56:59], s49 offen
    s_add_u32 s49, s50, 526336
    buffer_load_ushort v180, v173, s[52:55], s49 offen
    buffer_load_ushort v188, v173, s[56:59], s49 offen
    s_add_u32 s49, s50, 559232
    buffer_load_ushort v181, v173, s[52:55], s49 offen
    buffer_load_ushort v189, v173, s[56:59], s49 offen
    s_add_u32 s49, s50, 592128
    buffer_load_ushort v182, v173, s[52:55], s49 offen
    buffer_load_ushort v190, v173, s[56:59], s49 offen
    s_add_u32 s49, s50, 625024
    buffer_load_ushort v183, v173, s[52:55], s49 offen
    buffer_load_ushort v191, v173, s[56:59], s49 offen
    s_add_u32 s49, s50, 131584
    buffer_load_ushort v192, v173, s[52:55], s49 offen
    buffer_load_ushort v200, v173, s[56:59], s49 offen
    s_add_u32 s49, s50, 164480
    buffer_load_ushort v193, v173, s[52:55], s49 offen
    buffer_load_ushort v201, v173, s[56:59], s49 offen
    s_add_u32 s49, s50, 197376
    buffer_load_ushort v194, v173, s[52:55], s49 offen
    buffer_load_ushort v202, v173, s[56:59], s49 offen
    s_add_u32 s49, s50, 230272
    buffer_load_ushort v195, v173, s[52:55], s49 offen
    buffer_load_ushort v203, v173, s[56:59], s49 offen
    s_add_u32 s49, s50, 657920
    buffer_load_ushort v196, v173, s[52:55], s49 offen
    buffer_load_ushort v204, v173, s[56:59], s49 offen
    s_add_u32 s49, s50, 690816
    buffer_load_ushort v197, v173, s[52:55], s49 offen
    buffer_load_ushort v205, v173, s[56:59], s49 offen
    s_add_u32 s49, s50, 723712
    buffer_load_ushort v198, v173, s[52:55], s49 offen
    buffer_load_ushort v206, v173, s[56:59], s49 offen
    s_add_u32 s49, s50, 756608
    buffer_load_ushort v199, v173, s[52:55], s49 offen
    buffer_load_ushort v207, v173, s[56:59], s49 offen
    s_sub_u32 s24, s20, 1
    s_lshl_b32 s48, s24, 15
    s_and_b32 s49, s46, 1
    s_cmp_eq_u32 s49, 0
    s_cselect_b32 s56, s72, s74
    s_cselect_b32 s57, s73, s75
    s_mov_b32 s58, 0x158000
    s_mov_b32 s59, 0x00020000
    v_lshrrev_b32 v209, 2, v1
    v_mul_u32_u24 v208, 2752, v209
    v_and_b32 v209, 3, v1
    v_lshl_add_u32 v208, v209, 4, v208
    s_lshr_b32 s50, s46, 1
    s_lshl_b32 s50, s50, 6
    s_add_u32 m0, s48, 0
    s_add_u32 s49, s50, 0
    buffer_load_dwordx4 v208, s[56:59], s49 offen lds
    s_add_u32 m0, s48, 1024
    s_add_u32 s49, s50, 44032
    buffer_load_dwordx4 v208, s[56:59], s49 offen lds
    s_add_u32 m0, s48, 2048
    s_add_u32 s49, s50, 88064
    buffer_load_dwordx4 v208, s[56:59], s49 offen lds
    s_add_u32 m0, s48, 3072
    s_add_u32 s49, s50, 132096
    buffer_load_dwordx4 v208, s[56:59], s49 offen lds
    s_add_u32 m0, s48, 16384
    s_add_u32 s49, s50, 704512
    buffer_load_dwordx4 v208, s[56:59], s49 offen lds
    s_add_u32 m0, s48, 17408
    s_add_u32 s49, s50, 748544
    buffer_load_dwordx4 v208, s[56:59], s49 offen lds
    s_add_u32 m0, s48, 18432
    s_add_u32 s49, s50, 792576
    buffer_load_dwordx4 v208, s[56:59], s49 offen lds
    s_add_u32 m0, s48, 19456
    s_add_u32 s49, s50, 836608
    buffer_load_dwordx4 v208, s[56:59], s49 offen lds
    s_add_u32 m0, s48, 4096
    s_add_u32 s49, s50, 176128
    buffer_load_dwordx4 v208, s[56:59], s49 offen lds
    s_add_u32 m0, s48, 5120
    s_add_u32 s49, s50, 220160
    buffer_load_dwordx4 v208, s[56:59], s49 offen lds
    s_add_u32 m0, s48, 6144
    s_add_u32 s49, s50, 264192
    buffer_load_dwordx4 v208, s[56:59], s49 offen lds
    s_add_u32 m0, s48, 7168
    s_add_u32 s49, s50, 308224
    buffer_load_dwordx4 v208, s[56:59], s49 offen lds
    s_add_u32 m0, s48, 20480
    s_add_u32 s49, s50, 880640
    buffer_load_dwordx4 v208, s[56:59], s49 offen lds
    s_add_u32 m0, s48, 21504
    s_add_u32 s49, s50, 924672
    buffer_load_dwordx4 v208, s[56:59], s49 offen lds
    s_add_u32 m0, s48, 22528
    s_add_u32 s49, s50, 968704
    buffer_load_dwordx4 v208, s[56:59], s49 offen lds
    s_add_u32 m0, s48, 23552
    s_add_u32 s49, s50, 1012736
    buffer_load_dwordx4 v208, s[56:59], s49 offen lds
    v_and_b32 v4, 15, v1
    v_lshrrev_b32 v5, 4, v1
    v_cvt_f32_u32 v107, v4
    v_cvt_f32_u32 v106, v5
    s_lshl_b32 s24, s20, 4
    v_cvt_f32_u32 v6, s24
    v_add_f32 v104, v6, v107
    v_mul_f32 v105, v104, v106
    v_mul_f32 v105, 0x3e000000, v105
    v_fmamk_f32 v88, v104, 0x00000000, v105
    v_fmamk_f32 v89, v104, 0x3c800000, v105
    v_fmamk_f32 v90, v104, 0x3d000000, v105
    v_fmamk_f32 v91, v104, 0x3d400000, v105
    v_fmamk_f32 v92, v104, 0x3d800000, v105
    v_fmamk_f32 v93, v104, 0x3da00000, v105
    v_fmamk_f32 v94, v104, 0x3dc00000, v105
    v_fmamk_f32 v95, v104, 0x3de00000, v105
    v_cos_f32 v96, v88
    v_cos_f32 v97, v89
    v_cos_f32 v98, v90
    v_cos_f32 v99, v91
    v_cos_f32 v100, v92
    v_cos_f32 v101, v93
    v_cos_f32 v102, v94
    v_cos_f32 v103, v95
    v_sin_f32 v88, v88
    v_sin_f32 v89, v89
    v_sin_f32 v90, v90
    v_sin_f32 v91, v91
    v_sin_f32 v92, v92
    v_sin_f32 v93, v93
    v_sin_f32 v94, v94
    v_sin_f32 v95, v95
    v_cvt_pk_bf16_f32 v8, v96, v97
    v_cvt_pk_bf16_f32 v9, v98, v99
    v_cvt_pk_bf16_f32 v10, v100, v101
    v_cvt_pk_bf16_f32 v11, v102, v103
    v_cvt_pk_bf16_f32 v16, v88, v89
    v_cvt_pk_bf16_f32 v17, v90, v91
    v_cvt_pk_bf16_f32 v18, v92, v93
    v_cvt_pk_bf16_f32 v19, v94, v95
    v_xor_b32 v24, 0x80008000, v16
    v_xor_b32 v25, 0x80008000, v17
    v_xor_b32 v26, 0x80008000, v18
    v_xor_b32 v27, 0x80008000, v19
    v_fmamk_f32 v88, v104, 0x3f000000, v105
    v_fmamk_f32 v89, v104, 0x3f040000, v105
    v_fmamk_f32 v90, v104, 0x3f080000, v105
    v_fmamk_f32 v91, v104, 0x3f0c0000, v105
    v_fmamk_f32 v92, v104, 0x3f100000, v105
    v_fmamk_f32 v93, v104, 0x3f140000, v105
    v_fmamk_f32 v94, v104, 0x3f180000, v105
    v_fmamk_f32 v95, v104, 0x3f1c0000, v105
    v_cos_f32 v96, v88
    v_cos_f32 v97, v89
    v_cos_f32 v98, v90
    v_cos_f32 v99, v91
    v_cos_f32 v100, v92
    v_cos_f32 v101, v93
    v_cos_f32 v102, v94
    v_cos_f32 v103, v95
    v_sin_f32 v88, v88
    v_sin_f32 v89, v89
    v_sin_f32 v90, v90
    v_sin_f32 v91, v91
    v_sin_f32 v92, v92
    v_sin_f32 v93, v93
    v_sin_f32 v94, v94
    v_sin_f32 v95, v95
    v_cvt_pk_bf16_f32 v12, v96, v97
    v_cvt_pk_bf16_f32 v13, v98, v99
    v_cvt_pk_bf16_f32 v14, v100, v101
    v_cvt_pk_bf16_f32 v15, v102, v103
    v_cvt_pk_bf16_f32 v20, v88, v89
    v_cvt_pk_bf16_f32 v21, v90, v91
    v_cvt_pk_bf16_f32 v22, v92, v93
    v_cvt_pk_bf16_f32 v23, v94, v95
    v_xor_b32 v28, 0x80008000, v20
    v_xor_b32 v29, 0x80008000, v21
    v_xor_b32 v30, 0x80008000, v22
    v_xor_b32 v31, 0x80008000, v23
    v_mov_b32 v6, v107
    v_mul_f32 v105, v6, v106
    v_mul_f32 v105, 0x3e000000, v105
    v_fmamk_f32 v88, v6, 0x00000000, v105
    v_fmamk_f32 v89, v6, 0x3d000000, v105
    v_fmamk_f32 v90, v6, 0x3d800000, v105
    v_fmamk_f32 v91, v6, 0x3dc00000, v105
    v_fmamk_f32 v92, v6, 0x3f000000, v105
    v_fmamk_f32 v93, v6, 0x3f080000, v105
    v_fmamk_f32 v94, v6, 0x3f100000, v105
    v_fmamk_f32 v95, v6, 0x3f180000, v105
    v_cos_f32 v96, v88
    v_cos_f32 v97, v89
    v_cos_f32 v98, v90
    v_cos_f32 v99, v91
    v_cos_f32 v100, v92
    v_cos_f32 v101, v93
    v_cos_f32 v102, v94
    v_cos_f32 v103, v95
    v_sin_f32 v88, v88
    v_sin_f32 v89, v89
    v_sin_f32 v90, v90
    v_sin_f32 v91, v91
    v_sin_f32 v92, v92
    v_sin_f32 v93, v93
    v_sin_f32 v94, v94
    v_sin_f32 v95, v95
    v_cvt_pk_bf16_f32 v32, v96, v97
    v_cvt_pk_bf16_f32 v33, v98, v99
    v_cvt_pk_bf16_f32 v34, v100, v101
    v_cvt_pk_bf16_f32 v35, v102, v103
    v_cvt_pk_bf16_f32 v40, v88, v89
    v_cvt_pk_bf16_f32 v41, v90, v91
    v_cvt_pk_bf16_f32 v42, v92, v93
    v_cvt_pk_bf16_f32 v43, v94, v95
    v_xor_b32 v48, 0x80008000, v40
    v_xor_b32 v49, 0x80008000, v41
    v_xor_b32 v50, 0x80008000, v42
    v_xor_b32 v51, 0x80008000, v43
    v_add_f32 v6, 0x41800000, v107
    v_mul_f32 v105, v6, v106
    v_mul_f32 v105, 0x3e000000, v105
    v_fmamk_f32 v88, v6, 0x00000000, v105
    v_fmamk_f32 v89, v6, 0x3d000000, v105
    v_fmamk_f32 v90, v6, 0x3d800000, v105
    v_fmamk_f32 v91, v6, 0x3dc00000, v105
    v_fmamk_f32 v92, v6, 0x3f000000, v105
    v_fmamk_f32 v93, v6, 0x3f080000, v105
    v_fmamk_f32 v94, v6, 0x3f100000, v105
    v_fmamk_f32 v95, v6, 0x3f180000, v105
    v_cos_f32 v96, v88
    v_cos_f32 v97, v89
    v_cos_f32 v98, v90
    v_cos_f32 v99, v91
    v_cos_f32 v100, v92
    v_cos_f32 v101, v93
    v_cos_f32 v102, v94
    v_cos_f32 v103, v95
    v_sin_f32 v88, v88
    v_sin_f32 v89, v89
    v_sin_f32 v90, v90
    v_sin_f32 v91, v91
    v_sin_f32 v92, v92
    v_sin_f32 v93, v93
    v_sin_f32 v94, v94
    v_sin_f32 v95, v95
    v_cvt_pk_bf16_f32 v36, v96, v97
    v_cvt_pk_bf16_f32 v37, v98, v99
    v_cvt_pk_bf16_f32 v38, v100, v101
    v_cvt_pk_bf16_f32 v39, v102, v103
    v_cvt_pk_bf16_f32 v44, v88, v89
    v_cvt_pk_bf16_f32 v45, v90, v91
    v_cvt_pk_bf16_f32 v46, v92, v93
    v_cvt_pk_bf16_f32 v47, v94, v95
    v_xor_b32 v52, 0x80008000, v44
    v_xor_b32 v53, 0x80008000, v45
    v_xor_b32 v54, 0x80008000, v46
    v_xor_b32 v55, 0x80008000, v47
    v_mul_f32 v105, v104, v106
    v_mul_f32 v105, 0x3b000000, v105
    v_fmamk_f32 v88, v104, 0x00000000, v105
    v_fmamk_f32 v89, v104, 0x3a000000, v105
    v_fmamk_f32 v90, v104, 0x3a800000, v105
    v_fmamk_f32 v91, v104, 0x3ac00000, v105
    v_fmamk_f32 v92, v104, 0x3c000000, v105
    v_fmamk_f32 v93, v104, 0x3c080000, v105
    v_fmamk_f32 v94, v104, 0x3c100000, v105
    v_fmamk_f32 v95, v104, 0x3c180000, v105
    v_cos_f32 v56, v88
    v_cos_f32 v57, v89
    v_cos_f32 v58, v90
    v_cos_f32 v59, v91
    v_cos_f32 v60, v92
    v_cos_f32 v61, v93
    v_cos_f32 v62, v94
    v_cos_f32 v63, v95
    v_sin_f32 v64, v88
    v_sin_f32 v65, v89
    v_sin_f32 v66, v90
    v_sin_f32 v67, v91
    v_sin_f32 v68, v92
    v_sin_f32 v69, v93
    v_sin_f32 v70, v94
    v_sin_f32 v71, v95
    s_lshl_b32 s24, s20, 4
    v_cvt_f32_u32 v6, s24
    v_fmamk_f32 v6, v106, 0x40800000, v6
    v_mov_b32 v7, v107
    v_mul_f32 v7, 0x3a000000, v7
    v_mul_f32 v105, v7, v6
    v_mov_b32 v88, v105
    v_fmamk_f32 v89, v7, 0x3f800000, v105
    v_fmamk_f32 v90, v7, 0x40000000, v105
    v_fmamk_f32 v91, v7, 0x40400000, v105
    v_add_f32 v7, 0x41800000, v107
    v_mul_f32 v7, 0x3a000000, v7
    v_mul_f32 v105, v7, v6
    v_mov_b32 v92, v105
    v_fmamk_f32 v93, v7, 0x3f800000, v105
    v_fmamk_f32 v94, v7, 0x40000000, v105
    v_fmamk_f32 v95, v7, 0x40400000, v105
    v_cos_f32 v72, v88
    v_cos_f32 v73, v89
    v_cos_f32 v74, v90
    v_cos_f32 v75, v91
    v_cos_f32 v76, v92
    v_cos_f32 v77, v93
    v_cos_f32 v78, v94
    v_cos_f32 v79, v95
    v_sin_f32 v80, v88
    v_sin_f32 v81, v89
    v_sin_f32 v82, v90
    v_sin_f32 v83, v91
    v_sin_f32 v84, v92
    v_sin_f32 v85, v93
    v_sin_f32 v86, v94
    v_sin_f32 v87, v95
    v_mul_f32 v72, 0x3a000000, v72
    v_mul_f32 v73, 0x3a000000, v73
    v_mul_f32 v74, 0x3a000000, v74
    v_mul_f32 v75, 0x3a000000, v75
    v_mul_f32 v76, 0x3a000000, v76
    v_mul_f32 v77, 0x3a000000, v77
    v_mul_f32 v78, 0x3a000000, v78
    v_mul_f32 v79, 0x3a000000, v79
    v_mul_f32 v80, 0x3a000000, v80
    v_mul_f32 v81, 0x3a000000, v81
    v_mul_f32 v82, 0x3a000000, v82
    v_mul_f32 v83, 0x3a000000, v83
    v_mul_f32 v84, 0x3a000000, v84
    v_mul_f32 v85, 0x3a000000, v85
    v_mul_f32 v86, 0x3a000000, v86
    v_mul_f32 v87, 0x3a000000, v87
    s_waitcnt vmcnt(16)
    s_mul_i32 s25, s20, 6144
    s_add_u32 s25, s25, 131072
    v_mul_u32_u24 v210, 144, v2
    v_lshl_add_u32 v210, v3, 6, v210
    v_add_u32 v210, s25, v210
    v_lshl_or_b32 v176, v184, 16, v176
    v_lshl_or_b32 v177, v185, 16, v177
    v_lshl_or_b32 v178, v186, 16, v178
    v_lshl_or_b32 v179, v187, 16, v179
    v_lshl_or_b32 v180, v188, 16, v180
    v_lshl_or_b32 v181, v189, 16, v181
    v_lshl_or_b32 v182, v190, 16, v182
    v_lshl_or_b32 v183, v191, 16, v183
    ds_write_b128 v210, v[176:179] offset:0
    ds_write_b128 v210, v[180:183] offset:16
    v_lshl_or_b32 v192, v200, 16, v192
    v_lshl_or_b32 v193, v201, 16, v193
    v_lshl_or_b32 v194, v202, 16, v194
    v_lshl_or_b32 v195, v203, 16, v195
    v_lshl_or_b32 v196, v204, 16, v196
    v_lshl_or_b32 v197, v205, 16, v197
    v_lshl_or_b32 v198, v206, 16, v198
    v_lshl_or_b32 v199, v207, 16, v199
    ds_write_b128 v210, v[192:195] offset:32
    ds_write_b128 v210, v[196:199] offset:48
    v_lshrrev_b32 v212, 3, v1
    v_mul_u32_u24 v211, 144, v212
    v_lshlrev_b32 v212, 13, v212
    v_and_b32 v210, 7, v1
    v_lshlrev_b32 v210, 4, v210
    v_add_u32 v211, v211, v210
    v_add_u32 v211, s25, v211
    v_add_u32 v212, v212, v210
    s_waitcnt lgkmcnt(0)
    ds_read_b128 v[216:219], v211 offset:0
    ds_read_b128 v[220:223], v211 offset:1152
    ds_read_b128 v[224:227], v211 offset:2304
    ds_read_b128 v[228:231], v211 offset:3456
    s_add_u32 s12, s82, 0x1d00000
    s_addc_u32 s13, s83, 0
    s_mov_b32 s14, 0x200000
    s_mov_b32 s15, 0x00020000
    s_lshr_b32 s24, s2, 2
    s_lshl_b32 s24, s24, 7
    s_and_b32 s26, s2, 3
    s_lshl_b32 s26, s26, 6
    s_sub_u32 s27, s20, 2
    s_lshl_b32 s27, s27, 5
    s_add_u32 s26, s26, s27
    s_lshl_b32 s26, s26, 13
    s_add_u32 s24, s24, s26
    s_waitcnt lgkmcnt(3)
    s_add_u32 s26, s24, 0
    buffer_store_dwordx4 v[216:219], v212, s[12:15], s26 offen sc1
    s_waitcnt lgkmcnt(2)
    s_add_u32 s26, s24, 65536
    buffer_store_dwordx4 v[220:223], v212, s[12:15], s26 offen sc1
    s_waitcnt lgkmcnt(1)
    s_add_u32 s26, s24, 131072
    buffer_store_dwordx4 v[224:227], v212, s[12:15], s26 offen sc1
    s_waitcnt lgkmcnt(0)
    s_add_u32 s26, s24, 196608
    buffer_store_dwordx4 v[228:231], v212, s[12:15], s26 offen sc1
    s_add_u32 m0, s48, 8192
    s_add_u32 s49, s50, 352256
    buffer_load_dwordx4 v208, s[56:59], s49 offen lds
    s_add_u32 m0, s48, 9216
    s_add_u32 s49, s50, 396288
    buffer_load_dwordx4 v208, s[56:59], s49 offen lds
    s_add_u32 m0, s48, 10240
    s_add_u32 s49, s50, 440320
    buffer_load_dwordx4 v208, s[56:59], s49 offen lds
    s_add_u32 m0, s48, 11264
    s_add_u32 s49, s50, 484352
    buffer_load_dwordx4 v208, s[56:59], s49 offen lds
    s_add_u32 m0, s48, 24576
    s_add_u32 s49, s50, 1056768
    buffer_load_dwordx4 v208, s[56:59], s49 offen lds
    s_add_u32 m0, s48, 25600
    s_add_u32 s49, s50, 1100800
    buffer_load_dwordx4 v208, s[56:59], s49 offen lds
    s_add_u32 m0, s48, 26624
    s_add_u32 s49, s50, 1144832
    buffer_load_dwordx4 v208, s[56:59], s49 offen lds
    s_add_u32 m0, s48, 27648
    s_add_u32 s49, s50, 1188864
    buffer_load_dwordx4 v208, s[56:59], s49 offen lds
    s_add_u32 m0, s48, 12288
    s_add_u32 s49, s50, 528384
    buffer_load_dwordx4 v208, s[56:59], s49 offen lds
    s_add_u32 m0, s48, 13312
    s_add_u32 s49, s50, 572416
    buffer_load_dwordx4 v208, s[56:59], s49 offen lds
    s_add_u32 m0, s48, 14336
    s_add_u32 s49, s50, 616448
    buffer_load_dwordx4 v208, s[56:59], s49 offen lds
    s_add_u32 m0, s48, 15360
    s_add_u32 s49, s50, 660480
    buffer_load_dwordx4 v208, s[56:59], s49 offen lds
    s_add_u32 m0, s48, 28672
    s_add_u32 s49, s50, 1232896
    buffer_load_dwordx4 v208, s[56:59], s49 offen lds
    s_add_u32 m0, s48, 29696
    s_add_u32 s49, s50, 1276928
    buffer_load_dwordx4 v208, s[56:59], s49 offen lds
    s_add_u32 m0, s48, 30720
    s_add_u32 s49, s50, 1320960
    buffer_load_dwordx4 v208, s[56:59], s49 offen lds
    s_add_u32 m0, s48, 31744
    s_add_u32 s49, s50, 1364992
    buffer_load_dwordx4 v208, s[56:59], s49 offen lds
    v_mov_b32 v250, 156160
    s_mov_b32 s31, 0
    s_nop 0
L_lfw_23:
    ds_read_b32 v251, v250
    s_add_u32 s31, s31, 1
    s_waitcnt lgkmcnt(0)
    v_readfirstlane_b32 s24, v251
    s_nop 0
    s_cmp_eq_u32 s24, 1
    s_nop 1
    s_cbranch_scc1 L_lfwd_24
    s_cmp_lt_u32 s31, 16777216
    s_cbranch_scc1 L_lfw_23
L_lfwd_24:
    s_waitcnt vmcnt(16)
    s_add_u32 s4, s82, 0x1f00000
    s_addc_u32 s5, s83, 0
    s_mov_b32 s6, 0x5000
    s_mov_b32 s7, 0x00020000
    v_lshlrev_b32 v250, 3, v1
    v_add_u32 v250, s21, v250
    v_lshlrev_b32 v250, 7, v250
    v_mov_b32 v251, 1
    s_mov_b64 exec, 0xffff
    buffer_atomic_add v251, v250, s[4:7], 0 offen offset:0 sc1
    s_mov_b64 exec, -1
    v_and_b32 v209, 15, v1
    v_lshrrev_b32 v208, 2, v209
    v_lshl_add_u32 v208, v3, 3, v208
    v_lshlrev_b32 v208, 6, v208
    v_and_b32 v209, 3, v209
    v_lshl_add_u32 v208, v209, 3, v208
    v_lshrrev_b32 v209, 4, v1
    v_and_b32 v209, 1, v209
    v_lshl_add_u32 v208, v209, 5, v208
    v_add_u32 v208, s48, v208
    s_waitcnt vmcnt(25)
    ds_read_b64_tr_b16 v[176:177], v208 offset:0
    ds_read_b64_tr_b16 v[178:179], v208 offset:256
    ds_read_b64_tr_b16 v[180:181], v208 offset:16384
    ds_read_b64_tr_b16 v[182:183], v208 offset:16640
    ds_read_b64_tr_b16 v[184:185], v208 offset:1024
    ds_read_b64_tr_b16 v[186:187], v208 offset:1280
    ds_read_b64_tr_b16 v[188:189], v208 offset:17408
    ds_read_b64_tr_b16 v[190:191], v208 offset:17664
    ds_read_b64_tr_b16 v[192:193], v208 offset:2048
    ds_read_b64_tr_b16 v[194:195], v208 offset:2304
    ds_read_b64_tr_b16 v[196:197], v208 offset:18432
    ds_read_b64_tr_b16 v[198:199], v208 offset:18688
    ds_read_b64_tr_b16 v[200:201], v208 offset:3072
    ds_read_b64_tr_b16 v[202:203], v208 offset:3328
    ds_read_b64_tr_b16 v[204:205], v208 offset:19456
    ds_read_b64_tr_b16 v[206:207], v208 offset:19712
    s_waitcnt lgkmcnt(14)
    v_mfma_f32_32x32x16_bf16 v[104:119], a[0:3], v[176:179], 0
    v_mfma_f32_32x32x16_bf16 v[120:135], a[64:67], v[176:179], 0
    s_waitcnt lgkmcnt(12)
    v_mfma_f32_32x32x16_bf16 v[136:151], a[0:3], v[180:183], 0
    v_mfma_f32_32x32x16_bf16 v[152:167], a[64:67], v[180:183], 0
    s_waitcnt lgkmcnt(10)
    v_mfma_f32_32x32x16_bf16 v[104:119], a[4:7], v[184:187], v[104:119]
    v_mfma_f32_32x32x16_bf16 v[120:135], a[68:71], v[184:187], v[120:135]
    s_waitcnt lgkmcnt(8)
    v_mfma_f32_32x32x16_bf16 v[136:151], a[4:7], v[188:191], v[136:151]
    v_mfma_f32_32x32x16_bf16 v[152:167], a[68:71], v[188:191], v[152:167]
    s_waitcnt lgkmcnt(6)
    v_mfma_f32_32x32x16_bf16 v[104:119], a[8:11], v[192:195], v[104:119]
    v_mfma_f32_32x32x16_bf16 v[120:135], a[72:75], v[192:195], v[120:135]
    s_waitcnt lgkmcnt(4)
    v_mfma_f32_32x32x16_bf16 v[136:151], a[8:11], v[196:199], v[136:151]
    v_mfma_f32_32x32x16_bf16 v[152:167], a[72:75], v[196:199], v[152:167]
    s_waitcnt lgkmcnt(2)
    v_mfma_f32_32x32x16_bf16 v[104:119], a[12:15], v[200:203], v[104:119]
    v_mfma_f32_32x32x16_bf16 v[120:135], a[76:79], v[200:203], v[120:135]
    s_waitcnt lgkmcnt(0)
    v_mfma_f32_32x32x16_bf16 v[136:151], a[12:15], v[204:207], v[136:151]
    v_mfma_f32_32x32x16_bf16 v[152:167], a[76:79], v[204:207], v[152:167]
    s_waitcnt vmcnt(17)
    ds_read_b64_tr_b16 v[176:177], v208 offset:4096
    ds_read_b64_tr_b16 v[178:179], v208 offset:4352
    ds_read_b64_tr_b16 v[180:181], v208 offset:20480
    ds_read_b64_tr_b16 v[182:183], v208 offset:20736
    ds_read_b64_tr_b16 v[184:185], v208 offset:5120
    ds_read_b64_tr_b16 v[186:187], v208 offset:5376
    ds_read_b64_tr_b16 v[188:189], v208 offset:21504
    ds_read_b64_tr_b16 v[190:191], v208 offset:21760
    ds_read_b64_tr_b16 v[192:193], v208 offset:6144
    ds_read_b64_tr_b16 v[194:195], v208 offset:6400
    ds_read_b64_tr_b16 v[196:197], v208 offset:22528
    ds_read_b64_tr_b16 v[198:199], v208 offset:22784
    ds_read_b64_tr_b16 v[200:201], v208 offset:7168
    ds_read_b64_tr_b16 v[202:203], v208 offset:7424
    ds_read_b64_tr_b16 v[204:205], v208 offset:23552
    ds_read_b64_tr_b16 v[206:207], v208 offset:23808
    s_waitcnt lgkmcnt(14)
    v_mfma_f32_32x32x16_bf16 v[104:119], a[16:19], v[176:179], v[104:119]
    v_mfma_f32_32x32x16_bf16 v[120:135], a[80:83], v[176:179], v[120:135]
    s_waitcnt lgkmcnt(12)
    v_mfma_f32_32x32x16_bf16 v[136:151], a[16:19], v[180:183], v[136:151]
    v_mfma_f32_32x32x16_bf16 v[152:167], a[80:83], v[180:183], v[152:167]
    s_waitcnt lgkmcnt(10)
    v_mfma_f32_32x32x16_bf16 v[104:119], a[20:23], v[184:187], v[104:119]
    v_mfma_f32_32x32x16_bf16 v[120:135], a[84:87], v[184:187], v[120:135]
    s_waitcnt lgkmcnt(8)
    v_mfma_f32_32x32x16_bf16 v[136:151], a[20:23], v[188:191], v[136:151]
    v_mfma_f32_32x32x16_bf16 v[152:167], a[84:87], v[188:191], v[152:167]
    s_waitcnt lgkmcnt(6)
    v_mfma_f32_32x32x16_bf16 v[104:119], a[24:27], v[192:195], v[104:119]
    v_mfma_f32_32x32x16_bf16 v[120:135], a[88:91], v[192:195], v[120:135]
    s_waitcnt lgkmcnt(4)
    v_mfma_f32_32x32x16_bf16 v[136:151], a[24:27], v[196:199], v[136:151]
    v_mfma_f32_32x32x16_bf16 v[152:167], a[88:91], v[196:199], v[152:167]
    s_waitcnt lgkmcnt(2)
    v_mfma_f32_32x32x16_bf16 v[104:119], a[28:31], v[200:203], v[104:119]
    v_mfma_f32_32x32x16_bf16 v[120:135], a[92:95], v[200:203], v[120:135]
    s_waitcnt lgkmcnt(0)
    v_mfma_f32_32x32x16_bf16 v[136:151], a[28:31], v[204:207], v[136:151]
    v_mfma_f32_32x32x16_bf16 v[152:167], a[92:95], v[204:207], v[152:167]
    s_waitcnt vmcnt(9)
    ds_read_b64_tr_b16 v[176:177], v208 offset:8192
    ds_read_b64_tr_b16 v[178:179], v208 offset:8448
    ds_read_b64_tr_b16 v[180:181], v208 offset:24576
    ds_read_b64_tr_b16 v[182:183], v208 offset:24832
    ds_read_b64_tr_b16 v[184:185], v208 offset:9216
    ds_read_b64_tr_b16 v[186:187], v208 offset:9472
    ds_read_b64_tr_b16 v[188:189], v208 offset:25600
    ds_read_b64_tr_b16 v[190:191], v208 offset:25856
    ds_read_b64_tr_b16 v[192:193], v208 offset:10240
    ds_read_b64_tr_b16 v[194:195], v208 offset:10496
    ds_read_b64_tr_b16 v[196:197], v208 offset:26624
    ds_read_b64_tr_b16 v[198:199], v208 offset:26880
    ds_read_b64_tr_b16 v[200:201], v208 offset:11264
    ds_read_b64_tr_b16 v[202:203], v208 offset:11520
    ds_read_b64_tr_b16 v[204:205], v208 offset:27648
    ds_read_b64_tr_b16 v[206:207], v208 offset:27904
    s_waitcnt lgkmcnt(14)
    v_mfma_f32_32x32x16_bf16 v[104:119], a[32:35], v[176:179], v[104:119]
    v_mfma_f32_32x32x16_bf16 v[120:135], a[96:99], v[176:179], v[120:135]
    s_waitcnt lgkmcnt(12)
    v_mfma_f32_32x32x16_bf16 v[136:151], a[32:35], v[180:183], v[136:151]
    v_mfma_f32_32x32x16_bf16 v[152:167], a[96:99], v[180:183], v[152:167]
    s_waitcnt lgkmcnt(10)
    v_mfma_f32_32x32x16_bf16 v[104:119], a[36:39], v[184:187], v[104:119]
    v_mfma_f32_32x32x16_bf16 v[120:135], a[100:103], v[184:187], v[120:135]
    s_waitcnt lgkmcnt(8)
    v_mfma_f32_32x32x16_bf16 v[136:151], a[36:39], v[188:191], v[136:151]
    v_mfma_f32_32x32x16_bf16 v[152:167], a[100:103], v[188:191], v[152:167]
    s_waitcnt lgkmcnt(6)
    v_mfma_f32_32x32x16_bf16 v[104:119], a[40:43], v[192:195], v[104:119]
    v_mfma_f32_32x32x16_bf16 v[120:135], a[104:107], v[192:195], v[120:135]
    s_waitcnt lgkmcnt(4)
    v_mfma_f32_32x32x16_bf16 v[136:151], a[40:43], v[196:199], v[136:151]
    v_mfma_f32_32x32x16_bf16 v[152:167], a[104:107], v[196:199], v[152:167]
    s_waitcnt lgkmcnt(2)
    v_mfma_f32_32x32x16_bf16 v[104:119], a[44:47], v[200:203], v[104:119]
    v_mfma_f32_32x32x16_bf16 v[120:135], a[108:111], v[200:203], v[120:135]
    s_waitcnt lgkmcnt(0)
    v_mfma_f32_32x32x16_bf16 v[136:151], a[44:47], v[204:207], v[136:151]
    v_mfma_f32_32x32x16_bf16 v[152:167], a[108:111], v[204:207], v[152:167]
    s_waitcnt vmcnt(1)
    ds_read_b64_tr_b16 v[176:177], v208 offset:12288
    ds_read_b64_tr_b16 v[178:179], v208 offset:12544
    ds_read_b64_tr_b16 v[180:181], v208 offset:28672
    ds_read_b64_tr_b16 v[182:183], v208 offset:28928
    ds_read_b64_tr_b16 v[184:185], v208 offset:13312
    ds_read_b64_tr_b16 v[186:187], v208 offset:13568
    ds_read_b64_tr_b16 v[188:189], v208 offset:29696
    ds_read_b64_tr_b16 v[190:191], v208 offset:29952
    ds_read_b64_tr_b16 v[192:193], v208 offset:14336
    ds_read_b64_tr_b16 v[194:195], v208 offset:14592
    ds_read_b64_tr_b16 v[196:197], v208 offset:30720
    ds_read_b64_tr_b16 v[198:199], v208 offset:30976
    ds_read_b64_tr_b16 v[200:201], v208 offset:15360
    ds_read_b64_tr_b16 v[202:203], v208 offset:15616
    ds_read_b64_tr_b16 v[204:205], v208 offset:31744
    ds_read_b64_tr_b16 v[206:207], v208 offset:32000
    s_waitcnt lgkmcnt(14)
    v_mfma_f32_32x32x16_bf16 v[104:119], a[48:51], v[176:179], v[104:119]
    v_mfma_f32_32x32x16_bf16 v[120:135], a[112:115], v[176:179], v[120:135]
    s_waitcnt lgkmcnt(12)
    v_mfma_f32_32x32x16_bf16 v[136:151], a[48:51], v[180:183], v[136:151]
    v_mfma_f32_32x32x16_bf16 v[152:167], a[112:115], v[180:183], v[152:167]
    s_waitcnt lgkmcnt(10)
    v_mfma_f32_32x32x16_bf16 v[104:119], a[52:55], v[184:187], v[104:119]
    v_mfma_f32_32x32x16_bf16 v[120:135], a[116:119], v[184:187], v[120:135]
    s_waitcnt lgkmcnt(8)
    v_mfma_f32_32x32x16_bf16 v[136:151], a[52:55], v[188:191], v[136:151]
    v_mfma_f32_32x32x16_bf16 v[152:167], a[116:119], v[188:191], v[152:167]
    s_waitcnt lgkmcnt(6)
    v_mfma_f32_32x32x16_bf16 v[104:119], a[56:59], v[192:195], v[104:119]
    v_mfma_f32_32x32x16_bf16 v[120:135], a[120:123], v[192:195], v[120:135]
    s_waitcnt lgkmcnt(4)
    v_mfma_f32_32x32x16_bf16 v[136:151], a[56:59], v[196:199], v[136:151]
    v_mfma_f32_32x32x16_bf16 v[152:167], a[120:123], v[196:199], v[152:167]
    s_waitcnt lgkmcnt(2)
    v_mfma_f32_32x32x16_bf16 v[104:119], a[60:63], v[200:203], v[104:119]
    v_mfma_f32_32x32x16_bf16 v[120:135], a[124:127], v[200:203], v[120:135]
    s_waitcnt lgkmcnt(0)
    v_mfma_f32_32x32x16_bf16 v[136:151], a[60:63], v[204:207], v[136:151]
    v_mfma_f32_32x32x16_bf16 v[152:167], a[124:127], v[204:207], v[152:167]
    s_nop 10
    v_add_f32 v104, v104, v136
    v_add_f32 v105, v105, v137
    v_sub_f32 v106, v106, v138
    v_sub_f32 v107, v107, v139
    v_add_f32 v108, v108, v140
    v_add_f32 v109, v109, v141
    v_sub_f32 v110, v110, v142
    v_sub_f32 v111, v111, v143
    v_add_f32 v112, v112, v144
    v_add_f32 v113, v113, v145
    v_sub_f32 v114, v114, v146
    v_sub_f32 v115, v115, v147
    v_add_f32 v116, v116, v148
    v_add_f32 v117, v117, v149
    v_sub_f32 v118, v118, v150
    v_sub_f32 v119, v119, v151
    v_add_f32 v120, v120, v152
    v_add_f32 v121, v121, v153
    v_sub_f32 v122, v122, v154
    v_sub_f32 v123, v123, v155
    v_add_f32 v124, v124, v156
    v_add_f32 v125, v125, v157
    v_sub_f32 v126, v126, v158
    v_sub_f32 v127, v127, v159
    v_add_f32 v128, v128, v160
    v_add_f32 v129, v129, v161
    v_sub_f32 v130, v130, v162
    v_sub_f32 v131, v131, v163
    v_add_f32 v132, v132, v164
    v_add_f32 v133, v133, v165
    v_sub_f32 v134, v134, v166
    v_sub_f32 v135, v135, v167
    v_mov_b32 v175, 0x3d800000
    v_mov_b32 v176, 0x3d800000
    v_cmp_eq_u32 vcc, 0, v3
    s_cmp_eq_u32 s45, 0
    s_cselect_b64 s[26:27], vcc, 0
    v_mov_b32 v177, 0
    v_cndmask_b32 v175, v175, v177, s[26:27]
    v_mov_b32 v177, 0x3d3504f3
    v_cndmask_b32 v176, v176, v177, s[26:27]
    v_mul_f32 v104, v104, v175
    v_mul_f32 v105, v105, v176
    v_mul_f32 v106, 0x3d800000, v106
    v_mul_f32 v107, 0x3d800000, v107
    v_mul_f32 v108, 0x3d800000, v108
    v_mul_f32 v109, 0x3d800000, v109
    v_mul_f32 v110, 0x3d800000, v110
    v_mul_f32 v111, 0x3d800000, v111
    v_mul_f32 v112, 0x3d800000, v112
    v_mul_f32 v113, 0x3d800000, v113
    v_mul_f32 v114, 0x3d800000, v114
    v_mul_f32 v115, 0x3d800000, v115
    v_mul_f32 v116, 0x3d800000, v116
    v_mul_f32 v117, 0x3d800000, v117
    v_mul_f32 v118, 0x3d800000, v118
    v_mul_f32 v119, 0x3d800000, v119
    v_mul_f32 v120, 0x3d800000, v120
    v_mul_f32 v121, 0x3d800000, v121
    v_mul_f32 v122, 0x3d800000, v122
    v_mul_f32 v123, 0x3d800000, v123
    v_mul_f32 v124, 0x3d800000, v124
    v_mul_f32 v125, 0x3d800000, v125
    v_mul_f32 v126, 0x3d800000, v126
    v_mul_f32 v127, 0x3d800000, v127
    v_mul_f32 v128, 0x3d800000, v128
    v_mul_f32 v129, 0x3d800000, v129
    v_mul_f32 v130, 0x3d800000, v130
    v_mul_f32 v131, 0x3d800000, v131
    v_mul_f32 v132, 0x3d800000, v132
    v_mul_f32 v133, 0x3d800000, v133
    v_mul_f32 v134, 0x3d800000, v134
    v_mul_f32 v135, 0x3d800000, v135
    v_cvt_pk_bf16_f32 v136, v104, v105
    v_cvt_pk_bf16_f32 v137, v106, v107
    v_cvt_pk_bf16_f32 v138, v108, v109
    v_cvt_pk_bf16_f32 v139, v110, v111
    v_cvt_pk_bf16_f32 v140, v112, v113
    v_cvt_pk_bf16_f32 v141, v114, v115
    v_cvt_pk_bf16_f32 v142, v116, v117
    v_cvt_pk_bf16_f32 v143, v118, v119
    v_cvt_pk_bf16_f32 v144, v120, v121
    v_cvt_pk_bf16_f32 v145, v122, v123
    v_cvt_pk_bf16_f32 v146, v124, v125
    v_cvt_pk_bf16_f32 v147, v126, v127
    v_cvt_pk_bf16_f32 v148, v128, v129
    v_cvt_pk_bf16_f32 v149, v130, v131
    v_cvt_pk_bf16_f32 v150, v132, v133
    v_cvt_pk_bf16_f32 v151, v134, v135
    s_add_u32 s8, s82, 0x1500000
    s_addc_u32 s9, s83, 0
    s_mov_b32 s10, 0x2b0000
    s_mov_b32 s11, 0x00020000
    v_lshlrev_b32 v177, 4, v1
    s_lshl_b32 s24, s46, 15
    s_lshl_b32 s25, s45, 12
    s_add_u32 s24, s24, s25
    buffer_store_dwordx4 v[136:139], v177, s[8:11], s24 offen offset:0 sc1
    buffer_store_dwordx4 v[140:143], v177, s[8:11], s24 offen offset:1024 sc1
    buffer_store_dwordx4 v[144:147], v177, s[8:11], s24 offen offset:2048 sc1
    buffer_store_dwordx4 v[148:151], v177, s[8:11], s24 offen offset:3072 sc1
    s_cmp_eq_u32 s91, 0
    s_cbranch_scc1 L_r2x_25
    s_mov_b32 s46, 42
    s_waitcnt vmcnt(0)
    s_waitcnt vmcnt(24)
    v_mfma_f32_32x32x16_bf16 v[104:119], a[128:131], a[0:3], 0
    v_mfma_f32_32x32x16_bf16 v[120:135], a[128:131], a[64:67], 0
    v_mfma_f32_32x32x16_bf16 v[136:151], a[192:195], a[0:3], 0
    v_mfma_f32_32x32x16_bf16 v[152:167], a[192:195], a[64:67], 0
    v_mfma_f32_32x32x16_bf16 v[104:119], a[132:135], a[4:7], v[104:119]
    v_mfma_f32_32x32x16_bf16 v[120:135], a[132:135], a[68:71], v[120:135]
    v_mfma_f32_32x32x16_bf16 v[136:151], a[196:199], a[4:7], v[136:151]
    v_mfma_f32_32x32x16_bf16 v[152:167], a[196:199], a[68:71], v[152:167]
    v_mfma_f32_32x32x16_bf16 v[104:119], a[136:139], a[8:11], v[104:119]
    v_mfma_f32_32x32x16_bf16 v[120:135], a[136:139], a[72:75], v[120:135]
    v_mfma_f32_32x32x16_bf16 v[136:151], a[200:203], a[8:11], v[136:151]
    v_mfma_f32_32x32x16_bf16 v[152:167], a[200:203], a[72:75], v[152:167]
    v_mfma_f32_32x32x16_bf16 v[104:119], a[140:143], a[12:15], v[104:119]
    v_mfma_f32_32x32x16_bf16 v[120:135], a[140:143], a[76:79], v[120:135]
    v_mfma_f32_32x32x16_bf16 v[136:151], a[204:207], a[12:15], v[136:151]
    v_mfma_f32_32x32x16_bf16 v[152:167], a[204:207], a[76:79], v[152:167]
    s_waitcnt vmcnt(16)
    v_mfma_f32_32x32x16_bf16 v[104:119], a[144:147], a[16:19], v[104:119]
    v_mfma_f32_32x32x16_bf16 v[120:135], a[144:147], a[80:83], v[120:135]
    v_mfma_f32_32x32x16_bf16 v[136:151], a[208:211], a[16:19], v[136:151]
    v_mfma_f32_32x32x16_bf16 v[152:167], a[208:211], a[80:83], v[152:167]
    v_mfma_f32_32x32x16_bf16 v[104:119], a[148:151], a[20:23], v[104:119]
    v_mfma_f32_32x32x16_bf16 v[120:135], a[148:151], a[84:87], v[120:135]
    v_mfma_f32_32x32x16_bf16 v[136:151], a[212:215], a[20:23], v[136:151]
    v_mfma_f32_32x32x16_bf16 v[152:167], a[212:215], a[84:87], v[152:167]
    v_mfma_f32_32x32x16_bf16 v[104:119], a[152:155], a[24:27], v[104:119]
    v_mfma_f32_32x32x16_bf16 v[120:135], a[152:155], a[88:91], v[120:135]
    v_mfma_f32_32x32x16_bf16 v[136:151], a[216:219], a[24:27], v[136:151]
    v_mfma_f32_32x32x16_bf16 v[152:167], a[216:219], a[88:91], v[152:167]
    v_mfma_f32_32x32x16_bf16 v[104:119], a[156:159], a[28:31], v[104:119]
    v_mfma_f32_32x32x16_bf16 v[120:135], a[156:159], a[92:95], v[120:135]
    v_mfma_f32_32x32x16_bf16 v[136:151], a[220:223], a[28:31], v[136:151]
    v_mfma_f32_32x32x16_bf16 v[152:167], a[220:223], a[92:95], v[152:167]
    s_waitcnt vmcnt(8)
    v_mfma_f32_32x32x16_bf16 v[104:119], a[160:163], a[32:35], v[104:119]
    v_mfma_f32_32x32x16_bf16 v[120:135], a[160:163], a[96:99], v[120:135]
    v_mfma_f32_32x32x16_bf16 v[136:151], a[224:227], a[32:35], v[136:151]
    v_mfma_f32_32x32x16_bf16 v[152:167], a[224:227], a[96:99], v[152:167]
    v_mfma_f32_32x32x16_bf16 v[104:119], a[164:167], a[36:39], v[104:119]
    v_mfma_f32_32x32x16_bf16 v[120:135], a[164:167], a[100:103], v[120:135]
    v_mfma_f32_32x32x16_bf16 v[136:151], a[228:231], a[36:39], v[136:151]
    v_mfma_f32_32x32x16_bf16 v[152:167], a[228:231], a[100:103], v[152:167]
    v_mfma_f32_32x32x16_bf16 v[104:119], a[168:171], a[40:43], v[104:119]
    v_mfma_f32_32x32x16_bf16 v[120:135], a[168:171], a[104:107], v[120:135]
    v_mfma_f32_32x32x16_bf16 v[136:151], a[232:235], a[40:43], v[136:151]
    v_mfma_f32_32x32x16_bf16 v[152:167], a[232:235], a[104:107], v[152:167]
    v_mfma_f32_32x32x16_bf16 v[104:119], a[172:175], a[44:47], v[104:119]
    v_mfma_f32_32x32x16_bf16 v[120:135], a[172:175], a[108:111], v[120:135]
    v_mfma_f32_32x32x16_bf16 v[136:151], a[236:239], a[44:47], v[136:151]
    v_mfma_f32_32x32x16_bf16 v[152:167], a[236:239], a[108:111], v[152:167]
    s_waitcnt vmcnt(0)
    v_mfma_f32_32x32x16_bf16 v[104:119], a[176:179], a[48:51], v[104:119]
    v_mfma_f32_32x32x16_bf16 v[120:135], a[176:179], a[112:115], v[120:135]
    v_mfma_f32_32x32x16_bf16 v[136:151], a[240:243], a[48:51], v[136:151]
    v_mfma_f32_32x32x16_bf16 v[152:167], a[240:243], a[112:115], v[152:167]
    v_mfma_f32_32x32x16_bf16 v[104:119], a[180:183], a[52:55], v[104:119]
    v_mfma_f32_32x32x16_bf16 v[120:135], a[180:183], a[116:119], v[120:135]
    v_mfma_f32_32x32x16_bf16 v[136:151], a[244:247], a[52:55], v[136:151]
    v_mfma_f32_32x32x16_bf16 v[152:167], a[244:247], a[116:119], v[152:167]
    v_mfma_f32_32x32x16_bf16 v[104:119], a[184:187], a[56:59], v[104:119]
    v_mfma_f32_32x32x16_bf16 v[120:135], a[184:187], a[120:123], v[120:135]
    v_mfma_f32_32x32x16_bf16 v[136:151], a[248:251], a[56:59], v[136:151]
    v_mfma_f32_32x32x16_bf16 v[152:167], a[248:251], a[120:123], v[152:167]
    v_mfma_f32_32x32x16_bf16 v[104:119], a[188:191], a[60:63], v[104:119]
    v_mfma_f32_32x32x16_bf16 v[120:135], a[188:191], a[124:127], v[120:135]
    v_mfma_f32_32x32x16_bf16 v[136:151], a[252:255], a[60:63], v[136:151]
    v_mfma_f32_32x32x16_bf16 v[152:167], a[252:255], a[124:127], v[152:167]
    v_lshlrev_b32 v177, 30, v2
    v_and_b32 v177, 0x80000000, v177
    v_or_b32 v175, 0x3f800000, v177
    v_cmp_gt_u32 vcc, 2, v2
    s_cmp_eq_u32 s45, 0
    s_cselect_b64 s[26:27], vcc, 0
    v_mov_b32 v176, 0x3d800000
    v_mov_b32 v177, 0x3d3504f3
    v_cndmask_b32 v176, v176, v177, s[26:27]
    s_nop 1
    v_fma_f32 v104, v136, v175, v104
    v_fma_f32 v105, v137, v175, v105
    v_fma_f32 v106, v138, v175, v106
    v_fma_f32 v107, v139, v175, v107
    v_fma_f32 v108, v140, v175, v108
    v_fma_f32 v109, v141, v175, v109
    v_fma_f32 v110, v142, v175, v110
    v_fma_f32 v111, v143, v175, v111
    v_fma_f32 v112, v144, v175, v112
    v_fma_f32 v113, v145, v175, v113
    v_fma_f32 v114, v146, v175, v114
    v_fma_f32 v115, v147, v175, v115
    v_fma_f32 v116, v148, v175, v116
    v_fma_f32 v117, v149, v175, v117
    v_fma_f32 v118, v150, v175, v118
    v_fma_f32 v119, v151, v175, v119
    v_mul_f32 v104, v104, v176
    v_mul_f32 v105, v105, v176
    v_mul_f32 v106, v106, v176
    v_mul_f32 v107, v107, v176
    v_mul_f32 v108, v108, v176
    v_mul_f32 v109, v109, v176
    v_mul_f32 v110, v110, v176
    v_mul_f32 v111, v111, v176
    v_mul_f32 v112, v112, v176
    v_mul_f32 v113, v113, v176
    v_mul_f32 v114, v114, v176
    v_mul_f32 v115, v115, v176
    v_mul_f32 v116, v116, v176
    v_mul_f32 v117, v117, v176
    v_mul_f32 v118, v118, v176
    v_mul_f32 v119, v119, v176
    v_fma_f32 v120, v152, v175, v120
    v_fma_f32 v121, v153, v175, v121
    v_fma_f32 v122, v154, v175, v122
    v_fma_f32 v123, v155, v175, v123
    v_fma_f32 v124, v156, v175, v124
    v_fma_f32 v125, v157, v175, v125
    v_fma_f32 v126, v158, v175, v126
    v_fma_f32 v127, v159, v175, v127
    v_fma_f32 v128, v160, v175, v128
    v_fma_f32 v129, v161, v175, v129
    v_fma_f32 v130, v162, v175, v130
    v_fma_f32 v131, v163, v175, v131
    v_fma_f32 v132, v164, v175, v132
    v_fma_f32 v133, v165, v175, v133
    v_fma_f32 v134, v166, v175, v134
    v_fma_f32 v135, v167, v175, v135
    v_mul_f32 v120, 0x3d800000, v120
    v_mul_f32 v121, 0x3d800000, v121
    v_mul_f32 v122, 0x3d800000, v122
    v_mul_f32 v123, 0x3d800000, v123
    v_mul_f32 v124, 0x3d800000, v124
    v_mul_f32 v125, 0x3d800000, v125
    v_mul_f32 v126, 0x3d800000, v126
    v_mul_f32 v127, 0x3d800000, v127
    v_mul_f32 v128, 0x3d800000, v128
    v_mul_f32 v129, 0x3d800000, v129
    v_mul_f32 v130, 0x3d800000, v130
    v_mul_f32 v131, 0x3d800000, v131
    v_mul_f32 v132, 0x3d800000, v132
    v_mul_f32 v133, 0x3d800000, v133
    v_mul_f32 v134, 0x3d800000, v134
    v_mul_f32 v135, 0x3d800000, v135
    v_cvt_pk_bf16_f32 v136, v104, v105
    v_cvt_pk_bf16_f32 v137, v106, v107
    v_cvt_pk_bf16_f32 v138, v108, v109
    v_cvt_pk_bf16_f32 v139, v110, v111
    v_cvt_pk_bf16_f32 v140, v112, v113
    v_cvt_pk_bf16_f32 v141, v114, v115
    v_cvt_pk_bf16_f32 v142, v116, v117
    v_cvt_pk_bf16_f32 v143, v118, v119
    v_cvt_pk_bf16_f32 v144, v120, v121
    v_cvt_pk_bf16_f32 v145, v122, v123
    v_cvt_pk_bf16_f32 v146, v124, v125
    v_cvt_pk_bf16_f32 v147, v126, v127
    v_cvt_pk_bf16_f32 v148, v128, v129
    v_cvt_pk_bf16_f32 v149, v130, v131
    v_cvt_pk_bf16_f32 v150, v132, v133
    v_cvt_pk_bf16_f32 v151, v134, v135
    s_add_u32 s8, s82, 0x1800000
    s_addc_u32 s9, s83, 0
    s_mov_b32 s10, 0x158000
    s_mov_b32 s11, 0x00020000
    v_lshlrev_b32 v178, 4, v1
    s_mul_i32 s24, s45, 176128
    s_lshl_b32 s25, s46, 11
    s_add_u32 s24, s24, s25
    s_add_u32 s25, s24, 0
    buffer_store_dwordx4 v[136:139], v178, s[8:11], s25 offen offset:0 sc1
    buffer_store_dwordx4 v[140:143], v178, s[8:11], s25 offen offset:1024 sc1
    s_add_u32 s25, s24, 88064
    buffer_store_dwordx4 v[144:147], v178, s[8:11], s25 offen offset:0 sc1
    buffer_store_dwordx4 v[148:151], v178, s[8:11], s25 offen offset:1024 sc1
    s_nop 1
L_r2x_25:
L_rolej2_11:
    s_waitcnt vmcnt(0)
    s_add_u32 s4, s82, 0x1f00000
    s_addc_u32 s5, s83, 0
    s_mov_b32 s6, 0x5000
    s_mov_b32 s7, 0x00020000
    v_lshlrev_b32 v250, 3, v1
    v_add_u32 v250, s21, v250
    v_lshlrev_b32 v250, 7, v250
    v_mov_b32 v251, 1
    s_mov_b64 exec, 0xffff
    buffer_atomic_add v251, v250, s[4:7], 0 offen offset:4 sc1
    s_mov_b64 exec, -1
    s_barrier
    s_lshr_b32 s24, s22, 3
    s_lshl_b32 s40, s21, 2
    s_add_u32 s40, s40, s24
    s_and_b32 s41, s22, 7
    s_mul_i32 s42, s20, 22
    s_cmp_eq_u32 s20, 3
    s_cselect_b32 s24, 1, 0
    s_sub_u32 s42, s42, s24
    s_min_u32 s24, s21, 2
    s_mul_i32 s25, s21, 30
    s_add_u32 s25, s25, s24
    s_cmp_lt_u32 s21, 2
    s_cselect_b32 s24, 31, 30
    s_cmp_ge_u32 s22, s24
    s_cselect_b32 s90, 1, 0
    s_add_u32 s25, s25, s22
    s_min_u32 s25, s25, 241
    s_cmp_ge_u32 s25, 121
    s_cselect_b32 s24, 121, 0
    s_cselect_b32 s32, 11, 0
    s_sub_u32 s25, s25, s24
    s_mul_hi_u32 s33, s25, 0x1745D175
    s_mul_i32 s24, s33, 11
    s_sub_u32 s25, s25, s24
    s_add_u32 s32, s32, s25
    s_lshl_b32 s34, s33, 2
    s_add_u32 s34, s34, s20
    s_cmp_eq_u32 s90, 1
    s_cselect_b32 s34, 43, s34
    s_mov_b32 s8, s82
    s_mov_b32 s9, s83
    s_mov_b32 s10, 0x200000
    s_mov_b32 s11, 0x00020000
    s_add_u32 s12, s82, 0x1400000
    s_addc_u32 s13, s83, 0
    s_mov_b32 s14, 0x10000
    s_mov_b32 s15, 0x00020000
    s_lshl_b32 s28, s2, 7
    s_add_u32 s29, s28, 64
    s_lshl_b32 s23, s2, 7
    s_mov_b32 s30, 1.0
    s_cmp_lg_u32 s2, 0
    s_cselect_b32 s28, s28, 64
    s_cselect_b32 s29, s29, 0
    s_cselect_b32 s30, s30, 0
    v_lshrrev_b32 v6, 2, v0
    v_lshlrev_b32 v200, 15, v6
    v_and_b32 v6, 3, v0
    v_lshl_add_u32 v200, v6, 4, v200
    v_lshlrev_b32 v201, 5, v0
    v_lshrrev_b32 v6, 3, v1
    s_lshl_b32 s24, s20, 4
    v_add_u32 v6, s24, v6
    v_lshlrev_b32 v202, 15, v6
    v_and_b32 v6, 7, v1
    v_lshl_add_u32 v202, v6, 4, v202
    s_cmp_lg_u32 s20, 0
    s_cbranch_scc1 L_wt_26
    s_add_u32 s4, s82, 0x1f00000
    s_addc_u32 s5, s83, 0
    s_mov_b32 s6, 0x5000
    s_mov_b32 s7, 0x00020000
    s_and_b32 s24, s22, 15
    s_lshl_b32 s24, s24, 3
    v_add_u32 v250, s24, v1
    v_lshlrev_b32 v250, 7, v250
    s_mov_b64 exec, 0xff
    s_mov_b32 s31, 0
L_poll_27:
    buffer_load_dword v251, v250, s[4:7], 0 offen sc0 sc1
    s_add_u32 s31, s31, 1
    s_waitcnt vmcnt(0)
    v_cmp_le_u32 vcc, 0x80, v251
    s_nop 0
    s_cmp_eq_u64 vcc, exec
    s_nop 1
    s_cbranch_scc1 L_polld_28
    s_cmp_lt_u32 s31, 1048576
    s_cbranch_scc1 L_poll_27
L_polld_28:
    s_mov_b64 exec, -1
L_wt_26:
    s_barrier
    s_add_u32 s16, s82, 0x1d00000
    s_addc_u32 s17, s83, 0
    s_mov_b32 s18, 0x200000
    s_mov_b32 s19, 0x00020000
    v_lshlrev_b32 v116, 2, v4
    v_add_u32 v116, v116, v5
    v_lshlrev_b32 v116, 5, v116
    s_lshl_b32 s24, s2, 13
    s_lshl_b32 s25, s20, 11
    s_add_u32 s24, s24, s25
    buffer_load_dwordx4 v[108:111], v116, s[16:19], s24 offen
    buffer_load_dwordx4 v[112:115], v116, s[16:19], s24 offen offset:16
    buffer_load_dwordx4 v[120:123], v200, s[8:11], s28 offen
    buffer_load_dwordx4 v[124:127], v200, s[8:11], s29 offen
    buffer_load_dwordx4 v[192:195], v202, s[8:11], s23 offen
    s_add_u32 s24, s23, 262144
    buffer_load_dwordx4 v[196:199], v202, s[8:11], s24 offen
    s_mov_b32 s24, 0
    buffer_load_dwordx4 v[128:131], v201, s[12:15], s24 offen
    buffer_load_dwordx4 v[132:135], v201, s[12:15], s24 offen offset:16
    s_add_u32 s24, s24, 8192
    buffer_load_dwordx4 v[136:139], v201, s[12:15], s24 offen
    buffer_load_dwordx4 v[140:143], v201, s[12:15], s24 offen offset:16
    s_add_u32 s24, s24, 8192
    buffer_load_dwordx4 v[144:147], v201, s[12:15], s24 offen
    buffer_load_dwordx4 v[148:151], v201, s[12:15], s24 offen offset:16
    s_add_u32 s24, s24, 8192
    buffer_load_dwordx4 v[152:155], v201, s[12:15], s24 offen
    buffer_load_dwordx4 v[156:159], v201, s[12:15], s24 offen offset:16
    s_add_u32 s24, s24, 8192
    buffer_load_dwordx4 v[160:163], v201, s[12:15], s24 offen
    buffer_load_dwordx4 v[164:167], v201, s[12:15], s24 offen offset:16
    s_add_u32 s24, s24, 8192
    buffer_load_dwordx4 v[168:171], v201, s[12:15], s24 offen
    buffer_load_dwordx4 v[172:175], v201, s[12:15], s24 offen offset:16
    s_add_u32 s24, s24, 8192
    buffer_load_dwordx4 v[176:179], v201, s[12:15], s24 offen
    buffer_load_dwordx4 v[180:183], v201, s[12:15], s24 offen offset:16
    s_add_u32 s24, s24, 8192
    buffer_load_dwordx4 v[184:187], v201, s[12:15], s24 offen
    buffer_load_dwordx4 v[188:191], v201, s[12:15], s24 offen offset:16
    v_lshrrev_b32 v6, 3, v0
    v_mul_u32_u24 v206, 144, v6
    v_and_b32 v6, 7, v0
    v_lshl_add_u32 v206, v6, 4, v206
    v_mul_u32_u24 v207, 144, v4
    v_lshl_add_u32 v207, v5, 4, v207
    v_mul_u32_u24 v208, 144, v4
    v_lshl_add_u32 v208, v5, 3, v208
    s_lshl_b32 s24, s20, 5
    v_add_u32 v208, s24, v208
    s_waitcnt vmcnt(12)
    v_pk_add_f32 v[128:129], v[128:129], v[136:137]
    v_pk_add_f32 v[130:131], v[130:131], v[138:139]
    v_pk_add_f32 v[132:133], v[132:133], v[140:141]
    v_pk_add_f32 v[134:135], v[134:135], v[142:143]
    s_waitcnt vmcnt(10)
    v_pk_add_f32 v[128:129], v[128:129], v[144:145]
    v_pk_add_f32 v[130:131], v[130:131], v[146:147]
    v_pk_add_f32 v[132:133], v[132:133], v[148:149]
    v_pk_add_f32 v[134:135], v[134:135], v[150:151]
    s_waitcnt vmcnt(8)
    v_pk_add_f32 v[128:129], v[128:129], v[152:153]
    v_pk_add_f32 v[130:131], v[130:131], v[154:155]
    v_pk_add_f32 v[132:133], v[132:133], v[156:157]
    v_pk_add_f32 v[134:135], v[134:135], v[158:159]
    s_waitcnt vmcnt(6)
    v_pk_add_f32 v[128:129], v[128:129], v[160:161]
    v_pk_add_f32 v[130:131], v[130:131], v[162:163]
    v_pk_add_f32 v[132:133], v[132:133], v[164:165]
    v_pk_add_f32 v[134:135], v[134:135], v[166:167]
    s_waitcnt vmcnt(4)
    v_pk_add_f32 v[128:129], v[128:129], v[168:169]
    v_pk_add_f32 v[130:131], v[130:131], v[170:171]
    v_pk_add_f32 v[132:133], v[132:133], v[172:173]
    v_pk_add_f32 v[134:135], v[134:135], v[174:175]
    s_waitcnt vmcnt(2)
    v_pk_add_f32 v[128:129], v[128:129], v[176:177]
    v_pk_add_f32 v[130:131], v[130:131], v[178:179]
    v_pk_add_f32 v[132:133], v[132:133], v[180:181]
    v_pk_add_f32 v[134:135], v[134:135], v[182:183]
    s_waitcnt vmcnt(0)
    v_pk_add_f32 v[128:129], v[128:129], v[184:185]
    v_pk_add_f32 v[130:131], v[130:131], v[186:187]
    v_pk_add_f32 v[132:133], v[132:133], v[188:189]
    v_pk_add_f32 v[134:135], v[134:135], v[190:191]
    v_mul_f32 v128, 0x3b000000, v128
    v_mul_f32 v129, 0x3b000000, v129
    v_mul_f32 v130, 0x3b000000, v130
    v_mul_f32 v131, 0x3b000000, v131
    v_mul_f32 v132, 0x3b000000, v132
    v_mul_f32 v133, 0x3b000000, v133
    v_mul_f32 v134, 0x3b000000, v134
    v_mul_f32 v135, 0x3b000000, v135
    v_add_f32 v128, 0x3727c5ac, v128
    v_add_f32 v129, 0x3727c5ac, v129
    v_add_f32 v130, 0x3727c5ac, v130
    v_add_f32 v131, 0x3727c5ac, v131
    v_add_f32 v132, 0x3727c5ac, v132
    v_add_f32 v133, 0x3727c5ac, v133
    v_add_f32 v134, 0x3727c5ac, v134
    v_add_f32 v135, 0x3727c5ac, v135
    v_rsq_f32 v128, v128
    v_rsq_f32 v129, v129
    v_rsq_f32 v130, v130
    v_rsq_f32 v131, v131
    v_rsq_f32 v132, v132
    v_rsq_f32 v133, v133
    v_rsq_f32 v134, v134
    v_rsq_f32 v135, v135
    v_mul_f32 v136, s30, v128
    v_mul_f32 v137, s30, v129
    v_mul_f32 v138, s30, v130
    v_mul_f32 v139, s30, v131
    v_mul_f32 v140, s30, v132
    v_mul_f32 v141, s30, v133
    v_mul_f32 v142, s30, v134
    v_mul_f32 v143, s30, v135
    v_lshlrev_b32 v88, 16, v120
    v_and_b32 v89, 0xffff0000, v120
    v_lshlrev_b32 v90, 16, v121
    v_and_b32 v91, 0xffff0000, v121
    v_lshlrev_b32 v92, 16, v122
    v_and_b32 v93, 0xffff0000, v122
    v_lshlrev_b32 v94, 16, v123
    v_and_b32 v95, 0xffff0000, v123
    v_pk_mul_f32 v[88:89], v[88:89], v[128:129]
    v_pk_mul_f32 v[90:91], v[90:91], v[130:131]
    v_pk_mul_f32 v[92:93], v[92:93], v[132:133]
    v_pk_mul_f32 v[94:95], v[94:95], v[134:135]
    v_cvt_pk_bf16_f32 v144, v88, v89
    v_cvt_pk_bf16_f32 v145, v90, v91
    v_cvt_pk_bf16_f32 v146, v92, v93
    v_cvt_pk_bf16_f32 v147, v94, v95
    ds_write_b128 v206, v[144:147] offset:0
    v_lshlrev_b32 v88, 16, v124
    v_and_b32 v89, 0xffff0000, v124
    v_lshlrev_b32 v90, 16, v125
    v_and_b32 v91, 0xffff0000, v125
    v_lshlrev_b32 v92, 16, v126
    v_and_b32 v93, 0xffff0000, v126
    v_lshlrev_b32 v94, 16, v127
    v_and_b32 v95, 0xffff0000, v127
    v_pk_mul_f32 v[88:89], v[88:89], v[136:137]
    v_pk_mul_f32 v[90:91], v[90:91], v[138:139]
    v_pk_mul_f32 v[92:93], v[92:93], v[140:141]
    v_pk_mul_f32 v[94:95], v[94:95], v[142:143]
    v_cvt_pk_bf16_f32 v148, v88, v89
    v_cvt_pk_bf16_f32 v149, v90, v91
    v_cvt_pk_bf16_f32 v150, v92, v93
    v_cvt_pk_bf16_f32 v151, v94, v95
    ds_write_b128 v206, v[148:151] offset:4608
    s_waitcnt lgkmcnt(0)
    s_barrier
    ds_read_b128 v[160:163], v207 offset:0
    ds_read_b128 v[168:171], v207 offset:2304
    ds_read_b128 v[176:179], v207 offset:4608
    ds_read_b128 v[184:187], v207 offset:6912
    ds_read_b128 v[164:167], v207 offset:64
    ds_read_b128 v[172:175], v207 offset:2368
    ds_read_b128 v[180:183], v207 offset:4672
    ds_read_b128 v[188:191], v207 offset:6976
    s_waitcnt lgkmcnt(4)
    v_mfma_f32_16x16x32_bf16 v[212:215], v[160:163], v[8:11], 0
    v_mfma_f32_16x16x32_bf16 v[220:223], v[176:179], v[8:11], 0
    v_mfma_f32_16x16x32_bf16 v[216:219], v[168:171], v[8:11], 0
    v_mfma_f32_16x16x32_bf16 v[224:227], v[184:187], v[8:11], 0
    v_mfma_f32_16x16x32_bf16 v[212:215], v[176:179], v[16:19], v[212:215]
    v_mfma_f32_16x16x32_bf16 v[220:223], v[160:163], v[24:27], v[220:223]
    v_mfma_f32_16x16x32_bf16 v[216:219], v[184:187], v[16:19], v[216:219]
    v_mfma_f32_16x16x32_bf16 v[224:227], v[168:171], v[24:27], v[224:227]
    s_waitcnt lgkmcnt(0)
    v_mfma_f32_16x16x32_bf16 v[212:215], v[164:167], v[12:15], v[212:215]
    v_mfma_f32_16x16x32_bf16 v[220:223], v[180:183], v[12:15], v[220:223]
    v_mfma_f32_16x16x32_bf16 v[216:219], v[172:175], v[12:15], v[216:219]
    v_mfma_f32_16x16x32_bf16 v[224:227], v[188:191], v[12:15], v[224:227]
    v_mfma_f32_16x16x32_bf16 v[212:215], v[180:183], v[20:23], v[212:215]
    v_mfma_f32_16x16x32_bf16 v[220:223], v[164:167], v[28:31], v[220:223]
    v_mfma_f32_16x16x32_bf16 v[216:219], v[188:191], v[20:23], v[216:219]
    v_mfma_f32_16x16x32_bf16 v[224:227], v[172:175], v[28:31], v[224:227]
    s_nop 4
    v_pk_mul_f32 v[88:89], v[212:213], v[56:57]
    v_pk_mul_f32 v[96:97], v[220:221], v[56:57]
    v_pk_mul_f32 v[90:91], v[214:215], v[58:59]
    v_pk_mul_f32 v[98:99], v[222:223], v[58:59]
    v_pk_mul_f32 v[92:93], v[216:217], v[60:61]
    v_pk_mul_f32 v[100:101], v[224:225], v[60:61]
    v_pk_mul_f32 v[94:95], v[218:219], v[62:63]
    v_pk_mul_f32 v[102:103], v[226:227], v[62:63]
    v_pk_fma_f32 v[88:89], v[220:221], v[64:65], v[88:89]
    v_pk_fma_f32 v[96:97], v[212:213], v[64:65], v[96:97] neg_lo:[1,0,0] neg_hi:[1,0,0]
    v_pk_fma_f32 v[90:91], v[222:223], v[66:67], v[90:91]
    v_pk_fma_f32 v[98:99], v[214:215], v[66:67], v[98:99] neg_lo:[1,0,0] neg_hi:[1,0,0]
    v_pk_fma_f32 v[92:93], v[224:225], v[68:69], v[92:93]
    v_pk_fma_f32 v[100:101], v[216:217], v[68:69], v[100:101] neg_lo:[1,0,0] neg_hi:[1,0,0]
    v_pk_fma_f32 v[94:95], v[226:227], v[70:71], v[94:95]
    v_pk_fma_f32 v[102:103], v[218:219], v[70:71], v[102:103] neg_lo:[1,0,0] neg_hi:[1,0,0]
    v_cvt_pk_bf16_f32 v228, v88, v89
    v_cvt_pk_bf16_f32 v232, v96, v97
    v_cvt_pk_bf16_f32 v229, v90, v91
    v_cvt_pk_bf16_f32 v233, v98, v99
    v_cvt_pk_bf16_f32 v230, v92, v93
    v_cvt_pk_bf16_f32 v234, v100, v101
    v_cvt_pk_bf16_f32 v231, v94, v95
    v_cvt_pk_bf16_f32 v235, v102, v103
    s_nop 0
    v_mfma_f32_16x16x32_bf16 v[128:131], v[32:35], v[228:231], 0
    v_mfma_f32_16x16x32_bf16 v[136:139], v[32:35], v[232:235], 0
    v_mfma_f32_16x16x32_bf16 v[132:135], v[36:39], v[228:231], 0
    v_mfma_f32_16x16x32_bf16 v[140:143], v[36:39], v[232:235], 0
    v_mfma_f32_16x16x32_bf16 v[128:131], v[40:43], v[232:235], v[128:131]
    v_mfma_f32_16x16x32_bf16 v[136:139], v[48:51], v[228:231], v[136:139]
    v_mfma_f32_16x16x32_bf16 v[132:135], v[44:47], v[232:235], v[132:135]
    v_mfma_f32_16x16x32_bf16 v[140:143], v[52:55], v[228:231], v[140:143]
    v_lshlrev_b32 v212, 16, v108
    v_and_b32 v220, 0xffff0000, v108
    v_lshlrev_b32 v213, 16, v109
    v_and_b32 v221, 0xffff0000, v109
    v_lshlrev_b32 v214, 16, v110
    v_and_b32 v222, 0xffff0000, v110
    v_lshlrev_b32 v215, 16, v111
    v_and_b32 v223, 0xffff0000, v111
    v_lshlrev_b32 v216, 16, v112
    v_and_b32 v224, 0xffff0000, v112
    v_lshlrev_b32 v217, 16, v113
    v_and_b32 v225, 0xffff0000, v113
    v_lshlrev_b32 v218, 16, v114
    v_and_b32 v226, 0xffff0000, v114
    v_lshlrev_b32 v219, 16, v115
    v_and_b32 v227, 0xffff0000, v115
    v_pk_mul_f32 v[88:89], v[128:129], v[212:213]
    v_pk_mul_f32 v[96:97], v[136:137], v[212:213]
    v_pk_mul_f32 v[90:91], v[130:131], v[214:215]
    v_pk_mul_f32 v[98:99], v[138:139], v[214:215]
    v_pk_mul_f32 v[92:93], v[132:133], v[216:217]
    v_pk_mul_f32 v[100:101], v[140:141], v[216:217]
    v_pk_mul_f32 v[94:95], v[134:135], v[218:219]
    v_pk_mul_f32 v[102:103], v[142:143], v[218:219]
    v_pk_fma_f32 v[88:89], v[136:137], v[220:221], v[88:89] neg_lo:[1,0,0] neg_hi:[1,0,0]
    v_pk_fma_f32 v[96:97], v[128:129], v[220:221], v[96:97]
    v_pk_fma_f32 v[90:91], v[138:139], v[222:223], v[90:91] neg_lo:[1,0,0] neg_hi:[1,0,0]
    v_pk_fma_f32 v[98:99], v[130:131], v[222:223], v[98:99]
    v_pk_fma_f32 v[92:93], v[140:141], v[224:225], v[92:93] neg_lo:[1,0,0] neg_hi:[1,0,0]
    v_pk_fma_f32 v[100:101], v[132:133], v[224:225], v[100:101]
    v_pk_fma_f32 v[94:95], v[142:143], v[226:227], v[94:95] neg_lo:[1,0,0] neg_hi:[1,0,0]
    v_pk_fma_f32 v[102:103], v[134:135], v[226:227], v[102:103]
    v_cvt_pk_bf16_f32 v228, v88, v89
    v_cvt_pk_bf16_f32 v232, v96, v97
    v_cvt_pk_bf16_f32 v229, v90, v91
    v_cvt_pk_bf16_f32 v233, v98, v99
    v_cvt_pk_bf16_f32 v230, v92, v93
    v_cvt_pk_bf16_f32 v234, v100, v101
    v_cvt_pk_bf16_f32 v231, v94, v95
    v_cvt_pk_bf16_f32 v235, v102, v103
    s_nop 0
    v_mfma_f32_16x16x32_bf16 v[128:131], v[228:231], v[32:35], 0
    v_mfma_f32_16x16x32_bf16 v[136:139], v[232:235], v[32:35], 0
    v_mfma_f32_16x16x32_bf16 v[132:135], v[228:231], v[36:39], 0
    v_mfma_f32_16x16x32_bf16 v[140:143], v[232:235], v[36:39], 0
    v_mfma_f32_16x16x32_bf16 v[128:131], v[232:235], v[48:51], v[128:131]
    v_mfma_f32_16x16x32_bf16 v[136:139], v[228:231], v[40:43], v[136:139]
    v_mfma_f32_16x16x32_bf16 v[132:135], v[232:235], v[52:55], v[132:135]
    v_mfma_f32_16x16x32_bf16 v[140:143], v[228:231], v[44:47], v[140:143]
    s_nop 4
    v_pk_mul_f32 v[88:89], v[128:129], v[72:73]
    v_pk_mul_f32 v[96:97], v[136:137], v[72:73]
    v_pk_mul_f32 v[90:91], v[130:131], v[74:75]
    v_pk_mul_f32 v[98:99], v[138:139], v[74:75]
    v_pk_mul_f32 v[92:93], v[132:133], v[76:77]
    v_pk_mul_f32 v[100:101], v[140:141], v[76:77]
    v_pk_mul_f32 v[94:95], v[134:135], v[78:79]
    v_pk_mul_f32 v[102:103], v[142:143], v[78:79]
    v_pk_fma_f32 v[88:89], v[136:137], v[80:81], v[88:89] neg_lo:[1,0,0] neg_hi:[1,0,0]
    v_pk_fma_f32 v[96:97], v[128:129], v[80:81], v[96:97]
    v_pk_fma_f32 v[90:91], v[138:139], v[82:83], v[90:91] neg_lo:[1,0,0] neg_hi:[1,0,0]
    v_pk_fma_f32 v[98:99], v[130:131], v[82:83], v[98:99]
    v_pk_fma_f32 v[92:93], v[140:141], v[84:85], v[92:93] neg_lo:[1,0,0] neg_hi:[1,0,0]
    v_pk_fma_f32 v[100:101], v[132:133], v[84:85], v[100:101]
    v_pk_fma_f32 v[94:95], v[142:143], v[86:87], v[94:95] neg_lo:[1,0,0] neg_hi:[1,0,0]
    v_pk_fma_f32 v[102:103], v[134:135], v[86:87], v[102:103]
    v_cvt_pk_bf16_f32 v228, v88, v89
    v_cvt_pk_bf16_f32 v232, v96, v97
    v_cvt_pk_bf16_f32 v229, v90, v91
    v_cvt_pk_bf16_f32 v233, v98, v99
    v_cvt_pk_bf16_f32 v230, v92, v93
    v_cvt_pk_bf16_f32 v234, v100, v101
    v_cvt_pk_bf16_f32 v231, v94, v95
    v_cvt_pk_bf16_f32 v235, v102, v103
    ds_write_b64 v208, v[228:229] offset:9216
    ds_write_b64 v208, v[232:233] offset:13824
    ds_write_b64 v208, v[230:231] offset:11520
    ds_write_b64 v208, v[234:235] offset:16128
    s_waitcnt lgkmcnt(0)
    s_barrier
    ds_read_b128 v[160:163], v207 offset:9216
    ds_read_b128 v[168:171], v207 offset:11520
    ds_read_b128 v[176:179], v207 offset:13824
    ds_read_b128 v[184:187], v207 offset:16128
    ds_read_b128 v[164:167], v207 offset:9280
    ds_read_b128 v[172:175], v207 offset:11584
    ds_read_b128 v[180:183], v207 offset:13888
    ds_read_b128 v[188:191], v207 offset:16192
    s_waitcnt lgkmcnt(4)
    v_mfma_f32_16x16x32_bf16 v[212:215], v[8:11], v[160:163], 0
    v_mfma_f32_16x16x32_bf16 v[220:223], v[8:11], v[176:179], 0
    v_mfma_f32_16x16x32_bf16 v[216:219], v[8:11], v[168:171], 0
    v_mfma_f32_16x16x32_bf16 v[224:227], v[8:11], v[184:187], 0
    v_mfma_f32_16x16x32_bf16 v[212:215], v[24:27], v[176:179], v[212:215]
    v_mfma_f32_16x16x32_bf16 v[220:223], v[16:19], v[160:163], v[220:223]
    v_mfma_f32_16x16x32_bf16 v[216:219], v[24:27], v[184:187], v[216:219]
    v_mfma_f32_16x16x32_bf16 v[224:227], v[16:19], v[168:171], v[224:227]
    s_waitcnt lgkmcnt(0)
    v_mfma_f32_16x16x32_bf16 v[212:215], v[12:15], v[164:167], v[212:215]
    v_mfma_f32_16x16x32_bf16 v[220:223], v[12:15], v[180:183], v[220:223]
    v_mfma_f32_16x16x32_bf16 v[216:219], v[12:15], v[172:175], v[216:219]
    v_mfma_f32_16x16x32_bf16 v[224:227], v[12:15], v[188:191], v[224:227]
    v_mfma_f32_16x16x32_bf16 v[212:215], v[28:31], v[180:183], v[212:215]
    v_mfma_f32_16x16x32_bf16 v[220:223], v[20:23], v[164:167], v[220:223]
    v_mfma_f32_16x16x32_bf16 v[216:219], v[28:31], v[188:191], v[216:219]
    v_mfma_f32_16x16x32_bf16 v[224:227], v[20:23], v[172:175], v[224:227]
    v_mul_u32_u24 v236, 272, v4
    v_lshl_add_u32 v236, v5, 4, v236
    s_lshl_b32 s24, s20, 6
    v_add_u32 v236, s24, v236
    s_nop 0
    ds_write_b128 v236, v[212:215] offset:18432
    s_nop 0
    ds_write_b128 v236, v[216:219] offset:22784
    ds_write_b128 v236, v[220:223] offset:27136
    ds_write_b128 v236, v[224:227] offset:31488
    s_waitcnt lgkmcnt(0)
    s_barrier
    v_lshrrev_b32 v6, 2, v1
    v_and_b32 v6, 1, v6
    s_cmp_eq_u32 s2, 0
    s_cselect_b32 s24, 1, 0
    v_xor_b32 v237, s24, v6
    v_cmp_eq_u32 vcc, 0, v237
    v_mov_b32 v238, s30
    s_nop 0
    v_cndmask_b32 v238, v238, 1.0, vcc
    v_mul_u32_u24 v236, 8704, v237
    v_lshrrev_b32 v6, 4, v1
    s_lshl_b32 s24, s20, 3
    v_add_u32 v6, s24, v6
    v_mul_u32_u24 v6, 272, v6
    v_add_u32 v236, v236, v6
    v_lshrrev_b32 v6, 3, v1
    v_and_b32 v6, 1, v6
    v_lshl_add_u32 v236, v6, 7, v236
    v_and_b32 v6, 3, v1
    v_lshl_add_u32 v236, v6, 5, v236
    ds_read_b128 v[144:147], v236 offset:18432
    ds_read_b128 v[148:151], v236 offset:18448
    ds_read_b128 v[152:155], v236 offset:19520
    ds_read_b128 v[156:159], v236 offset:19536
    s_add_u32 s8, s82, 0x200000
    s_addc_u32 s9, s83, 0
    s_mov_b32 s10, 0x200000
    s_mov_b32 s11, 0x00020000
    v_lshlrev_b32 v88, 16, v192
    v_and_b32 v89, 0xffff0000, v192
    v_lshlrev_b32 v90, 16, v193
    v_and_b32 v91, 0xffff0000, v193
    v_lshlrev_b32 v92, 16, v194
    v_and_b32 v93, 0xffff0000, v194
    v_lshlrev_b32 v94, 16, v195
    v_and_b32 v95, 0xffff0000, v195
    s_waitcnt lgkmcnt(2)
    v_fma_f32 v88, v144, v238, v88
    v_fma_f32 v89, v145, v238, v89
    v_fma_f32 v90, v146, v238, v90
    v_fma_f32 v91, v147, v238, v91
    v_fma_f32 v92, v148, v238, v92
    v_fma_f32 v93, v149, v238, v93
    v_fma_f32 v94, v150, v238, v94
    v_fma_f32 v95, v151, v238, v95
    v_cvt_pk_bf16_f32 v96, v88, v89
    v_cvt_pk_bf16_f32 v97, v90, v91
    v_cvt_pk_bf16_f32 v98, v92, v93
    v_cvt_pk_bf16_f32 v99, v94, v95
    buffer_store_dwordx4 v[96:99], v202, s[8:11], s23 offen sc1
    v_lshlrev_b32 v88, 16, v196
    v_and_b32 v89, 0xffff0000, v196
    v_lshlrev_b32 v90, 16, v197
    v_and_b32 v91, 0xffff0000, v197
    v_lshlrev_b32 v92, 16, v198
    v_and_b32 v93, 0xffff0000, v198
    v_lshlrev_b32 v94, 16, v199
    v_and_b32 v95, 0xffff0000, v199
    s_waitcnt lgkmcnt(0)
    v_fma_f32 v88, v152, v238, v88
    v_fma_f32 v89, v153, v238, v89
    v_fma_f32 v90, v154, v238, v90
    v_fma_f32 v91, v155, v238, v91
    v_fma_f32 v92, v156, v238, v92
    v_fma_f32 v93, v157, v238, v93
    v_fma_f32 v94, v158, v238, v94
    v_fma_f32 v95, v159, v238, v95
    v_cvt_pk_bf16_f32 v100, v88, v89
    v_cvt_pk_bf16_f32 v101, v90, v91
    v_cvt_pk_bf16_f32 v102, v92, v93
    v_cvt_pk_bf16_f32 v103, v94, v95
    s_add_u32 s24, s23, 262144
    buffer_store_dwordx4 v[100:103], v202, s[8:11], s24 offen sc1
    s_cmp_lg_u32 s20, 0
    s_cbranch_scc1 L_wt_31
    s_add_u32 s4, s82, 0x1f00004
    s_addc_u32 s5, s83, 0
    s_mov_b32 s6, 0x4ffc
    s_mov_b32 s7, 0x00020000
    s_and_b32 s24, s22, 15
    s_lshl_b32 s24, s24, 3
    v_add_u32 v250, s24, v1
    v_lshlrev_b32 v250, 7, v250
    s_mov_b64 exec, 0xff
    s_mov_b32 s31, 0
L_poll_32:
    buffer_load_dword v251, v250, s[4:7], 0 offen sc0 sc1
    s_add_u32 s31, s31, 1
    s_waitcnt vmcnt(0)
    v_cmp_le_u32 vcc, 0x80, v251
    s_nop 0
    s_cmp_eq_u64 vcc, exec
    s_nop 1
    s_cbranch_scc1 L_polld_33
    s_cmp_lt_u32 s31, 1048576
    s_cbranch_scc1 L_poll_32
L_polld_33:
    s_mov_b64 exec, -1
L_wt_31:
    s_barrier
    s_add_u32 s4, s82, 0x1f00000
    s_addc_u32 s5, s83, 0
    s_mov_b32 s6, 0x5000
    s_mov_b32 s7, 0x00020000
    v_lshlrev_b32 v250, 3, v1
    v_add_u32 v250, s21, v250
    v_lshlrev_b32 v250, 7, v250
    v_mov_b32 v251, 1
    s_waitcnt vmcnt(0) lgkmcnt(0)
    s_barrier
    s_cmp_lg_u32 s20, 0
    s_cbranch_scc1 L_arr_34
    s_mov_b64 exec, 0xffff
    buffer_atomic_add v251, v250, s[4:7], 0 offen offset:8 sc1
    s_mov_b64 exec, -1
L_arr_34:
    s_add_u32 s16, s82, 0x1500000
    s_addc_u32 s17, s83, 0
    s_mov_b32 s18, 0x2b0000
    s_mov_b32 s19, 0x00020000
    v_lshlrev_b32 v104, 4, v1
    s_add_u32 s60, s20, 0
    s_and_b32 s60, s60, 3
    s_lshl_b32 s60, s60, 13
    s_lshl_b32 s61, s34, 16
    s_add_u32 s61, s61, s60
    s_add_u32 s60, s61, 0
    buffer_load_dwordx4 a[0:3], v104, s[16:19], s60 offen offset:0
    s_add_u32 s60, s61, 32768
    buffer_load_dwordx4 a[4:7], v104, s[16:19], s60 offen offset:0
    s_add_u32 s60, s61, 0
    buffer_load_dwordx4 a[8:11], v104, s[16:19], s60 offen offset:1024
    s_add_u32 s60, s61, 32768
    buffer_load_dwordx4 a[12:15], v104, s[16:19], s60 offen offset:1024
    s_add_u32 s60, s61, 0
    buffer_load_dwordx4 a[16:19], v104, s[16:19], s60 offen offset:2048
    s_add_u32 s60, s61, 32768
    buffer_load_dwordx4 a[20:23], v104, s[16:19], s60 offen offset:2048
    s_add_u32 s60, s61, 0
    buffer_load_dwordx4 a[24:27], v104, s[16:19], s60 offen offset:3072
    s_add_u32 s60, s61, 32768
    buffer_load_dwordx4 a[28:31], v104, s[16:19], s60 offen offset:3072
    s_add_u32 s60, s61, 4096
    buffer_load_dwordx4 a[32:35], v104, s[16:19], s60 offen offset:0
    s_add_u32 s60, s61, 36864
    buffer_load_dwordx4 a[36:39], v104, s[16:19], s60 offen offset:0
    s_add_u32 s60, s61, 4096
    buffer_load_dwordx4 a[40:43], v104, s[16:19], s60 offen offset:1024
    s_add_u32 s60, s61, 36864
    buffer_load_dwordx4 a[44:47], v104, s[16:19], s60 offen offset:1024
    s_add_u32 s60, s61, 4096
    buffer_load_dwordx4 a[48:51], v104, s[16:19], s60 offen offset:2048
    s_add_u32 s60, s61, 36864
    buffer_load_dwordx4 a[52:55], v104, s[16:19], s60 offen offset:2048
    s_add_u32 s60, s61, 4096
    buffer_load_dwordx4 a[56:59], v104, s[16:19], s60 offen offset:3072
    s_add_u32 s60, s61, 36864
    buffer_load_dwordx4 a[60:63], v104, s[16:19], s60 offen offset:3072
    s_add_u32 s60, s20, 1
    s_and_b32 s60, s60, 3
    s_lshl_b32 s60, s60, 13
    s_lshl_b32 s61, s34, 16
    s_add_u32 s61, s61, s60
    s_add_u32 s60, s61, 0
    buffer_load_dwordx4 a[64:67], v104, s[16:19], s60 offen offset:0
    s_add_u32 s60, s61, 32768
    buffer_load_dwordx4 a[68:71], v104, s[16:19], s60 offen offset:0
    s_add_u32 s60, s61, 0
    buffer_load_dwordx4 a[72:75], v104, s[16:19], s60 offen offset:1024
    s_add_u32 s60, s61, 32768
    buffer_load_dwordx4 a[76:79], v104, s[16:19], s60 offen offset:1024
    s_add_u32 s60, s61, 0
    buffer_load_dwordx4 a[80:83], v104, s[16:19], s60 offen offset:2048
    s_add_u32 s60, s61, 32768
    buffer_load_dwordx4 a[84:87], v104, s[16:19], s60 offen offset:2048
    s_add_u32 s60, s61, 0
    buffer_load_dwordx4 a[88:91], v104, s[16:19], s60 offen offset:3072
    s_add_u32 s60, s61, 32768
    buffer_load_dwordx4 a[92:95], v104, s[16:19], s60 offen offset:3072
    s_add_u32 s60, s61, 4096
    buffer_load_dwordx4 a[96:99], v104, s[16:19], s60 offen offset:0
    s_add_u32 s60, s61, 36864
    buffer_load_dwordx4 a[100:103], v104, s[16:19], s60 offen offset:0
    s_add_u32 s60, s61, 4096
    buffer_load_dwordx4 a[104:107], v104, s[16:19], s60 offen offset:1024
    s_add_u32 s60, s61, 36864
    buffer_load_dwordx4 a[108:111], v104, s[16:19], s60 offen offset:1024
    s_add_u32 s60, s61, 4096
    buffer_load_dwordx4 a[112:115], v104, s[16:19], s60 offen offset:2048
    s_add_u32 s60, s61, 36864
    buffer_load_dwordx4 a[116:119], v104, s[16:19], s60 offen offset:2048
    s_add_u32 s60, s61, 4096
    buffer_load_dwordx4 a[120:123], v104, s[16:19], s60 offen offset:3072
    s_add_u32 s60, s61, 36864
    buffer_load_dwordx4 a[124:127], v104, s[16:19], s60 offen offset:3072
    s_add_u32 s60, s20, 2
    s_and_b32 s60, s60, 3
    s_lshl_b32 s60, s60, 13
    s_lshl_b32 s61, s34, 16
    s_add_u32 s61, s61, s60
    s_add_u32 s60, s61, 0
    buffer_load_dwordx4 a[128:131], v104, s[16:19], s60 offen offset:0
    s_add_u32 s60, s61, 32768
    buffer_load_dwordx4 a[132:135], v104, s[16:19], s60 offen offset:0
    s_add_u32 s60, s61, 0
    buffer_load_dwordx4 a[136:139], v104, s[16:19], s60 offen offset:1024
    s_add_u32 s60, s61, 32768
    buffer_load_dwordx4 a[140:143], v104, s[16:19], s60 offen offset:1024
    s_add_u32 s60, s61, 0
    buffer_load_dwordx4 a[144:147], v104, s[16:19], s60 offen offset:2048
    s_add_u32 s60, s61, 32768
    buffer_load_dwordx4 a[148:151], v104, s[16:19], s60 offen offset:2048
    s_add_u32 s60, s61, 0
    buffer_load_dwordx4 a[152:155], v104, s[16:19], s60 offen offset:3072
    s_add_u32 s60, s61, 32768
    buffer_load_dwordx4 a[156:159], v104, s[16:19], s60 offen offset:3072
    s_add_u32 s60, s61, 4096
    buffer_load_dwordx4 a[160:163], v104, s[16:19], s60 offen offset:0
    s_add_u32 s60, s61, 36864
    buffer_load_dwordx4 a[164:167], v104, s[16:19], s60 offen offset:0
    s_add_u32 s60, s61, 4096
    buffer_load_dwordx4 a[168:171], v104, s[16:19], s60 offen offset:1024
    s_add_u32 s60, s61, 36864
    buffer_load_dwordx4 a[172:175], v104, s[16:19], s60 offen offset:1024
    s_add_u32 s60, s61, 4096
    buffer_load_dwordx4 a[176:179], v104, s[16:19], s60 offen offset:2048
    s_add_u32 s60, s61, 36864
    buffer_load_dwordx4 a[180:183], v104, s[16:19], s60 offen offset:2048
    s_add_u32 s60, s61, 4096
    buffer_load_dwordx4 a[184:187], v104, s[16:19], s60 offen offset:3072
    s_add_u32 s60, s61, 36864
    buffer_load_dwordx4 a[188:191], v104, s[16:19], s60 offen offset:3072
    s_add_u32 s60, s20, 3
    s_and_b32 s60, s60, 3
    s_lshl_b32 s60, s60, 13
    s_lshl_b32 s61, s34, 16
    s_add_u32 s61, s61, s60
    s_add_u32 s60, s61, 0
    buffer_load_dwordx4 a[192:195], v104, s[16:19], s60 offen offset:0
    s_add_u32 s60, s61, 32768
    buffer_load_dwordx4 a[196:199], v104, s[16:19], s60 offen offset:0
    s_add_u32 s60, s61, 0
    buffer_load_dwordx4 a[200:203], v104, s[16:19], s60 offen offset:1024
    s_add_u32 s60, s61, 32768
    buffer_load_dwordx4 a[204:207], v104, s[16:19], s60 offen offset:1024
    s_add_u32 s60, s61, 0
    buffer_load_dwordx4 a[208:211], v104, s[16:19], s60 offen offset:2048
    s_add_u32 s60, s61, 32768
    buffer_load_dwordx4 a[212:215], v104, s[16:19], s60 offen offset:2048
    s_add_u32 s60, s61, 0
    buffer_load_dwordx4 a[216:219], v104, s[16:19], s60 offen offset:3072
    s_add_u32 s60, s61, 32768
    buffer_load_dwordx4 a[220:223], v104, s[16:19], s60 offen offset:3072
    s_add_u32 s60, s61, 4096
    buffer_load_dwordx4 a[224:227], v104, s[16:19], s60 offen offset:0
    s_add_u32 s60, s61, 36864
    buffer_load_dwordx4 a[228:231], v104, s[16:19], s60 offen offset:0
    s_add_u32 s60, s61, 4096
    buffer_load_dwordx4 a[232:235], v104, s[16:19], s60 offen offset:1024
    s_add_u32 s60, s61, 36864
    buffer_load_dwordx4 a[236:239], v104, s[16:19], s60 offen offset:1024
    s_add_u32 s60, s61, 4096
    buffer_load_dwordx4 a[240:243], v104, s[16:19], s60 offen offset:2048
    s_add_u32 s60, s61, 36864
    buffer_load_dwordx4 a[244:247], v104, s[16:19], s60 offen offset:2048
    s_add_u32 s60, s61, 4096
    buffer_load_dwordx4 a[248:251], v104, s[16:19], s60 offen offset:3072
    s_add_u32 s60, s61, 36864
    buffer_load_dwordx4 a[252:255], v104, s[16:19], s60 offen offset:3072
    s_cmp_eq_u32 s90, 1
    s_cbranch_scc1 L_g4skip_29
    s_cmp_eq_u32 s32, 21
    s_cselect_b32 s35, 1, 3
    v_lshlrev_b32 v8, 4, v1
    v_mov_b32 v7, v8
    s_mul_i32 s36, s32, 98304
    s_lshl_b32 s24, s20, 13
    s_add_u32 s36, s36, s24
    s_lshl_b32 s37, s20, 13
    v_and_b32 v5, 15, v1
    v_lshrrev_b32 v6, 2, v5
    v_lshl_add_u32 v6, v3, 2, v6
    v_lshlrev_b32 v6, 6, v6
    v_and_b32 v5, 3, v5
    v_lshl_add_u32 v6, v5, 3, v6
    v_lshrrev_b32 v5, 4, v1
    v_and_b32 v5, 1, v5
    v_lshl_add_u32 v6, v5, 5, v6
    s_add_u32 s24, s20, 0
    s_and_b32 s24, s24, 3
    s_lshl_b32 s24, s24, 13
    v_add_u32 v9, s24, v6
    s_add_u32 s24, s20, 1
    s_and_b32 s24, s24, 3
    s_lshl_b32 s24, s24, 13
    v_add_u32 v10, s24, v6
    s_add_u32 s24, s20, 2
    s_and_b32 s24, s24, 3
    s_lshl_b32 s24, s24, 13
    v_add_u32 v11, s24, v6
    s_add_u32 s24, s20, 3
    s_and_b32 s24, s24, 3
    s_lshl_b32 s24, s24, 13
    v_add_u32 v12, s24, v6
    v_cmp_eq_u32 vcc, 0, v3
    s_cmp_eq_u32 s20, 0
    s_cselect_b64 s[26:27], vcc, 0
    v_mov_b32 v5, 0xffff0000
    v_cndmask_b32 v13, -1, v5, s[26:27]
    v_lshlrev_b32 v5, 2, v3
    v_sub_u32 v5, v2, v5
    v_cmp_eq_u32 vcc, 0, v5
    s_nop 1
    v_cndmask_b32 v16, 0, 1.0, vcc
    v_cmp_eq_u32 vcc, 1, v5
    s_nop 1
    v_cndmask_b32 v17, 0, 1.0, vcc
    v_cmp_eq_u32 vcc, 2, v5
    s_nop 1
    v_cndmask_b32 v18, 0, 1.0, vcc
    v_cmp_eq_u32 vcc, 3, v5
    s_nop 1
    v_cndmask_b32 v19, 0, 1.0, vcc
    v_cmp_eq_u32 vcc, 8, v5
    s_nop 1
    v_cndmask_b32 v20, 0, 1.0, vcc
    v_cmp_eq_u32 vcc, 9, v5
    s_nop 1
    v_cndmask_b32 v21, 0, 1.0, vcc
    v_cmp_eq_u32 vcc, 10, v5
    s_nop 1
    v_cndmask_b32 v22, 0, 1.0, vcc
    v_cmp_eq_u32 vcc, 11, v5
    s_nop 1
    v_cndmask_b32 v23, 0, 1.0, vcc
    v_cmp_eq_u32 vcc, 16, v5
    s_nop 1
    v_cndmask_b32 v24, 0, 1.0, vcc
    v_cmp_eq_u32 vcc, 17, v5
    s_nop 1
    v_cndmask_b32 v25, 0, 1.0, vcc
    v_cmp_eq_u32 vcc, 18, v5
    s_nop 1
    v_cndmask_b32 v26, 0, 1.0, vcc
    v_cmp_eq_u32 vcc, 19, v5
    s_nop 1
    v_cndmask_b32 v27, 0, 1.0, vcc
    v_cmp_eq_u32 vcc, 24, v5
    s_nop 1
    v_cndmask_b32 v28, 0, 1.0, vcc
    v_cmp_eq_u32 vcc, 25, v5
    s_nop 1
    v_cndmask_b32 v29, 0, 1.0, vcc
    v_cmp_eq_u32 vcc, 26, v5
    s_nop 1
    v_cndmask_b32 v30, 0, 1.0, vcc
    v_cmp_eq_u32 vcc, 27, v5
    s_nop 1
    v_cndmask_b32 v31, 0, 1.0, vcc
    v_lshlrev_b32 v15, 5, v2
    v_add_u32 v15, 98304, v15
    v_lshl_add_u32 v14, v3, 2, v15
    s_lshl_b32 s24, s20, 3
    v_add_u32 v14, s24, v14
    s_mul_i32 s38, s32, 264192
    s_lshl_b32 s25, s34, 11
    s_add_u32 s38, s38, s25
    s_cmp_ge_u32 s34, 43
    s_cselect_b32 s25, 0x7f000000, 0
    s_add_u32 s38, s38, s25
    s_add_u32 s8, s82, 0x200000
    s_addc_u32 s9, s83, 0
    s_mov_b32 s10, 0x200000
    s_mov_b32 s11, 0x00020000
    s_add_u32 s12, s82, 0x800000
    s_addc_u32 s13, s83, 0
    s_mov_b32 s14, 0x560000
    s_mov_b32 s15, 0x00020000
    s_add_u32 s16, s82, 0x1800000
    s_addc_u32 s17, s83, 0
    s_mov_b32 s18, 0x158000
    s_mov_b32 s19, 0x00020000
    v_lshlrev_b32 v4, 4, v1
    s_mul_i32 s47, s41, 176128
    s_lshl_b32 s24, s42, 10
    s_add_u32 s47, s47, s24
    s_cmp_ge_u32 s20, 2
    s_cselect_b32 s48, 0x7f000000, 0
    s_add_u32 s48, s48, s47
    s_cmp_lg_u32 s20, 0
    s_cbranch_scc1 L_wt_35
    s_add_u32 s4, s82, 0x1f00008
    s_addc_u32 s5, s83, 0
    s_mov_b32 s6, 0x4ff8
    s_mov_b32 s7, 0x00020000
    s_and_b32 s24, s22, 15
    s_lshl_b32 s24, s24, 3
    v_add_u32 v250, s24, v1
    v_lshlrev_b32 v250, 7, v250
    s_mov_b64 exec, 0xff
    s_mov_b32 s31, 0
L_poll_36:
    buffer_load_dword v251, v250, s[4:7], 0 offen sc0 sc1
    s_add_u32 s31, s31, 1
    s_waitcnt vmcnt(0)
    v_cmp_le_u32 vcc, 0x20, v251
    s_nop 0
    s_cmp_eq_u64 vcc, exec
    s_nop 1
    s_cbranch_scc1 L_polld_37
    s_cmp_lt_u32 s31, 1048576
    s_cbranch_scc1 L_poll_36
L_polld_37:
    s_mov_b64 exec, -1
L_wt_35:
    s_barrier
    s_add_u32 m0, s37, 0
    s_add_u32 s39, s36, 0
    buffer_load_dwordx4 v7, s[8:11], s39 offen lds
    s_add_u32 m0, s37, 1024
    s_add_u32 s39, s36, 1024
    buffer_load_dwordx4 v7, s[8:11], s39 offen lds
    s_add_u32 m0, s37, 2048
    s_add_u32 s39, s36, 2048
    buffer_load_dwordx4 v7, s[8:11], s39 offen lds
    s_add_u32 m0, s37, 3072
    s_add_u32 s39, s36, 3072
    buffer_load_dwordx4 v7, s[8:11], s39 offen lds
    s_add_u32 m0, s37, 4096
    s_add_u32 s39, s36, 4096
    buffer_load_dwordx4 v7, s[8:11], s39 offen lds
    s_add_u32 m0, s37, 5120
    s_add_u32 s39, s36, 5120
    buffer_load_dwordx4 v7, s[8:11], s39 offen lds
    s_add_u32 m0, s37, 6144
    s_add_u32 s39, s36, 6144
    buffer_load_dwordx4 v7, s[8:11], s39 offen lds
    s_add_u32 m0, s37, 7168
    s_add_u32 s39, s36, 7168
    buffer_load_dwordx4 v7, s[8:11], s39 offen lds
    s_waitcnt vmcnt(4)
    ds_read_b64_tr_b16 v[32:33], v9 offset:0
    ds_read_b64_tr_b16 v[34:35], v9 offset:512
    ds_read_b64_tr_b16 v[36:37], v9 offset:1024
    ds_read_b64_tr_b16 v[38:39], v9 offset:1536
    ds_read_b64_tr_b16 v[40:41], v9 offset:2048
    ds_read_b64_tr_b16 v[42:43], v9 offset:2560
    ds_read_b64_tr_b16 v[44:45], v9 offset:3072
    ds_read_b64_tr_b16 v[46:47], v9 offset:3584
    s_waitcnt lgkmcnt(4)
    v_mfma_f32_32x32x16_bf16 v[52:67], a[0:3], v[32:35], 0
    s_waitcnt vmcnt(3)
    ds_read_b64_tr_b16 v[48:49], v9 offset:4096
    ds_read_b64_tr_b16 v[50:51], v9 offset:4608
    v_mfma_f32_32x32x16_bf16 v[68:83], a[4:7], v[32:35], 0
    v_and_b32 v168, v13, v32
    v_mov_b32 v169, v33
    v_mov_b32 v170, v34
    v_mov_b32 v171, v35
    s_nop 1
    v_mfma_f32_32x32x16_bf16 v[116:131], v[168:171], v[168:171], 0
    v_mfma_f32_32x32x16_bf16 v[52:67], a[8:11], v[36:39], v[52:67]
    s_waitcnt vmcnt(2)
    ds_read_b64_tr_b16 v[32:33], v9 offset:5120
    ds_read_b64_tr_b16 v[34:35], v9 offset:5632
    v_mfma_f32_32x32x16_bf16 v[68:83], a[12:15], v[36:39], v[68:83]
    v_mfma_f32_32x32x16_bf16 v[116:131], v[36:39], v[36:39], v[116:131]
    s_waitcnt lgkmcnt(4)
    v_mfma_f32_32x32x16_bf16 v[52:67], a[16:19], v[40:43], v[52:67]
    s_waitcnt vmcnt(1)
    ds_read_b64_tr_b16 v[36:37], v9 offset:6144
    ds_read_b64_tr_b16 v[38:39], v9 offset:6656
    v_mfma_f32_32x32x16_bf16 v[68:83], a[20:23], v[40:43], v[68:83]
    v_mfma_f32_32x32x16_bf16 v[116:131], v[40:43], v[40:43], v[116:131]
    v_mfma_f32_32x32x16_bf16 v[52:67], a[24:27], v[44:47], v[52:67]
    s_waitcnt vmcnt(0)
    ds_read_b64_tr_b16 v[40:41], v9 offset:7168
    ds_read_b64_tr_b16 v[42:43], v9 offset:7680
    v_mfma_f32_32x32x16_bf16 v[68:83], a[28:31], v[44:47], v[68:83]
    v_mfma_f32_32x32x16_bf16 v[116:131], v[44:47], v[44:47], v[116:131]
    s_waitcnt lgkmcnt(4)
    v_mfma_f32_32x32x16_bf16 v[52:67], a[32:35], v[48:51], v[52:67]
    s_barrier
    ds_read_b64_tr_b16 v[44:45], v10 offset:0
    ds_read_b64_tr_b16 v[46:47], v10 offset:512
    v_mfma_f32_32x32x16_bf16 v[68:83], a[36:39], v[48:51], v[68:83]
    s_add_u32 m0, s37, 32768
    s_add_u32 s39, s36, 32768
    buffer_load_dwordx4 v7, s[8:11], s39 offen lds
    v_mfma_f32_32x32x16_bf16 v[116:131], v[48:51], v[48:51], v[116:131]
    v_mfma_f32_32x32x16_bf16 v[52:67], a[40:43], v[32:35], v[52:67]
    ds_read_b64_tr_b16 v[48:49], v10 offset:1024
    ds_read_b64_tr_b16 v[50:51], v10 offset:1536
    v_mfma_f32_32x32x16_bf16 v[68:83], a[44:47], v[32:35], v[68:83]
    s_add_u32 m0, s37, 33792
    s_add_u32 s39, s36, 33792
    buffer_load_dwordx4 v7, s[8:11], s39 offen lds
    v_mfma_f32_32x32x16_bf16 v[116:131], v[32:35], v[32:35], v[116:131]
    s_waitcnt lgkmcnt(4)
    v_mfma_f32_32x32x16_bf16 v[52:67], a[48:51], v[36:39], v[52:67]
    ds_read_b64_tr_b16 v[32:33], v10 offset:2048
    ds_read_b64_tr_b16 v[34:35], v10 offset:2560
    v_mfma_f32_32x32x16_bf16 v[68:83], a[52:55], v[36:39], v[68:83]
    s_add_u32 m0, s37, 34816
    s_add_u32 s39, s36, 34816
    buffer_load_dwordx4 v7, s[8:11], s39 offen lds
    v_mfma_f32_32x32x16_bf16 v[116:131], v[36:39], v[36:39], v[116:131]
    v_mfma_f32_32x32x16_bf16 v[52:67], a[56:59], v[40:43], v[52:67]
    ds_read_b64_tr_b16 v[36:37], v10 offset:3072
    ds_read_b64_tr_b16 v[38:39], v10 offset:3584
    v_mfma_f32_32x32x16_bf16 v[68:83], a[60:63], v[40:43], v[68:83]
    s_add_u32 m0, s37, 35840
    s_add_u32 s39, s36, 35840
    buffer_load_dwordx4 v7, s[8:11], s39 offen lds
    v_mfma_f32_32x32x16_bf16 v[116:131], v[40:43], v[40:43], v[116:131]
    s_waitcnt lgkmcnt(4)
    v_mfma_f32_32x32x16_bf16 v[52:67], a[64:67], v[44:47], v[52:67]
    ds_read_b64_tr_b16 v[40:41], v10 offset:4096
    ds_read_b64_tr_b16 v[42:43], v10 offset:4608
    v_mfma_f32_32x32x16_bf16 v[68:83], a[68:71], v[44:47], v[68:83]
    s_add_u32 m0, s37, 36864
    s_add_u32 s39, s36, 36864
    buffer_load_dwordx4 v7, s[8:11], s39 offen lds
    v_mfma_f32_32x32x16_bf16 v[52:67], a[72:75], v[48:51], v[52:67]
    ds_read_b64_tr_b16 v[44:45], v10 offset:5120
    ds_read_b64_tr_b16 v[46:47], v10 offset:5632
    v_mfma_f32_32x32x16_bf16 v[68:83], a[76:79], v[48:51], v[68:83]
    s_add_u32 m0, s37, 37888
    s_add_u32 s39, s36, 37888
    buffer_load_dwordx4 v7, s[8:11], s39 offen lds
    s_waitcnt lgkmcnt(4)
    v_mfma_f32_32x32x16_bf16 v[52:67], a[80:83], v[32:35], v[52:67]
    ds_read_b64_tr_b16 v[48:49], v10 offset:6144
    ds_read_b64_tr_b16 v[50:51], v10 offset:6656
    v_mfma_f32_32x32x16_bf16 v[68:83], a[84:87], v[32:35], v[68:83]
    s_add_u32 m0, s37, 38912
    s_add_u32 s39, s36, 38912
    buffer_load_dwordx4 v7, s[8:11], s39 offen lds
    v_mul_f32 v132, v116, v16
    v_mul_f32 v133, v117, v17
    v_fmac_f32 v132, v118, v18
    v_fmac_f32 v133, v119, v19
    v_fmac_f32 v132, v120, v20
    v_fmac_f32 v133, v121, v21
    v_fmac_f32 v132, v122, v22
    v_fmac_f32 v133, v123, v23
    v_fmac_f32 v132, v124, v24
    v_fmac_f32 v133, v125, v25
    v_fmac_f32 v132, v126, v26
    v_fmac_f32 v133, v127, v27
    v_fmac_f32 v132, v128, v28
    v_fmac_f32 v133, v129, v29
    v_fmac_f32 v132, v130, v30
    v_fmac_f32 v133, v131, v31
    v_add_f32 v132, v132, v133
    ds_write_b32 v14, v132 offset:0
    v_mfma_f32_32x32x16_bf16 v[52:67], a[88:91], v[36:39], v[52:67]
    ds_read_b64_tr_b16 v[32:33], v10 offset:7168
    ds_read_b64_tr_b16 v[34:35], v10 offset:7680
    v_mfma_f32_32x32x16_bf16 v[68:83], a[92:95], v[36:39], v[68:83]
    s_add_u32 m0, s37, 39936
    s_add_u32 s39, s36, 39936
    buffer_load_dwordx4 v7, s[8:11], s39 offen lds
    s_waitcnt lgkmcnt(5)
    v_mfma_f32_32x32x16_bf16 v[52:67], a[96:99], v[40:43], v[52:67]
    ds_read_b64_tr_b16 v[36:37], v11 offset:0
    ds_read_b64_tr_b16 v[38:39], v11 offset:512
    v_mfma_f32_32x32x16_bf16 v[68:83], a[100:103], v[40:43], v[68:83]
    s_add_u32 m0, s37, 65536
    s_add_u32 s39, s36, 65536
    buffer_load_dwordx4 v7, s[8:11], s39 offen lds
    v_mfma_f32_32x32x16_bf16 v[52:67], a[104:107], v[44:47], v[52:67]
    ds_read_b64_tr_b16 v[40:41], v11 offset:1024
    ds_read_b64_tr_b16 v[42:43], v11 offset:1536
    v_mfma_f32_32x32x16_bf16 v[68:83], a[108:111], v[44:47], v[68:83]
    s_add_u32 m0, s37, 66560
    s_add_u32 s39, s36, 66560
    buffer_load_dwordx4 v7, s[8:11], s39 offen lds
    s_waitcnt lgkmcnt(4)
    v_mfma_f32_32x32x16_bf16 v[52:67], a[112:115], v[48:51], v[52:67]
    ds_read_b64_tr_b16 v[44:45], v11 offset:2048
    ds_read_b64_tr_b16 v[46:47], v11 offset:2560
    v_mfma_f32_32x32x16_bf16 v[68:83], a[116:119], v[48:51], v[68:83]
    s_add_u32 m0, s37, 67584
    s_add_u32 s39, s36, 67584
    buffer_load_dwordx4 v7, s[8:11], s39 offen lds
    v_mfma_f32_32x32x16_bf16 v[52:67], a[120:123], v[32:35], v[52:67]
    ds_read_b64_tr_b16 v[48:49], v11 offset:3072
    ds_read_b64_tr_b16 v[50:51], v11 offset:3584
    v_mfma_f32_32x32x16_bf16 v[68:83], a[124:127], v[32:35], v[68:83]
    s_add_u32 m0, s37, 68608
    s_add_u32 s39, s36, 68608
    buffer_load_dwordx4 v7, s[8:11], s39 offen lds
    s_waitcnt lgkmcnt(4)
    v_mfma_f32_32x32x16_bf16 v[52:67], a[128:131], v[36:39], v[52:67]
    ds_read_b64_tr_b16 v[32:33], v11 offset:4096
    ds_read_b64_tr_b16 v[34:35], v11 offset:4608
    v_mfma_f32_32x32x16_bf16 v[68:83], a[132:135], v[36:39], v[68:83]
    s_add_u32 m0, s37, 69632
    s_add_u32 s39, s36, 69632
    buffer_load_dwordx4 v7, s[8:11], s39 offen lds
    v_mfma_f32_32x32x16_bf16 v[52:67], a[136:139], v[40:43], v[52:67]
    ds_read_b64_tr_b16 v[36:37], v11 offset:5120
    ds_read_b64_tr_b16 v[38:39], v11 offset:5632
    v_mfma_f32_32x32x16_bf16 v[68:83], a[140:143], v[40:43], v[68:83]
    s_add_u32 m0, s37, 70656
    s_add_u32 s39, s36, 70656
    buffer_load_dwordx4 v7, s[8:11], s39 offen lds
    s_waitcnt lgkmcnt(4)
    v_mfma_f32_32x32x16_bf16 v[52:67], a[144:147], v[44:47], v[52:67]
    ds_read_b64_tr_b16 v[40:41], v11 offset:6144
    ds_read_b64_tr_b16 v[42:43], v11 offset:6656
    v_mfma_f32_32x32x16_bf16 v[68:83], a[148:151], v[44:47], v[68:83]
    s_add_u32 m0, s37, 71680
    s_add_u32 s39, s36, 71680
    buffer_load_dwordx4 v7, s[8:11], s39 offen lds
    v_mfma_f32_32x32x16_bf16 v[52:67], a[152:155], v[48:51], v[52:67]
    ds_read_b64_tr_b16 v[44:45], v11 offset:7168
    ds_read_b64_tr_b16 v[46:47], v11 offset:7680
    v_mfma_f32_32x32x16_bf16 v[68:83], a[156:159], v[48:51], v[68:83]
    s_add_u32 m0, s37, 72704
    s_add_u32 s39, s36, 72704
    buffer_load_dwordx4 v7, s[8:11], s39 offen lds
    s_waitcnt lgkmcnt(4)
    v_mfma_f32_32x32x16_bf16 v[52:67], a[160:163], v[32:35], v[52:67]
    ds_read_b64_tr_b16 v[48:49], v12 offset:0
    ds_read_b64_tr_b16 v[50:51], v12 offset:512
    v_mfma_f32_32x32x16_bf16 v[68:83], a[164:167], v[32:35], v[68:83]
    v_mfma_f32_32x32x16_bf16 v[52:67], a[168:171], v[36:39], v[52:67]
    ds_read_b64_tr_b16 v[32:33], v12 offset:1024
    ds_read_b64_tr_b16 v[34:35], v12 offset:1536
    v_mfma_f32_32x32x16_bf16 v[68:83], a[172:175], v[36:39], v[68:83]
    s_waitcnt lgkmcnt(4)
    v_mfma_f32_32x32x16_bf16 v[52:67], a[176:179], v[40:43], v[52:67]
    ds_read_b64_tr_b16 v[36:37], v12 offset:2048
    ds_read_b64_tr_b16 v[38:39], v12 offset:2560
    v_mfma_f32_32x32x16_bf16 v[68:83], a[180:183], v[40:43], v[68:83]
    v_mfma_f32_32x32x16_bf16 v[52:67], a[184:187], v[44:47], v[52:67]
    ds_read_b64_tr_b16 v[40:41], v12 offset:3072
    ds_read_b64_tr_b16 v[42:43], v12 offset:3584
    v_mfma_f32_32x32x16_bf16 v[68:83], a[188:191], v[44:47], v[68:83]
    s_waitcnt lgkmcnt(4)
    v_mfma_f32_32x32x16_bf16 v[52:67], a[192:195], v[48:51], v[52:67]
    ds_read_b64_tr_b16 v[44:45], v12 offset:4096
    ds_read_b64_tr_b16 v[46:47], v12 offset:4608
    v_mfma_f32_32x32x16_bf16 v[68:83], a[196:199], v[48:51], v[68:83]
    v_mfma_f32_32x32x16_bf16 v[52:67], a[200:203], v[32:35], v[52:67]
    ds_read_b64_tr_b16 v[48:49], v12 offset:5120
    ds_read_b64_tr_b16 v[50:51], v12 offset:5632
    v_mfma_f32_32x32x16_bf16 v[68:83], a[204:207], v[32:35], v[68:83]
    s_waitcnt lgkmcnt(4)
    v_mfma_f32_32x32x16_bf16 v[52:67], a[208:211], v[36:39], v[52:67]
    ds_read_b64_tr_b16 v[32:33], v12 offset:6144
    ds_read_b64_tr_b16 v[34:35], v12 offset:6656
    v_mfma_f32_32x32x16_bf16 v[68:83], a[212:215], v[36:39], v[68:83]
    v_mfma_f32_32x32x16_bf16 v[52:67], a[216:219], v[40:43], v[52:67]
    ds_read_b64_tr_b16 v[36:37], v12 offset:7168
    ds_read_b64_tr_b16 v[38:39], v12 offset:7680
    v_mfma_f32_32x32x16_bf16 v[68:83], a[220:223], v[40:43], v[68:83]
    s_waitcnt vmcnt(8)
    s_barrier
    s_waitcnt lgkmcnt(4)
    v_mfma_f32_32x32x16_bf16 v[52:67], a[224:227], v[44:47], v[52:67]
    ds_read_b64_tr_b16 v[40:41], v9 offset:32768
    ds_read_b64_tr_b16 v[42:43], v9 offset:33280
    v_mfma_f32_32x32x16_bf16 v[68:83], a[228:231], v[44:47], v[68:83]
    v_mfma_f32_32x32x16_bf16 v[52:67], a[232:235], v[48:51], v[52:67]
    ds_read_b64_tr_b16 v[44:45], v9 offset:33792
    ds_read_b64_tr_b16 v[46:47], v9 offset:34304
    v_mfma_f32_32x32x16_bf16 v[68:83], a[236:239], v[48:51], v[68:83]
    s_waitcnt lgkmcnt(4)
    v_mfma_f32_32x32x16_bf16 v[52:67], a[240:243], v[32:35], v[52:67]
    ds_read_b64_tr_b16 v[48:49], v9 offset:34816
    ds_read_b64_tr_b16 v[50:51], v9 offset:35328
    v_mfma_f32_32x32x16_bf16 v[68:83], a[244:247], v[32:35], v[68:83]
    v_mfma_f32_32x32x16_bf16 v[52:67], a[248:251], v[36:39], v[52:67]
    ds_read_b64_tr_b16 v[32:33], v9 offset:35840
    ds_read_b64_tr_b16 v[34:35], v9 offset:36352
    v_mfma_f32_32x32x16_bf16 v[68:83], a[252:255], v[36:39], v[68:83]
    s_cmp_eq_u32 s35, 1
    s_nop 9
    s_cbranch_scc1 L_g4_done_39_1
    s_waitcnt lgkmcnt(4)
    v_mfma_f32_32x32x16_bf16 v[84:99], a[0:3], v[40:43], 0
    ds_read_b64_tr_b16 v[36:37], v9 offset:36864
    ds_read_b64_tr_b16 v[38:39], v9 offset:37376
    v_mfma_f32_32x32x16_bf16 v[100:115], a[4:7], v[40:43], 0
    v_and_b32 v168, v13, v40
    v_mov_b32 v169, v41
    v_mov_b32 v170, v42
    v_mov_b32 v171, v43
    s_nop 1
    v_mfma_f32_32x32x16_bf16 v[116:131], v[168:171], v[168:171], 0
    v_mfma_f32_32x32x16_bf16 v[84:99], a[8:11], v[44:47], v[84:99]
    ds_read_b64_tr_b16 v[40:41], v9 offset:37888
    ds_read_b64_tr_b16 v[42:43], v9 offset:38400
    v_mfma_f32_32x32x16_bf16 v[100:115], a[12:15], v[44:47], v[100:115]
    v_mfma_f32_32x32x16_bf16 v[116:131], v[44:47], v[44:47], v[116:131]
    s_waitcnt lgkmcnt(4)
    v_mfma_f32_32x32x16_bf16 v[84:99], a[16:19], v[48:51], v[84:99]
    ds_read_b64_tr_b16 v[44:45], v9 offset:38912
    ds_read_b64_tr_b16 v[46:47], v9 offset:39424
    ds_read_b128 v[144:147], v15 offset:0
    ds_read_b128 v[148:151], v15 offset:16
    v_mfma_f32_32x32x16_bf16 v[100:115], a[20:23], v[48:51], v[100:115]
    v_mfma_f32_32x32x16_bf16 v[116:131], v[48:51], v[48:51], v[116:131]
    v_mfma_f32_32x32x16_bf16 v[84:99], a[24:27], v[32:35], v[84:99]
    ds_read_b64_tr_b16 v[48:49], v9 offset:39936
    ds_read_b64_tr_b16 v[50:51], v9 offset:40448
    v_mfma_f32_32x32x16_bf16 v[100:115], a[28:31], v[32:35], v[100:115]
    s_waitcnt lgkmcnt(2)
    v_mfma_f32_32x32x16_bf16 v[116:131], v[32:35], v[32:35], v[116:131]
    s_waitcnt lgkmcnt(6)
    v_mfma_f32_32x32x16_bf16 v[84:99], a[32:35], v[36:39], v[84:99]
    ds_read_b64_tr_b16 v[32:33], v10 offset:32768
    ds_read_b64_tr_b16 v[34:35], v10 offset:33280
    v_add_f32 v144, v144, v148
    v_add_f32 v145, v145, v149
    v_add_f32 v146, v146, v150
    v_mfma_f32_32x32x16_bf16 v[100:115], a[36:39], v[36:39], v[100:115]
    v_add_f32 v147, v147, v151
    v_add_f32 v144, v144, v145
    v_add_f32 v146, v146, v147
    v_mfma_f32_32x32x16_bf16 v[116:131], v[36:39], v[36:39], v[116:131]
    v_mfma_f32_32x32x16_bf16 v[84:99], a[40:43], v[40:43], v[84:99]
    ds_read_b64_tr_b16 v[36:37], v10 offset:33792
    ds_read_b64_tr_b16 v[38:39], v10 offset:34304
    v_add_f32 v144, v144, v146
    v_mul_f32 v144, 0x3b000000, v144
    v_add_f32 v140, 0x3727c5ac, v144
    v_mfma_f32_32x32x16_bf16 v[100:115], a[44:47], v[40:43], v[100:115]
    v_rsq_f32 v145, v140
    s_nop 0
    v_mul_f32 v136, 0xc0135761, v145
    v_mfma_f32_32x32x16_bf16 v[116:131], v[40:43], v[40:43], v[116:131]
    s_waitcnt lgkmcnt(4)
    v_mfma_f32_32x32x16_bf16 v[84:99], a[48:51], v[44:47], v[84:99]
    ds_read_b64_tr_b16 v[40:41], v10 offset:34816
    ds_read_b64_tr_b16 v[42:43], v10 offset:35328
    v_mul_f32 v146, v145, v145
    v_mul_f32 v146, v146, v145
    v_mul_f32 v138, 0xbdd2d3e8, v146
    v_mfma_f32_32x32x16_bf16 v[100:115], a[52:55], v[44:47], v[100:115]
    v_mul_f32 v144, v52, v52
    v_mul_f32 v150, v54, v54
    v_mul_f32 v156, v56, v56
    v_mfma_f32_32x32x16_bf16 v[116:131], v[44:47], v[44:47], v[116:131]
    v_mfma_f32_32x32x16_bf16 v[84:99], a[56:59], v[48:51], v[84:99]
    ds_read_b64_tr_b16 v[44:45], v10 offset:35840
    ds_read_b64_tr_b16 v[46:47], v10 offset:36352
    v_mul_f32 v162, v58, v58
    v_mul_f32 v145, v53, v53
    v_mul_f32 v151, v55, v55
    v_mfma_f32_32x32x16_bf16 v[100:115], a[60:63], v[48:51], v[100:115]
    v_mul_f32 v157, v57, v57
    v_mul_f32 v163, v59, v59
    v_mul_f32 v148, v52, v68
    v_mfma_f32_32x32x16_bf16 v[116:131], v[48:51], v[48:51], v[116:131]
    s_waitcnt lgkmcnt(4)
    v_mfma_f32_32x32x16_bf16 v[84:99], a[64:67], v[32:35], v[84:99]
    ds_read_b64_tr_b16 v[48:49], v10 offset:36864
    ds_read_b64_tr_b16 v[50:51], v10 offset:37376
    v_mul_f32 v154, v54, v70
    v_mul_f32 v160, v56, v72
    v_mul_f32 v166, v58, v74
    v_mfma_f32_32x32x16_bf16 v[100:115], a[68:71], v[32:35], v[100:115]
    v_mul_f32 v149, v53, v69
    v_mul_f32 v155, v55, v71
    v_mul_f32 v161, v57, v73
    v_mfma_f32_32x32x16_bf16 v[84:99], a[72:75], v[36:39], v[84:99]
    ds_read_b64_tr_b16 v[32:33], v10 offset:37888
    ds_read_b64_tr_b16 v[34:35], v10 offset:38400
    v_mul_f32 v167, v59, v75
    v_fma_f32 v144, v144, v138, v136
    v_fma_f32 v150, v150, v138, v136
    v_mfma_f32_32x32x16_bf16 v[100:115], a[76:79], v[36:39], v[100:115]
    v_fma_f32 v156, v156, v138, v136
    v_fma_f32 v162, v162, v138, v136
    v_fma_f32 v145, v145, v138, v136
    s_waitcnt lgkmcnt(4)
    v_mfma_f32_32x32x16_bf16 v[84:99], a[80:83], v[40:43], v[84:99]
    ds_read_b64_tr_b16 v[36:37], v10 offset:38912
    ds_read_b64_tr_b16 v[38:39], v10 offset:39424
    v_fma_f32 v151, v151, v138, v136
    v_fma_f32 v157, v157, v138, v136
    v_fma_f32 v163, v163, v138, v136
    v_mfma_f32_32x32x16_bf16 v[100:115], a[84:87], v[40:43], v[100:115]
    v_mul_f32 v144, v144, v52
    v_mul_f32 v150, v150, v54
    v_mul_f32 v156, v156, v56
    v_mul_f32 v132, v116, v16
    v_mul_f32 v133, v117, v17
    v_fmac_f32 v132, v118, v18
    v_fmac_f32 v133, v119, v19
    v_fmac_f32 v132, v120, v20
    v_fmac_f32 v133, v121, v21
    v_fmac_f32 v132, v122, v22
    v_fmac_f32 v133, v123, v23
    v_fmac_f32 v132, v124, v24
    v_fmac_f32 v133, v125, v25
    v_fmac_f32 v132, v126, v26
    v_fmac_f32 v133, v127, v27
    v_fmac_f32 v132, v128, v28
    v_fmac_f32 v133, v129, v29
    v_fmac_f32 v132, v130, v30
    v_fmac_f32 v133, v131, v31
    v_add_f32 v132, v132, v133
    ds_write_b32 v14, v132 offset:1024
    v_mfma_f32_32x32x16_bf16 v[84:99], a[88:91], v[44:47], v[84:99]
    ds_read_b64_tr_b16 v[40:41], v10 offset:39936
    ds_read_b64_tr_b16 v[42:43], v10 offset:40448
    v_mul_f32 v162, v162, v58
    v_mul_f32 v145, v145, v53
    v_mul_f32 v151, v151, v55
    v_mfma_f32_32x32x16_bf16 v[100:115], a[92:95], v[44:47], v[100:115]
    v_mul_f32 v157, v157, v57
    v_mul_f32 v163, v163, v59
    v_exp_f32 v146, v144
    s_waitcnt lgkmcnt(5)
    v_mfma_f32_32x32x16_bf16 v[84:99], a[96:99], v[48:51], v[84:99]
    ds_read_b64_tr_b16 v[44:45], v11 offset:32768
    ds_read_b64_tr_b16 v[46:47], v11 offset:33280
    v_exp_f32 v152, v150
    v_exp_f32 v158, v156
    v_exp_f32 v164, v162
    v_mfma_f32_32x32x16_bf16 v[100:115], a[100:103], v[48:51], v[100:115]
    v_exp_f32 v147, v145
    v_exp_f32 v153, v151
    v_exp_f32 v159, v157
    v_mfma_f32_32x32x16_bf16 v[84:99], a[104:107], v[32:35], v[84:99]
    ds_read_b64_tr_b16 v[48:49], v11 offset:33792
    ds_read_b64_tr_b16 v[50:51], v11 offset:34304
    v_exp_f32 v165, v163
    v_fma_f32 v146, v146, v140, v140
    v_fma_f32 v152, v152, v140, v140
    v_mfma_f32_32x32x16_bf16 v[100:115], a[108:111], v[32:35], v[100:115]
    v_fma_f32 v158, v158, v140, v140
    v_fma_f32 v164, v164, v140, v140
    v_fma_f32 v147, v147, v140, v140
    s_waitcnt lgkmcnt(4)
    v_mfma_f32_32x32x16_bf16 v[84:99], a[112:115], v[36:39], v[84:99]
    ds_read_b64_tr_b16 v[32:33], v11 offset:34816
    ds_read_b64_tr_b16 v[34:35], v11 offset:35328
    v_fma_f32 v153, v153, v140, v140
    v_fma_f32 v159, v159, v140, v140
    v_fma_f32 v165, v165, v140, v140
    v_mfma_f32_32x32x16_bf16 v[100:115], a[116:119], v[36:39], v[100:115]
    v_rcp_f32 v146, v146
    v_rcp_f32 v152, v152
    v_rcp_f32 v158, v158
    v_mfma_f32_32x32x16_bf16 v[84:99], a[120:123], v[40:43], v[84:99]
    ds_read_b64_tr_b16 v[36:37], v11 offset:35840
    ds_read_b64_tr_b16 v[38:39], v11 offset:36352
    v_rcp_f32 v164, v164
    v_rcp_f32 v147, v147
    v_rcp_f32 v153, v153
    v_mfma_f32_32x32x16_bf16 v[100:115], a[124:127], v[40:43], v[100:115]
    v_rcp_f32 v159, v159
    v_rcp_f32 v165, v165
    v_mul_f32 v148, v148, v146
    s_waitcnt lgkmcnt(4)
    v_mfma_f32_32x32x16_bf16 v[84:99], a[128:131], v[44:47], v[84:99]
    ds_read_b64_tr_b16 v[40:41], v11 offset:36864
    ds_read_b64_tr_b16 v[42:43], v11 offset:37376
    v_mul_f32 v154, v154, v152
    v_mul_f32 v160, v160, v158
    v_mul_f32 v166, v166, v164
    v_mfma_f32_32x32x16_bf16 v[100:115], a[132:135], v[44:47], v[100:115]
    v_mul_f32 v149, v149, v147
    v_mul_f32 v155, v155, v153
    v_mul_f32 v161, v161, v159
    v_mfma_f32_32x32x16_bf16 v[84:99], a[136:139], v[48:51], v[84:99]
    ds_read_b64_tr_b16 v[44:45], v11 offset:37888
    ds_read_b64_tr_b16 v[46:47], v11 offset:38400
    v_mul_f32 v167, v167, v165
    v_cvt_pk_bf16_f32 v168, v148, v149
    v_cvt_pk_bf16_f32 v169, v154, v155
    v_mfma_f32_32x32x16_bf16 v[100:115], a[140:143], v[48:51], v[100:115]
    v_cvt_pk_bf16_f32 v170, v160, v161
    v_cvt_pk_bf16_f32 v171, v166, v167
    s_add_u32 s24, s38, 0
    s_waitcnt lgkmcnt(4)
    v_mfma_f32_32x32x16_bf16 v[84:99], a[144:147], v[32:35], v[84:99]
    ds_read_b64_tr_b16 v[48:49], v11 offset:38912
    ds_read_b64_tr_b16 v[50:51], v11 offset:39424
    buffer_store_dwordx4 v[168:171], v8, s[12:15], s24 offen sc1
    v_mul_f32 v144, v60, v60
    v_mul_f32 v150, v62, v62
    v_mfma_f32_32x32x16_bf16 v[100:115], a[148:151], v[32:35], v[100:115]
    v_mul_f32 v156, v64, v64
    v_mul_f32 v162, v66, v66
    v_mul_f32 v145, v61, v61
    v_mfma_f32_32x32x16_bf16 v[84:99], a[152:155], v[36:39], v[84:99]
    ds_read_b64_tr_b16 v[32:33], v11 offset:39936
    ds_read_b64_tr_b16 v[34:35], v11 offset:40448
    v_mul_f32 v151, v63, v63
    v_mul_f32 v157, v65, v65
    v_mul_f32 v163, v67, v67
    v_mfma_f32_32x32x16_bf16 v[100:115], a[156:159], v[36:39], v[100:115]
    v_mul_f32 v148, v60, v76
    v_mul_f32 v154, v62, v78
    v_mul_f32 v160, v64, v80
    s_waitcnt lgkmcnt(4)
    v_mfma_f32_32x32x16_bf16 v[84:99], a[160:163], v[40:43], v[84:99]
    ds_read_b64_tr_b16 v[36:37], v12 offset:32768
    ds_read_b64_tr_b16 v[38:39], v12 offset:33280
    v_mul_f32 v166, v66, v82
    v_mul_f32 v149, v61, v77
    v_mul_f32 v155, v63, v79
    v_mfma_f32_32x32x16_bf16 v[100:115], a[164:167], v[40:43], v[100:115]
    v_mul_f32 v161, v65, v81
    v_mul_f32 v167, v67, v83
    v_fma_f32 v144, v144, v138, v136
    v_mfma_f32_32x32x16_bf16 v[84:99], a[168:171], v[44:47], v[84:99]
    ds_read_b64_tr_b16 v[40:41], v12 offset:33792
    ds_read_b64_tr_b16 v[42:43], v12 offset:34304
    v_fma_f32 v150, v150, v138, v136
    v_fma_f32 v156, v156, v138, v136
    v_fma_f32 v162, v162, v138, v136
    v_mfma_f32_32x32x16_bf16 v[100:115], a[172:175], v[44:47], v[100:115]
    v_fma_f32 v145, v145, v138, v136
    v_fma_f32 v151, v151, v138, v136
    v_fma_f32 v157, v157, v138, v136
    s_waitcnt lgkmcnt(4)
    v_mfma_f32_32x32x16_bf16 v[84:99], a[176:179], v[48:51], v[84:99]
    ds_read_b64_tr_b16 v[44:45], v12 offset:34816
    ds_read_b64_tr_b16 v[46:47], v12 offset:35328
    v_fma_f32 v163, v163, v138, v136
    v_mul_f32 v144, v144, v60
    v_mul_f32 v150, v150, v62
    v_mfma_f32_32x32x16_bf16 v[100:115], a[180:183], v[48:51], v[100:115]
    v_mul_f32 v156, v156, v64
    v_mul_f32 v162, v162, v66
    v_mul_f32 v145, v145, v61
    v_mfma_f32_32x32x16_bf16 v[84:99], a[184:187], v[32:35], v[84:99]
    ds_read_b64_tr_b16 v[48:49], v12 offset:35840
    ds_read_b64_tr_b16 v[50:51], v12 offset:36352
    v_mul_f32 v151, v151, v63
    v_mul_f32 v157, v157, v65
    v_mul_f32 v163, v163, v67
    v_mfma_f32_32x32x16_bf16 v[100:115], a[188:191], v[32:35], v[100:115]
    v_exp_f32 v146, v144
    v_exp_f32 v152, v150
    v_exp_f32 v158, v156
    s_waitcnt lgkmcnt(4)
    v_mfma_f32_32x32x16_bf16 v[84:99], a[192:195], v[36:39], v[84:99]
    ds_read_b64_tr_b16 v[32:33], v12 offset:36864
    ds_read_b64_tr_b16 v[34:35], v12 offset:37376
    v_exp_f32 v164, v162
    v_exp_f32 v147, v145
    v_exp_f32 v153, v151
    v_mfma_f32_32x32x16_bf16 v[100:115], a[196:199], v[36:39], v[100:115]
    v_exp_f32 v159, v157
    v_exp_f32 v165, v163
    v_fma_f32 v146, v146, v140, v140
    v_mfma_f32_32x32x16_bf16 v[84:99], a[200:203], v[40:43], v[84:99]
    ds_read_b64_tr_b16 v[36:37], v12 offset:37888
    ds_read_b64_tr_b16 v[38:39], v12 offset:38400
    v_fma_f32 v152, v152, v140, v140
    v_fma_f32 v158, v158, v140, v140
    v_fma_f32 v164, v164, v140, v140
    v_mfma_f32_32x32x16_bf16 v[100:115], a[204:207], v[40:43], v[100:115]
    v_fma_f32 v147, v147, v140, v140
    v_fma_f32 v153, v153, v140, v140
    v_fma_f32 v159, v159, v140, v140
    s_waitcnt lgkmcnt(4)
    v_mfma_f32_32x32x16_bf16 v[84:99], a[208:211], v[44:47], v[84:99]
    ds_read_b64_tr_b16 v[40:41], v12 offset:38912
    ds_read_b64_tr_b16 v[42:43], v12 offset:39424
    v_fma_f32 v165, v165, v140, v140
    v_rcp_f32 v146, v146
    v_rcp_f32 v152, v152
    v_mfma_f32_32x32x16_bf16 v[100:115], a[212:215], v[44:47], v[100:115]
    v_rcp_f32 v158, v158
    v_rcp_f32 v164, v164
    v_rcp_f32 v147, v147
    v_mfma_f32_32x32x16_bf16 v[84:99], a[216:219], v[48:51], v[84:99]
    ds_read_b64_tr_b16 v[44:45], v12 offset:39936
    ds_read_b64_tr_b16 v[46:47], v12 offset:40448
    v_rcp_f32 v153, v153
    v_rcp_f32 v159, v159
    v_rcp_f32 v165, v165
    v_mfma_f32_32x32x16_bf16 v[100:115], a[220:223], v[48:51], v[100:115]
    v_mul_f32 v148, v148, v146
    v_mul_f32 v154, v154, v152
    v_mul_f32 v160, v160, v158
    s_waitcnt vmcnt(1)
    s_barrier
    s_waitcnt lgkmcnt(4)
    v_mfma_f32_32x32x16_bf16 v[84:99], a[224:227], v[32:35], v[84:99]
    v_add_u32 v9, 32768, v9
    ds_read_b64_tr_b16 v[48:49], v9 offset:32768
    ds_read_b64_tr_b16 v[50:51], v9 offset:33280
    v_mul_f32 v166, v166, v164
    v_mul_f32 v149, v149, v147
    v_mul_f32 v155, v155, v153
    v_mfma_f32_32x32x16_bf16 v[100:115], a[228:231], v[32:35], v[100:115]
    v_mul_f32 v161, v161, v159
    v_mul_f32 v167, v167, v165
    v_cvt_pk_bf16_f32 v172, v148, v149
    v_mfma_f32_32x32x16_bf16 v[84:99], a[232:235], v[36:39], v[84:99]
    ds_read_b64_tr_b16 v[32:33], v9 offset:33792
    ds_read_b64_tr_b16 v[34:35], v9 offset:34304
    v_cvt_pk_bf16_f32 v173, v154, v155
    v_cvt_pk_bf16_f32 v174, v160, v161
    v_cvt_pk_bf16_f32 v175, v166, v167
    v_mfma_f32_32x32x16_bf16 v[100:115], a[236:239], v[36:39], v[100:115]
    s_add_u32 s24, s38, 1024
    buffer_store_dwordx4 v[172:175], v8, s[12:15], s24 offen sc1
    s_waitcnt lgkmcnt(4)
    v_mfma_f32_32x32x16_bf16 v[84:99], a[240:243], v[40:43], v[84:99]
    ds_read_b64_tr_b16 v[36:37], v9 offset:34816
    ds_read_b64_tr_b16 v[38:39], v9 offset:35328
    v_mfma_f32_32x32x16_bf16 v[100:115], a[244:247], v[40:43], v[100:115]
    v_mfma_f32_32x32x16_bf16 v[84:99], a[248:251], v[44:47], v[84:99]
    ds_read_b64_tr_b16 v[40:41], v9 offset:35840
    ds_read_b64_tr_b16 v[42:43], v9 offset:36352
    v_mfma_f32_32x32x16_bf16 v[100:115], a[252:255], v[44:47], v[100:115]
    s_waitcnt lgkmcnt(4)
    v_mfma_f32_32x32x16_bf16 v[52:67], a[0:3], v[48:51], 0
    ds_read_b64_tr_b16 v[44:45], v9 offset:36864
    ds_read_b64_tr_b16 v[46:47], v9 offset:37376
    v_mfma_f32_32x32x16_bf16 v[68:83], a[4:7], v[48:51], 0
    s_add_u32 s63, s47, 0
    buffer_load_dwordx4 a[0:3], v4, s[16:19], s63 offen offset:0
    s_add_u32 s63, s47, 88064
    buffer_load_dwordx4 a[4:7], v4, s[16:19], s63 offen offset:0
    v_and_b32 v168, v13, v48
    v_mov_b32 v169, v49
    v_mov_b32 v170, v50
    v_mov_b32 v171, v51
    s_nop 1
    v_mfma_f32_32x32x16_bf16 v[116:131], v[168:171], v[168:171], 0
    v_mfma_f32_32x32x16_bf16 v[52:67], a[8:11], v[32:35], v[52:67]
    ds_read_b64_tr_b16 v[48:49], v9 offset:37888
    ds_read_b64_tr_b16 v[50:51], v9 offset:38400
    v_mfma_f32_32x32x16_bf16 v[68:83], a[12:15], v[32:35], v[68:83]
    s_add_u32 s63, s47, 0
    buffer_load_dwordx4 a[8:11], v4, s[16:19], s63 offen offset:1024
    s_add_u32 s63, s47, 88064
    buffer_load_dwordx4 a[12:15], v4, s[16:19], s63 offen offset:1024
    v_mfma_f32_32x32x16_bf16 v[116:131], v[32:35], v[32:35], v[116:131]
    s_waitcnt lgkmcnt(4)
    v_mfma_f32_32x32x16_bf16 v[52:67], a[16:19], v[36:39], v[52:67]
    ds_read_b64_tr_b16 v[32:33], v9 offset:38912
    ds_read_b64_tr_b16 v[34:35], v9 offset:39424
    ds_read_b128 v[144:147], v15 offset:1024
    ds_read_b128 v[148:151], v15 offset:1040
    v_mfma_f32_32x32x16_bf16 v[68:83], a[20:23], v[36:39], v[68:83]
    s_add_u32 s63, s47, 0
    buffer_load_dwordx4 a[16:19], v4, s[16:19], s63 offen offset:2048
    s_add_u32 s63, s47, 88064
    buffer_load_dwordx4 a[20:23], v4, s[16:19], s63 offen offset:2048
    v_mfma_f32_32x32x16_bf16 v[116:131], v[36:39], v[36:39], v[116:131]
    v_mfma_f32_32x32x16_bf16 v[52:67], a[24:27], v[40:43], v[52:67]
    ds_read_b64_tr_b16 v[36:37], v9 offset:39936
    ds_read_b64_tr_b16 v[38:39], v9 offset:40448
    v_mfma_f32_32x32x16_bf16 v[68:83], a[28:31], v[40:43], v[68:83]
    s_add_u32 s63, s47, 0
    buffer_load_dwordx4 a[24:27], v4, s[16:19], s63 offen offset:3072
    s_add_u32 s63, s47, 88064
    buffer_load_dwordx4 a[28:31], v4, s[16:19], s63 offen offset:3072
    s_waitcnt lgkmcnt(2)
    v_mfma_f32_32x32x16_bf16 v[116:131], v[40:43], v[40:43], v[116:131]
    s_waitcnt lgkmcnt(6)
    v_mfma_f32_32x32x16_bf16 v[52:67], a[32:35], v[44:47], v[52:67]
    v_add_u32 v10, 32768, v10
    ds_read_b64_tr_b16 v[40:41], v10 offset:32768
    ds_read_b64_tr_b16 v[42:43], v10 offset:33280
    v_add_f32 v144, v144, v148
    v_add_f32 v145, v145, v149
    v_add_f32 v146, v146, v150
    v_mfma_f32_32x32x16_bf16 v[68:83], a[36:39], v[44:47], v[68:83]
    s_add_u32 s63, s47, 4096
    buffer_load_dwordx4 a[32:35], v4, s[16:19], s63 offen offset:0
    s_add_u32 s63, s47, 92160
    buffer_load_dwordx4 a[36:39], v4, s[16:19], s63 offen offset:0
    v_add_f32 v147, v147, v151
    v_add_f32 v144, v144, v145
    v_add_f32 v146, v146, v147
    v_mfma_f32_32x32x16_bf16 v[116:131], v[44:47], v[44:47], v[116:131]
    v_mfma_f32_32x32x16_bf16 v[52:67], a[40:43], v[48:51], v[52:67]
    ds_read_b64_tr_b16 v[44:45], v10 offset:33792
    ds_read_b64_tr_b16 v[46:47], v10 offset:34304
    v_add_f32 v144, v144, v146
    v_mul_f32 v144, 0x3b000000, v144
    v_add_f32 v140, 0x3727c5ac, v144
    v_mfma_f32_32x32x16_bf16 v[68:83], a[44:47], v[48:51], v[68:83]
    s_add_u32 s63, s47, 4096
    buffer_load_dwordx4 a[40:43], v4, s[16:19], s63 offen offset:1024
    s_add_u32 s63, s47, 92160
    buffer_load_dwordx4 a[44:47], v4, s[16:19], s63 offen offset:1024
    v_rsq_f32 v145, v140
    s_nop 0
    v_mul_f32 v136, 0xc0135761, v145
    v_mfma_f32_32x32x16_bf16 v[116:131], v[48:51], v[48:51], v[116:131]
    s_waitcnt lgkmcnt(4)
    v_mfma_f32_32x32x16_bf16 v[52:67], a[48:51], v[32:35], v[52:67]
    ds_read_b64_tr_b16 v[48:49], v10 offset:34816
    ds_read_b64_tr_b16 v[50:51], v10 offset:35328
    v_mul_f32 v146, v145, v145
    v_mul_f32 v146, v146, v145
    v_mul_f32 v138, 0xbdd2d3e8, v146
    v_mfma_f32_32x32x16_bf16 v[68:83], a[52:55], v[32:35], v[68:83]
    s_add_u32 s63, s47, 4096
    buffer_load_dwordx4 a[48:51], v4, s[16:19], s63 offen offset:2048
    s_add_u32 s63, s47, 92160
    buffer_load_dwordx4 a[52:55], v4, s[16:19], s63 offen offset:2048
    v_mul_f32 v144, v84, v84
    v_mul_f32 v150, v86, v86
    v_mul_f32 v156, v88, v88
    v_mfma_f32_32x32x16_bf16 v[116:131], v[32:35], v[32:35], v[116:131]
    v_mfma_f32_32x32x16_bf16 v[52:67], a[56:59], v[36:39], v[52:67]
    ds_read_b64_tr_b16 v[32:33], v10 offset:35840
    ds_read_b64_tr_b16 v[34:35], v10 offset:36352
    v_mul_f32 v162, v90, v90
    v_mul_f32 v145, v85, v85
    v_mul_f32 v151, v87, v87
    v_mfma_f32_32x32x16_bf16 v[68:83], a[60:63], v[36:39], v[68:83]
    s_add_u32 s63, s47, 4096
    buffer_load_dwordx4 a[56:59], v4, s[16:19], s63 offen offset:3072
    s_add_u32 s63, s47, 92160
    buffer_load_dwordx4 a[60:63], v4, s[16:19], s63 offen offset:3072
    v_mul_f32 v157, v89, v89
    v_mul_f32 v163, v91, v91
    v_mul_f32 v148, v84, v100
    v_mfma_f32_32x32x16_bf16 v[116:131], v[36:39], v[36:39], v[116:131]
    s_waitcnt lgkmcnt(4)
    v_mfma_f32_32x32x16_bf16 v[52:67], a[64:67], v[40:43], v[52:67]
    ds_read_b64_tr_b16 v[36:37], v10 offset:36864
    ds_read_b64_tr_b16 v[38:39], v10 offset:37376
    v_mul_f32 v154, v86, v102
    v_mul_f32 v160, v88, v104
    v_mul_f32 v166, v90, v106
    v_mfma_f32_32x32x16_bf16 v[68:83], a[68:71], v[40:43], v[68:83]
    v_mul_f32 v149, v85, v101
    v_mul_f32 v155, v87, v103
    v_mul_f32 v161, v89, v105
    v_mfma_f32_32x32x16_bf16 v[52:67], a[72:75], v[44:47], v[52:67]
    ds_read_b64_tr_b16 v[40:41], v10 offset:37888
    ds_read_b64_tr_b16 v[42:43], v10 offset:38400
    v_mul_f32 v167, v91, v107
    v_fma_f32 v144, v144, v138, v136
    v_fma_f32 v150, v150, v138, v136
    v_mfma_f32_32x32x16_bf16 v[68:83], a[76:79], v[44:47], v[68:83]
    v_fma_f32 v156, v156, v138, v136
    v_fma_f32 v162, v162, v138, v136
    v_fma_f32 v145, v145, v138, v136
    s_waitcnt lgkmcnt(4)
    v_mfma_f32_32x32x16_bf16 v[52:67], a[80:83], v[48:51], v[52:67]
    ds_read_b64_tr_b16 v[44:45], v10 offset:38912
    ds_read_b64_tr_b16 v[46:47], v10 offset:39424
    v_fma_f32 v151, v151, v138, v136
    v_fma_f32 v157, v157, v138, v136
    v_fma_f32 v163, v163, v138, v136
    v_mfma_f32_32x32x16_bf16 v[68:83], a[84:87], v[48:51], v[68:83]
    v_mul_f32 v144, v144, v84
    v_mul_f32 v150, v150, v86
    v_mul_f32 v156, v156, v88
    v_mul_f32 v132, v116, v16
    v_mul_f32 v133, v117, v17
    v_fmac_f32 v132, v118, v18
    v_fmac_f32 v133, v119, v19
    v_fmac_f32 v132, v120, v20
    v_fmac_f32 v133, v121, v21
    v_fmac_f32 v132, v122, v22
    v_fmac_f32 v133, v123, v23
    v_fmac_f32 v132, v124, v24
    v_fmac_f32 v133, v125, v25
    v_fmac_f32 v132, v126, v26
    v_fmac_f32 v133, v127, v27
    v_fmac_f32 v132, v128, v28
    v_fmac_f32 v133, v129, v29
    v_fmac_f32 v132, v130, v30
    v_fmac_f32 v133, v131, v31
    v_add_f32 v132, v132, v133
    ds_write_b32 v14, v132 offset:2048
    v_mfma_f32_32x32x16_bf16 v[52:67], a[88:91], v[32:35], v[52:67]
    ds_read_b64_tr_b16 v[48:49], v10 offset:39936
    ds_read_b64_tr_b16 v[50:51], v10 offset:40448
    v_mul_f32 v162, v162, v90
    v_mul_f32 v145, v145, v85
    v_mul_f32 v151, v151, v87
    v_mfma_f32_32x32x16_bf16 v[68:83], a[92:95], v[32:35], v[68:83]
    v_mul_f32 v157, v157, v89
    v_mul_f32 v163, v163, v91
    v_exp_f32 v146, v144
    s_waitcnt lgkmcnt(5)
    v_mfma_f32_32x32x16_bf16 v[52:67], a[96:99], v[36:39], v[52:67]
    v_add_u32 v11, 32768, v11
    ds_read_b64_tr_b16 v[32:33], v11 offset:32768
    ds_read_b64_tr_b16 v[34:35], v11 offset:33280
    v_exp_f32 v152, v150
    v_exp_f32 v158, v156
    v_exp_f32 v164, v162
    v_mfma_f32_32x32x16_bf16 v[68:83], a[100:103], v[36:39], v[68:83]
    v_exp_f32 v147, v145
    v_exp_f32 v153, v151
    v_exp_f32 v159, v157
    v_mfma_f32_32x32x16_bf16 v[52:67], a[104:107], v[40:43], v[52:67]
    ds_read_b64_tr_b16 v[36:37], v11 offset:33792
    ds_read_b64_tr_b16 v[38:39], v11 offset:34304
    v_exp_f32 v165, v163
    v_fma_f32 v146, v146, v140, v140
    v_fma_f32 v152, v152, v140, v140
    v_mfma_f32_32x32x16_bf16 v[68:83], a[108:111], v[40:43], v[68:83]
    v_fma_f32 v158, v158, v140, v140
    v_fma_f32 v164, v164, v140, v140
    v_fma_f32 v147, v147, v140, v140
    s_waitcnt lgkmcnt(4)
    v_mfma_f32_32x32x16_bf16 v[52:67], a[112:115], v[44:47], v[52:67]
    ds_read_b64_tr_b16 v[40:41], v11 offset:34816
    ds_read_b64_tr_b16 v[42:43], v11 offset:35328
    v_fma_f32 v153, v153, v140, v140
    v_fma_f32 v159, v159, v140, v140
    v_fma_f32 v165, v165, v140, v140
    v_mfma_f32_32x32x16_bf16 v[68:83], a[116:119], v[44:47], v[68:83]
    v_rcp_f32 v146, v146
    v_rcp_f32 v152, v152
    v_rcp_f32 v158, v158
    v_mfma_f32_32x32x16_bf16 v[52:67], a[120:123], v[48:51], v[52:67]
    ds_read_b64_tr_b16 v[44:45], v11 offset:35840
    ds_read_b64_tr_b16 v[46:47], v11 offset:36352
    v_rcp_f32 v164, v164
    v_rcp_f32 v147, v147
    v_rcp_f32 v153, v153
    v_mfma_f32_32x32x16_bf16 v[68:83], a[124:127], v[48:51], v[68:83]
    v_rcp_f32 v159, v159
    v_rcp_f32 v165, v165
    v_mul_f32 v148, v148, v146
    s_waitcnt lgkmcnt(4)
    v_mfma_f32_32x32x16_bf16 v[52:67], a[128:131], v[32:35], v[52:67]
    ds_read_b64_tr_b16 v[48:49], v11 offset:36864
    ds_read_b64_tr_b16 v[50:51], v11 offset:37376
    v_mul_f32 v154, v154, v152
    v_mul_f32 v160, v160, v158
    v_mul_f32 v166, v166, v164
    v_mfma_f32_32x32x16_bf16 v[68:83], a[132:135], v[32:35], v[68:83]
    v_mul_f32 v149, v149, v147
    v_mul_f32 v155, v155, v153
    v_mul_f32 v161, v161, v159
    v_mfma_f32_32x32x16_bf16 v[52:67], a[136:139], v[36:39], v[52:67]
    ds_read_b64_tr_b16 v[32:33], v11 offset:37888
    ds_read_b64_tr_b16 v[34:35], v11 offset:38400
    v_mul_f32 v167, v167, v165
    v_cvt_pk_bf16_f32 v168, v148, v149
    v_cvt_pk_bf16_f32 v169, v154, v155
    v_mfma_f32_32x32x16_bf16 v[68:83], a[140:143], v[36:39], v[68:83]
    v_cvt_pk_bf16_f32 v170, v160, v161
    v_cvt_pk_bf16_f32 v171, v166, v167
    s_add_u32 s24, s38, 88064
    s_waitcnt lgkmcnt(4)
    v_mfma_f32_32x32x16_bf16 v[52:67], a[144:147], v[40:43], v[52:67]
    ds_read_b64_tr_b16 v[36:37], v11 offset:38912
    ds_read_b64_tr_b16 v[38:39], v11 offset:39424
    buffer_store_dwordx4 v[168:171], v8, s[12:15], s24 offen sc1
    v_mul_f32 v144, v92, v92
    v_mul_f32 v150, v94, v94
    v_mfma_f32_32x32x16_bf16 v[68:83], a[148:151], v[40:43], v[68:83]
    v_mul_f32 v156, v96, v96
    v_mul_f32 v162, v98, v98
    v_mul_f32 v145, v93, v93
    v_mfma_f32_32x32x16_bf16 v[52:67], a[152:155], v[44:47], v[52:67]
    ds_read_b64_tr_b16 v[40:41], v11 offset:39936
    ds_read_b64_tr_b16 v[42:43], v11 offset:40448
    v_mul_f32 v151, v95, v95
    v_mul_f32 v157, v97, v97
    v_mul_f32 v163, v99, v99
    v_mfma_f32_32x32x16_bf16 v[68:83], a[156:159], v[44:47], v[68:83]
    v_mul_f32 v148, v92, v108
    v_mul_f32 v154, v94, v110
    v_mul_f32 v160, v96, v112
    s_waitcnt lgkmcnt(4)
    v_mfma_f32_32x32x16_bf16 v[52:67], a[160:163], v[48:51], v[52:67]
    v_add_u32 v12, 32768, v12
    ds_read_b64_tr_b16 v[44:45], v12 offset:32768
    ds_read_b64_tr_b16 v[46:47], v12 offset:33280
    v_mul_f32 v166, v98, v114
    v_mul_f32 v149, v93, v109
    v_mul_f32 v155, v95, v111
    v_mfma_f32_32x32x16_bf16 v[68:83], a[164:167], v[48:51], v[68:83]
    v_mul_f32 v161, v97, v113
    v_mul_f32 v167, v99, v115
    v_fma_f32 v144, v144, v138, v136
    v_mfma_f32_32x32x16_bf16 v[52:67], a[168:171], v[32:35], v[52:67]
    ds_read_b64_tr_b16 v[48:49], v12 offset:33792
    ds_read_b64_tr_b16 v[50:51], v12 offset:34304
    v_fma_f32 v150, v150, v138, v136
    v_fma_f32 v156, v156, v138, v136
    v_fma_f32 v162, v162, v138, v136
    v_mfma_f32_32x32x16_bf16 v[68:83], a[172:175], v[32:35], v[68:83]
    v_fma_f32 v145, v145, v138, v136
    v_fma_f32 v151, v151, v138, v136
    v_fma_f32 v157, v157, v138, v136
    s_waitcnt lgkmcnt(4)
    v_mfma_f32_32x32x16_bf16 v[52:67], a[176:179], v[36:39], v[52:67]
    ds_read_b64_tr_b16 v[32:33], v12 offset:34816
    ds_read_b64_tr_b16 v[34:35], v12 offset:35328
    v_fma_f32 v163, v163, v138, v136
    v_mul_f32 v144, v144, v92
    v_mul_f32 v150, v150, v94
    v_mfma_f32_32x32x16_bf16 v[68:83], a[180:183], v[36:39], v[68:83]
    v_mul_f32 v156, v156, v96
    v_mul_f32 v162, v162, v98
    v_mul_f32 v145, v145, v93
    v_mfma_f32_32x32x16_bf16 v[52:67], a[184:187], v[40:43], v[52:67]
    ds_read_b64_tr_b16 v[36:37], v12 offset:35840
    ds_read_b64_tr_b16 v[38:39], v12 offset:36352
    v_mul_f32 v151, v151, v95
    v_mul_f32 v157, v157, v97
    v_mul_f32 v163, v163, v99
    v_mfma_f32_32x32x16_bf16 v[68:83], a[188:191], v[40:43], v[68:83]
    v_exp_f32 v146, v144
    v_exp_f32 v152, v150
    v_exp_f32 v158, v156
    s_waitcnt lgkmcnt(4)
    v_mfma_f32_32x32x16_bf16 v[52:67], a[192:195], v[44:47], v[52:67]
    ds_read_b64_tr_b16 v[40:41], v12 offset:36864
    ds_read_b64_tr_b16 v[42:43], v12 offset:37376
    v_exp_f32 v164, v162
    v_exp_f32 v147, v145
    v_exp_f32 v153, v151
    v_mfma_f32_32x32x16_bf16 v[68:83], a[196:199], v[44:47], v[68:83]
    v_exp_f32 v159, v157
    v_exp_f32 v165, v163
    v_fma_f32 v146, v146, v140, v140
    v_mfma_f32_32x32x16_bf16 v[52:67], a[200:203], v[48:51], v[52:67]
    ds_read_b64_tr_b16 v[44:45], v12 offset:37888
    ds_read_b64_tr_b16 v[46:47], v12 offset:38400
    v_fma_f32 v152, v152, v140, v140
    v_fma_f32 v158, v158, v140, v140
    v_fma_f32 v164, v164, v140, v140
    v_mfma_f32_32x32x16_bf16 v[68:83], a[204:207], v[48:51], v[68:83]
    v_fma_f32 v147, v147, v140, v140
    v_fma_f32 v153, v153, v140, v140
    v_fma_f32 v159, v159, v140, v140
    s_waitcnt lgkmcnt(4)
    v_mfma_f32_32x32x16_bf16 v[52:67], a[208:211], v[32:35], v[52:67]
    ds_read_b64_tr_b16 v[48:49], v12 offset:38912
    ds_read_b64_tr_b16 v[50:51], v12 offset:39424
    v_fma_f32 v165, v165, v140, v140
    v_rcp_f32 v146, v146
    v_rcp_f32 v152, v152
    v_mfma_f32_32x32x16_bf16 v[68:83], a[212:215], v[32:35], v[68:83]
    v_rcp_f32 v158, v158
    v_rcp_f32 v164, v164
    v_rcp_f32 v147, v147
    v_mfma_f32_32x32x16_bf16 v[52:67], a[216:219], v[36:39], v[52:67]
    ds_read_b64_tr_b16 v[32:33], v12 offset:39936
    ds_read_b64_tr_b16 v[34:35], v12 offset:40448
    v_rcp_f32 v153, v153
    v_rcp_f32 v159, v159
    v_rcp_f32 v165, v165
    v_mfma_f32_32x32x16_bf16 v[68:83], a[220:223], v[36:39], v[68:83]
    v_mul_f32 v148, v148, v146
    v_mul_f32 v154, v154, v152
    v_mul_f32 v160, v160, v158
    s_barrier
    s_waitcnt lgkmcnt(4)
    v_mfma_f32_32x32x16_bf16 v[52:67], a[224:227], v[40:43], v[52:67]
    v_mul_f32 v166, v166, v164
    v_mul_f32 v149, v149, v147
    v_mul_f32 v155, v155, v153
    v_mfma_f32_32x32x16_bf16 v[68:83], a[228:231], v[40:43], v[68:83]
    v_mul_f32 v161, v161, v159
    v_mul_f32 v167, v167, v165
    v_cvt_pk_bf16_f32 v172, v148, v149
    v_mfma_f32_32x32x16_bf16 v[52:67], a[232:235], v[44:47], v[52:67]
    v_cvt_pk_bf16_f32 v173, v154, v155
    v_cvt_pk_bf16_f32 v174, v160, v161
    v_cvt_pk_bf16_f32 v175, v166, v167
    v_mfma_f32_32x32x16_bf16 v[68:83], a[236:239], v[44:47], v[68:83]
    s_add_u32 s24, s38, 89088
    buffer_store_dwordx4 v[172:175], v8, s[12:15], s24 offen sc1
    s_waitcnt lgkmcnt(0)
    v_mfma_f32_32x32x16_bf16 v[52:67], a[240:243], v[48:51], v[52:67]
    v_mfma_f32_32x32x16_bf16 v[68:83], a[244:247], v[48:51], v[68:83]
    v_mfma_f32_32x32x16_bf16 v[52:67], a[248:251], v[32:35], v[52:67]
    v_mfma_f32_32x32x16_bf16 v[68:83], a[252:255], v[32:35], v[68:83]
    ds_read_b128 v[144:147], v15 offset:2048
    ds_read_b128 v[148:151], v15 offset:2064
    s_waitcnt lgkmcnt(0)
    v_add_f32 v144, v144, v148
    v_add_f32 v145, v145, v149
    v_add_f32 v146, v146, v150
    v_add_f32 v147, v147, v151
    v_add_f32 v144, v144, v145
    v_add_f32 v146, v146, v147
    v_add_f32 v144, v144, v146
    v_mul_f32 v144, 0x3b000000, v144
    v_add_f32 v140, 0x3727c5ac, v144
    v_rsq_f32 v145, v140
    s_nop 0
    v_mul_f32 v136, 0xc0135761, v145
    v_mul_f32 v146, v145, v145
    v_mul_f32 v146, v146, v145
    v_mul_f32 v138, 0xbdd2d3e8, v146
    v_pk_mul_f32 v[144:145], v[52:53], v[52:53]
    v_pk_mul_f32 v[150:151], v[54:55], v[54:55]
    v_pk_mul_f32 v[156:157], v[56:57], v[56:57]
    v_pk_mul_f32 v[162:163], v[58:59], v[58:59]
    v_pk_mul_f32 v[148:149], v[52:53], v[68:69]
    v_pk_mul_f32 v[154:155], v[54:55], v[70:71]
    v_pk_mul_f32 v[160:161], v[56:57], v[72:73]
    v_pk_mul_f32 v[166:167], v[58:59], v[74:75]
    v_pk_fma_f32 v[144:145], v[144:145], v[138:139], v[136:137] op_sel_hi:[1,0,0]
    v_pk_fma_f32 v[150:151], v[150:151], v[138:139], v[136:137] op_sel_hi:[1,0,0]
    v_pk_fma_f32 v[156:157], v[156:157], v[138:139], v[136:137] op_sel_hi:[1,0,0]
    v_pk_fma_f32 v[162:163], v[162:163], v[138:139], v[136:137] op_sel_hi:[1,0,0]
    v_pk_mul_f32 v[144:145], v[144:145], v[52:53]
    v_pk_mul_f32 v[150:151], v[150:151], v[54:55]
    v_pk_mul_f32 v[156:157], v[156:157], v[56:57]
    v_pk_mul_f32 v[162:163], v[162:163], v[58:59]
    v_exp_f32 v146, v144
    v_exp_f32 v152, v150
    v_exp_f32 v158, v156
    v_exp_f32 v164, v162
    v_exp_f32 v147, v145
    v_exp_f32 v153, v151
    v_exp_f32 v159, v157
    v_exp_f32 v165, v163
    v_pk_fma_f32 v[146:147], v[146:147], v[140:141], v[140:141] op_sel_hi:[1,0,0]
    v_pk_fma_f32 v[152:153], v[152:153], v[140:141], v[140:141] op_sel_hi:[1,0,0]
    v_pk_fma_f32 v[158:159], v[158:159], v[140:141], v[140:141] op_sel_hi:[1,0,0]
    v_pk_fma_f32 v[164:165], v[164:165], v[140:141], v[140:141] op_sel_hi:[1,0,0]
    v_rcp_f32 v146, v146
    v_rcp_f32 v152, v152
    v_rcp_f32 v158, v158
    v_rcp_f32 v164, v164
    v_rcp_f32 v147, v147
    v_rcp_f32 v153, v153
    v_rcp_f32 v159, v159
    v_rcp_f32 v165, v165
    v_pk_mul_f32 v[148:149], v[148:149], v[146:147]
    v_pk_mul_f32 v[154:155], v[154:155], v[152:153]
    v_pk_mul_f32 v[160:161], v[160:161], v[158:159]
    v_pk_mul_f32 v[166:167], v[166:167], v[164:165]
    v_cvt_pk_bf16_f32 v168, v148, v149
    v_cvt_pk_bf16_f32 v169, v154, v155
    v_cvt_pk_bf16_f32 v170, v160, v161
    v_cvt_pk_bf16_f32 v171, v166, v167
    s_add_u32 s24, s38, 176128
    buffer_store_dwordx4 v[168:171], v8, s[12:15], s24 offen sc1
    v_pk_mul_f32 v[144:145], v[60:61], v[60:61]
    v_pk_mul_f32 v[150:151], v[62:63], v[62:63]
    v_pk_mul_f32 v[156:157], v[64:65], v[64:65]
    v_pk_mul_f32 v[162:163], v[66:67], v[66:67]
    v_pk_mul_f32 v[148:149], v[60:61], v[76:77]
    v_pk_mul_f32 v[154:155], v[62:63], v[78:79]
    v_pk_mul_f32 v[160:161], v[64:65], v[80:81]
    v_pk_mul_f32 v[166:167], v[66:67], v[82:83]
    v_pk_fma_f32 v[144:145], v[144:145], v[138:139], v[136:137] op_sel_hi:[1,0,0]
    v_pk_fma_f32 v[150:151], v[150:151], v[138:139], v[136:137] op_sel_hi:[1,0,0]
    v_pk_fma_f32 v[156:157], v[156:157], v[138:139], v[136:137] op_sel_hi:[1,0,0]
    v_pk_fma_f32 v[162:163], v[162:163], v[138:139], v[136:137] op_sel_hi:[1,0,0]
    v_pk_mul_f32 v[144:145], v[144:145], v[60:61]
    v_pk_mul_f32 v[150:151], v[150:151], v[62:63]
    v_pk_mul_f32 v[156:157], v[156:157], v[64:65]
    v_pk_mul_f32 v[162:163], v[162:163], v[66:67]
    v_exp_f32 v146, v144
    v_exp_f32 v152, v150
    v_exp_f32 v158, v156
    v_exp_f32 v164, v162
    v_exp_f32 v147, v145
    v_exp_f32 v153, v151
    v_exp_f32 v159, v157
    v_exp_f32 v165, v163
    v_pk_fma_f32 v[146:147], v[146:147], v[140:141], v[140:141] op_sel_hi:[1,0,0]
    v_pk_fma_f32 v[152:153], v[152:153], v[140:141], v[140:141] op_sel_hi:[1,0,0]
    v_pk_fma_f32 v[158:159], v[158:159], v[140:141], v[140:141] op_sel_hi:[1,0,0]
    v_pk_fma_f32 v[164:165], v[164:165], v[140:141], v[140:141] op_sel_hi:[1,0,0]
    v_rcp_f32 v146, v146
    v_rcp_f32 v152, v152
    v_rcp_f32 v158, v158
    v_rcp_f32 v164, v164
    v_rcp_f32 v147, v147
    v_rcp_f32 v153, v153
    v_rcp_f32 v159, v159
    v_rcp_f32 v165, v165
    v_pk_mul_f32 v[148:149], v[148:149], v[146:147]
    v_pk_mul_f32 v[154:155], v[154:155], v[152:153]
    v_pk_mul_f32 v[160:161], v[160:161], v[158:159]
    v_pk_mul_f32 v[166:167], v[166:167], v[164:165]
    v_cvt_pk_bf16_f32 v172, v148, v149
    v_cvt_pk_bf16_f32 v173, v154, v155
    v_cvt_pk_bf16_f32 v174, v160, v161
    v_cvt_pk_bf16_f32 v175, v166, v167
    s_add_u32 s24, s38, 177152
    buffer_store_dwordx4 v[172:175], v8, s[12:15], s24 offen sc1
    s_nop 0
    s_branch L_g4_done_39
L_g4_done_39_1:
    s_waitcnt lgkmcnt(0)
    ds_read_b128 v[144:147], v15 offset:0
    ds_read_b128 v[148:151], v15 offset:16
    s_waitcnt lgkmcnt(0)
    v_add_f32 v144, v144, v148
    v_add_f32 v145, v145, v149
    v_add_f32 v146, v146, v150
    v_add_f32 v147, v147, v151
    v_add_f32 v144, v144, v145
    v_add_f32 v146, v146, v147
    v_add_f32 v144, v144, v146
    v_mul_f32 v144, 0x3b000000, v144
    v_add_f32 v140, 0x3727c5ac, v144
    v_rsq_f32 v145, v140
    s_nop 0
    v_mul_f32 v136, 0xc0135761, v145
    v_mul_f32 v146, v145, v145
    v_mul_f32 v146, v146, v145
    v_mul_f32 v138, 0xbdd2d3e8, v146
    v_pk_mul_f32 v[144:145], v[52:53], v[52:53]
    v_pk_mul_f32 v[150:151], v[54:55], v[54:55]
    v_pk_mul_f32 v[156:157], v[56:57], v[56:57]
    v_pk_mul_f32 v[162:163], v[58:59], v[58:59]
    v_pk_mul_f32 v[148:149], v[52:53], v[68:69]
    v_pk_mul_f32 v[154:155], v[54:55], v[70:71]
    v_pk_mul_f32 v[160:161], v[56:57], v[72:73]
    v_pk_mul_f32 v[166:167], v[58:59], v[74:75]
    v_pk_fma_f32 v[144:145], v[144:145], v[138:139], v[136:137] op_sel_hi:[1,0,0]
    v_pk_fma_f32 v[150:151], v[150:151], v[138:139], v[136:137] op_sel_hi:[1,0,0]
    v_pk_fma_f32 v[156:157], v[156:157], v[138:139], v[136:137] op_sel_hi:[1,0,0]
    v_pk_fma_f32 v[162:163], v[162:163], v[138:139], v[136:137] op_sel_hi:[1,0,0]
    v_pk_mul_f32 v[144:145], v[144:145], v[52:53]
    v_pk_mul_f32 v[150:151], v[150:151], v[54:55]
    v_pk_mul_f32 v[156:157], v[156:157], v[56:57]
    v_pk_mul_f32 v[162:163], v[162:163], v[58:59]
    v_exp_f32 v146, v144
    v_exp_f32 v152, v150
    v_exp_f32 v158, v156
    v_exp_f32 v164, v162
    v_exp_f32 v147, v145
    v_exp_f32 v153, v151
    v_exp_f32 v159, v157
    v_exp_f32 v165, v163
    v_pk_fma_f32 v[146:147], v[146:147], v[140:141], v[140:141] op_sel_hi:[1,0,0]
    v_pk_fma_f32 v[152:153], v[152:153], v[140:141], v[140:141] op_sel_hi:[1,0,0]
    v_pk_fma_f32 v[158:159], v[158:159], v[140:141], v[140:141] op_sel_hi:[1,0,0]
    v_pk_fma_f32 v[164:165], v[164:165], v[140:141], v[140:141] op_sel_hi:[1,0,0]
    v_rcp_f32 v146, v146
    v_rcp_f32 v152, v152
    v_rcp_f32 v158, v158
    v_rcp_f32 v164, v164
    v_rcp_f32 v147, v147
    v_rcp_f32 v153, v153
    v_rcp_f32 v159, v159
    v_rcp_f32 v165, v165
    v_pk_mul_f32 v[148:149], v[148:149], v[146:147]
    v_pk_mul_f32 v[154:155], v[154:155], v[152:153]
    v_pk_mul_f32 v[160:161], v[160:161], v[158:159]
    v_pk_mul_f32 v[166:167], v[166:167], v[164:165]
    v_cvt_pk_bf16_f32 v168, v148, v149
    v_cvt_pk_bf16_f32 v169, v154, v155
    v_cvt_pk_bf16_f32 v170, v160, v161
    v_cvt_pk_bf16_f32 v171, v166, v167
    s_add_u32 s24, s38, 0
    buffer_store_dwordx4 v[168:171], v8, s[12:15], s24 offen sc1
    v_pk_mul_f32 v[144:145], v[60:61], v[60:61]
    v_pk_mul_f32 v[150:151], v[62:63], v[62:63]
    v_pk_mul_f32 v[156:157], v[64:65], v[64:65]
    v_pk_mul_f32 v[162:163], v[66:67], v[66:67]
    v_pk_mul_f32 v[148:149], v[60:61], v[76:77]
    v_pk_mul_f32 v[154:155], v[62:63], v[78:79]
    v_pk_mul_f32 v[160:161], v[64:65], v[80:81]
    v_pk_mul_f32 v[166:167], v[66:67], v[82:83]
    v_pk_fma_f32 v[144:145], v[144:145], v[138:139], v[136:137] op_sel_hi:[1,0,0]
    v_pk_fma_f32 v[150:151], v[150:151], v[138:139], v[136:137] op_sel_hi:[1,0,0]
    v_pk_fma_f32 v[156:157], v[156:157], v[138:139], v[136:137] op_sel_hi:[1,0,0]
    v_pk_fma_f32 v[162:163], v[162:163], v[138:139], v[136:137] op_sel_hi:[1,0,0]
    v_pk_mul_f32 v[144:145], v[144:145], v[60:61]
    v_pk_mul_f32 v[150:151], v[150:151], v[62:63]
    v_pk_mul_f32 v[156:157], v[156:157], v[64:65]
    v_pk_mul_f32 v[162:163], v[162:163], v[66:67]
    v_exp_f32 v146, v144
    v_exp_f32 v152, v150
    v_exp_f32 v158, v156
    v_exp_f32 v164, v162
    v_exp_f32 v147, v145
    v_exp_f32 v153, v151
    v_exp_f32 v159, v157
    v_exp_f32 v165, v163
    v_pk_fma_f32 v[146:147], v[146:147], v[140:141], v[140:141] op_sel_hi:[1,0,0]
    v_pk_fma_f32 v[152:153], v[152:153], v[140:141], v[140:141] op_sel_hi:[1,0,0]
    v_pk_fma_f32 v[158:159], v[158:159], v[140:141], v[140:141] op_sel_hi:[1,0,0]
    v_pk_fma_f32 v[164:165], v[164:165], v[140:141], v[140:141] op_sel_hi:[1,0,0]
    v_rcp_f32 v146, v146
    v_rcp_f32 v152, v152
    v_rcp_f32 v158, v158
    v_rcp_f32 v164, v164
    v_rcp_f32 v147, v147
    v_rcp_f32 v153, v153
    v_rcp_f32 v159, v159
    v_rcp_f32 v165, v165
    v_pk_mul_f32 v[148:149], v[148:149], v[146:147]
    v_pk_mul_f32 v[154:155], v[154:155], v[152:153]
    v_pk_mul_f32 v[160:161], v[160:161], v[158:159]
    v_pk_mul_f32 v[166:167], v[166:167], v[164:165]
    v_cvt_pk_bf16_f32 v172, v148, v149
    v_cvt_pk_bf16_f32 v173, v154, v155
    v_cvt_pk_bf16_f32 v174, v160, v161
    v_cvt_pk_bf16_f32 v175, v166, v167
    s_add_u32 s24, s38, 1024
    buffer_store_dwordx4 v[172:175], v8, s[12:15], s24 offen sc1
    s_nop 1
L_g4_done_39:
    s_add_u32 s63, s47, 8192
    buffer_load_dwordx4 a[64:67], v4, s[16:19], s63 offen offset:0
    s_add_u32 s63, s47, 96256
    buffer_load_dwordx4 a[68:71], v4, s[16:19], s63 offen offset:0
    s_add_u32 s63, s47, 8192
    buffer_load_dwordx4 a[72:75], v4, s[16:19], s63 offen offset:1024
    s_add_u32 s63, s47, 96256
    buffer_load_dwordx4 a[76:79], v4, s[16:19], s63 offen offset:1024
    s_add_u32 s63, s47, 8192
    buffer_load_dwordx4 a[80:83], v4, s[16:19], s63 offen offset:2048
    s_add_u32 s63, s47, 96256
    buffer_load_dwordx4 a[84:87], v4, s[16:19], s63 offen offset:2048
    s_add_u32 s63, s47, 8192
    buffer_load_dwordx4 a[88:91], v4, s[16:19], s63 offen offset:3072
    s_add_u32 s63, s47, 96256
    buffer_load_dwordx4 a[92:95], v4, s[16:19], s63 offen offset:3072
    s_add_u32 s63, s47, 12288
    buffer_load_dwordx4 a[96:99], v4, s[16:19], s63 offen offset:0
    s_add_u32 s63, s47, 100352
    buffer_load_dwordx4 a[100:103], v4, s[16:19], s63 offen offset:0
    s_add_u32 s63, s47, 12288
    buffer_load_dwordx4 a[104:107], v4, s[16:19], s63 offen offset:1024
    s_add_u32 s63, s47, 100352
    buffer_load_dwordx4 a[108:111], v4, s[16:19], s63 offen offset:1024
    s_add_u32 s63, s47, 12288
    buffer_load_dwordx4 a[112:115], v4, s[16:19], s63 offen offset:2048
    s_add_u32 s63, s47, 100352
    buffer_load_dwordx4 a[116:119], v4, s[16:19], s63 offen offset:2048
    s_add_u32 s63, s47, 12288
    buffer_load_dwordx4 a[120:123], v4, s[16:19], s63 offen offset:3072
    s_add_u32 s63, s47, 100352
    buffer_load_dwordx4 a[124:127], v4, s[16:19], s63 offen offset:3072
    s_add_u32 s4, s82, 0x1f04000
    s_addc_u32 s5, s83, 0
    s_mov_b32 s6, 0x1000
    s_mov_b32 s7, 0x00020000
    s_lshl_b32 s24, s32, 7
    v_mov_b32 v250, s24
    v_mov_b32 v251, 1
    s_waitcnt vmcnt(16) lgkmcnt(0)
    s_barrier
    s_cmp_lg_u32 s20, 0
    s_cbranch_scc1 L_arr_40
    s_mov_b64 exec, 1
    buffer_atomic_add v251, v250, s[4:7], 0 offen offset:0 sc1
    s_mov_b64 exec, -1
L_arr_40:
    s_add_u32 s63, s47, 16384
    buffer_load_dwordx4 a[128:131], v4, s[16:19], s63 offen offset:0
    s_add_u32 s63, s47, 104448
    buffer_load_dwordx4 a[132:135], v4, s[16:19], s63 offen offset:0
    s_add_u32 s63, s47, 16384
    buffer_load_dwordx4 a[136:139], v4, s[16:19], s63 offen offset:1024
    s_add_u32 s63, s47, 104448
    buffer_load_dwordx4 a[140:143], v4, s[16:19], s63 offen offset:1024
    s_add_u32 s63, s47, 16384
    buffer_load_dwordx4 a[144:147], v4, s[16:19], s63 offen offset:2048
    s_add_u32 s63, s47, 104448
    buffer_load_dwordx4 a[148:151], v4, s[16:19], s63 offen offset:2048
    s_add_u32 s63, s47, 16384
    buffer_load_dwordx4 a[152:155], v4, s[16:19], s63 offen offset:3072
    s_add_u32 s63, s47, 104448
    buffer_load_dwordx4 a[156:159], v4, s[16:19], s63 offen offset:3072
    s_add_u32 s63, s47, 20480
    buffer_load_dwordx4 a[160:163], v4, s[16:19], s63 offen offset:0
    s_add_u32 s63, s47, 108544
    buffer_load_dwordx4 a[164:167], v4, s[16:19], s63 offen offset:0
    s_add_u32 s63, s48, 20480
    buffer_load_dwordx4 a[168:171], v4, s[16:19], s63 offen offset:1024
    s_add_u32 s63, s48, 108544
    buffer_load_dwordx4 a[172:175], v4, s[16:19], s63 offen offset:1024
    s_cmp_lg_u32 s32, 21
    s_cbranch_scc1 L_g4join_30
    s_add_u32 s63, s47, 0
    buffer_load_dwordx4 a[0:3], v4, s[16:19], s63 offen offset:0
    s_add_u32 s63, s47, 88064
    buffer_load_dwordx4 a[4:7], v4, s[16:19], s63 offen offset:0
    s_add_u32 s63, s47, 0
    buffer_load_dwordx4 a[8:11], v4, s[16:19], s63 offen offset:1024
    s_add_u32 s63, s47, 88064
    buffer_load_dwordx4 a[12:15], v4, s[16:19], s63 offen offset:1024
    s_add_u32 s63, s47, 0
    buffer_load_dwordx4 a[16:19], v4, s[16:19], s63 offen offset:2048
    s_add_u32 s63, s47, 88064
    buffer_load_dwordx4 a[20:23], v4, s[16:19], s63 offen offset:2048
    s_add_u32 s63, s47, 0
    buffer_load_dwordx4 a[24:27], v4, s[16:19], s63 offen offset:3072
    s_add_u32 s63, s47, 88064
    buffer_load_dwordx4 a[28:31], v4, s[16:19], s63 offen offset:3072
    s_add_u32 s63, s47, 4096
    buffer_load_dwordx4 a[32:35], v4, s[16:19], s63 offen offset:0
    s_add_u32 s63, s47, 92160
    buffer_load_dwordx4 a[36:39], v4, s[16:19], s63 offen offset:0
    s_add_u32 s63, s47, 4096
    buffer_load_dwordx4 a[40:43], v4, s[16:19], s63 offen offset:1024
    s_add_u32 s63, s47, 92160
    buffer_load_dwordx4 a[44:47], v4, s[16:19], s63 offen offset:1024
    s_add_u32 s63, s47, 4096
    buffer_load_dwordx4 a[48:51], v4, s[16:19], s63 offen offset:2048
    s_add_u32 s63, s47, 92160
    buffer_load_dwordx4 a[52:55], v4, s[16:19], s63 offen offset:2048
    s_add_u32 s63, s47, 4096
    buffer_load_dwordx4 a[56:59], v4, s[16:19], s63 offen offset:3072
    s_add_u32 s63, s47, 92160
    buffer_load_dwordx4 a[60:63], v4, s[16:19], s63 offen offset:3072
    s_branch L_g4join_30
L_g4skip_29:
    s_cmp_lg_u32 s20, 0
    s_cbranch_scc1 L_wt2_41
    s_add_u32 s4, s82, 0x1f00000
    s_addc_u32 s5, s83, 0
    s_mov_b32 s6, 0x5000
    s_mov_b32 s7, 0x00020000
    s_and_b32 s24, s22, 15
    s_lshl_b32 s24, s24, 3
    v_and_b32 v250, 7, v1
    v_add_u32 v250, s24, v250
    v_lshlrev_b32 v250, 7, v250
    v_cmp_gt_u32 vcc, 8, v1
    v_mov_b32 v249, 4
    v_mov_b32 v251, 8
    v_cndmask_b32 v249, v249, v251, vcc
    v_add_u32 v250, v250, v249
    v_mov_b32 v249, 128
    v_mov_b32 v251, 32
    v_cndmask_b32 v249, v249, v251, vcc
    s_mov_b64 exec, 0xffff
    s_mov_b32 s31, 0
L_poll_42:
    buffer_load_dword v251, v250, s[4:7], 0 offen sc0 sc1
    s_add_u32 s31, s31, 1
    s_waitcnt vmcnt(0)
    v_cmp_le_u32 vcc, v249, v251
    s_nop 0
    s_cmp_eq_u64 vcc, exec
    s_nop 1
    s_cbranch_scc1 L_polld_43
    s_cmp_lt_u32 s31, 1048576
    s_cbranch_scc1 L_poll_42
L_polld_43:
    s_mov_b64 exec, -1
L_wt2_41:
    s_barrier
    s_add_u32 s16, s82, 0x1800000
    s_addc_u32 s17, s83, 0
    s_mov_b32 s18, 0x158000
    s_mov_b32 s19, 0x00020000
    v_lshlrev_b32 v4, 4, v1
    s_mul_i32 s47, s41, 176128
    s_lshl_b32 s24, s42, 10
    s_add_u32 s47, s47, s24
    s_cmp_ge_u32 s20, 2
    s_cselect_b32 s48, 0x7f000000, 0
    s_add_u32 s48, s48, s47
    s_add_u32 s63, s47, 0
    buffer_load_dwordx4 a[0:3], v4, s[16:19], s63 offen offset:0
    s_add_u32 s63, s47, 88064
    buffer_load_dwordx4 a[4:7], v4, s[16:19], s63 offen offset:0
    s_add_u32 s63, s47, 0
    buffer_load_dwordx4 a[8:11], v4, s[16:19], s63 offen offset:1024
    s_add_u32 s63, s47, 88064
    buffer_load_dwordx4 a[12:15], v4, s[16:19], s63 offen offset:1024
    s_add_u32 s63, s47, 0
    buffer_load_dwordx4 a[16:19], v4, s[16:19], s63 offen offset:2048
    s_add_u32 s63, s47, 88064
    buffer_load_dwordx4 a[20:23], v4, s[16:19], s63 offen offset:2048
    s_add_u32 s63, s47, 0
    buffer_load_dwordx4 a[24:27], v4, s[16:19], s63 offen offset:3072
    s_add_u32 s63, s47, 88064
    buffer_load_dwordx4 a[28:31], v4, s[16:19], s63 offen offset:3072
    s_add_u32 s63, s47, 4096
    buffer_load_dwordx4 a[32:35], v4, s[16:19], s63 offen offset:0
    s_add_u32 s63, s47, 92160
    buffer_load_dwordx4 a[36:39], v4, s[16:19], s63 offen offset:0
    s_add_u32 s63, s47, 4096
    buffer_load_dwordx4 a[40:43], v4, s[16:19], s63 offen offset:1024
    s_add_u32 s63, s47, 92160
    buffer_load_dwordx4 a[44:47], v4, s[16:19], s63 offen offset:1024
    s_add_u32 s63, s47, 4096
    buffer_load_dwordx4 a[48:51], v4, s[16:19], s63 offen offset:2048
    s_add_u32 s63, s47, 92160
    buffer_load_dwordx4 a[52:55], v4, s[16:19], s63 offen offset:2048
    s_add_u32 s63, s47, 4096
    buffer_load_dwordx4 a[56:59], v4, s[16:19], s63 offen offset:3072
    s_add_u32 s63, s47, 92160
    buffer_load_dwordx4 a[60:63], v4, s[16:19], s63 offen offset:3072
    s_add_u32 s63, s47, 8192
    buffer_load_dwordx4 a[64:67], v4, s[16:19], s63 offen offset:0
    s_add_u32 s63, s47, 96256
    buffer_load_dwordx4 a[68:71], v4, s[16:19], s63 offen offset:0
    s_add_u32 s63, s47, 8192
    buffer_load_dwordx4 a[72:75], v4, s[16:19], s63 offen offset:1024
    s_add_u32 s63, s47, 96256
    buffer_load_dwordx4 a[76:79], v4, s[16:19], s63 offen offset:1024
    s_add_u32 s63, s47, 8192
    buffer_load_dwordx4 a[80:83], v4, s[16:19], s63 offen offset:2048
    s_add_u32 s63, s47, 96256
    buffer_load_dwordx4 a[84:87], v4, s[16:19], s63 offen offset:2048
    s_add_u32 s63, s47, 8192
    buffer_load_dwordx4 a[88:91], v4, s[16:19], s63 offen offset:3072
    s_add_u32 s63, s47, 96256
    buffer_load_dwordx4 a[92:95], v4, s[16:19], s63 offen offset:3072
    s_add_u32 s63, s47, 12288
    buffer_load_dwordx4 a[96:99], v4, s[16:19], s63 offen offset:0
    s_add_u32 s63, s47, 100352
    buffer_load_dwordx4 a[100:103], v4, s[16:19], s63 offen offset:0
    s_add_u32 s63, s47, 12288
    buffer_load_dwordx4 a[104:107], v4, s[16:19], s63 offen offset:1024
    s_add_u32 s63, s47, 100352
    buffer_load_dwordx4 a[108:111], v4, s[16:19], s63 offen offset:1024
    s_add_u32 s63, s47, 12288
    buffer_load_dwordx4 a[112:115], v4, s[16:19], s63 offen offset:2048
    s_add_u32 s63, s47, 100352
    buffer_load_dwordx4 a[116:119], v4, s[16:19], s63 offen offset:2048
    s_add_u32 s63, s47, 12288
    buffer_load_dwordx4 a[120:123], v4, s[16:19], s63 offen offset:3072
    s_add_u32 s63, s47, 100352
    buffer_load_dwordx4 a[124:127], v4, s[16:19], s63 offen offset:3072
    s_add_u32 s63, s47, 16384
    buffer_load_dwordx4 a[128:131], v4, s[16:19], s63 offen offset:0
    s_add_u32 s63, s47, 104448
    buffer_load_dwordx4 a[132:135], v4, s[16:19], s63 offen offset:0
    s_add_u32 s63, s47, 16384
    buffer_load_dwordx4 a[136:139], v4, s[16:19], s63 offen offset:1024
    s_add_u32 s63, s47, 104448
    buffer_load_dwordx4 a[140:143], v4, s[16:19], s63 offen offset:1024
    s_add_u32 s63, s47, 16384
    buffer_load_dwordx4 a[144:147], v4, s[16:19], s63 offen offset:2048
    s_add_u32 s63, s47, 104448
    buffer_load_dwordx4 a[148:151], v4, s[16:19], s63 offen offset:2048
    s_add_u32 s63, s47, 16384
    buffer_load_dwordx4 a[152:155], v4, s[16:19], s63 offen offset:3072
    s_add_u32 s63, s47, 104448
    buffer_load_dwordx4 a[156:159], v4, s[16:19], s63 offen offset:3072
    s_add_u32 s63, s47, 20480
    buffer_load_dwordx4 a[160:163], v4, s[16:19], s63 offen offset:0
    s_add_u32 s63, s47, 108544
    buffer_load_dwordx4 a[164:167], v4, s[16:19], s63 offen offset:0
    s_add_u32 s63, s48, 20480
    buffer_load_dwordx4 a[168:171], v4, s[16:19], s63 offen offset:1024
    s_add_u32 s63, s48, 108544
    buffer_load_dwordx4 a[172:175], v4, s[16:19], s63 offen offset:1024
L_g4join_30:
    s_add_u32 s12, s82, 0x200000
    s_addc_u32 s13, s83, 0
    s_mov_b32 s14, 0x200000
    s_mov_b32 s15, 0x00020000
    v_lshlrev_b32 v16, 6, v2
    v_lshl_add_u32 v16, v3, 3, v16
    s_lshl_b32 s24, s41, 12
    s_lshl_b32 s25, s40, 16
    s_add_u32 s24, s24, s25
    s_lshl_b32 s25, s20, 4
    s_add_u32 s24, s24, s25
    s_add_u32 s25, s24, 0
    buffer_load_dwordx2 v[8:9], v16, s[12:15], s25 offen
    s_add_u32 s25, s24, 2048
    buffer_load_dwordx2 v[10:11], v16, s[12:15], s25 offen
    s_add_u32 s25, s24, 32768
    buffer_load_dwordx2 v[12:13], v16, s[12:15], s25 offen
    s_add_u32 s25, s24, 34816
    buffer_load_dwordx2 v[14:15], v16, s[12:15], s25 offen
    s_add_u32 s8, s82, 0x800000
    s_addc_u32 s9, s83, 0
    s_mov_b32 s10, 0x560000
    s_mov_b32 s11, 0x00020000
    s_lshl_b32 s24, s20, 3
    v_xor_b32 v196, s24, v1
    v_lshlrev_b32 v196, 4, v196
    s_mul_i32 s25, s40, 176128
    s_lshl_b32 s24, s42, 10
    s_add_u32 s25, s25, s24
    s_cmp_lg_u32 s20, 0
    s_cbranch_scc1 L_wt_44
    s_add_u32 s4, s82, 0x1f04000
    s_addc_u32 s5, s83, 0
    s_mov_b32 s6, 0x1000
    s_mov_b32 s7, 0x00020000
    s_lshl_b32 s24, s40, 1
    v_add_u32 v250, s24, v1
    v_mul_u32_u24 v250, 43691, v250
    v_lshrrev_b32 v250, 17, v250
    v_lshlrev_b32 v250, 7, v250
    s_mov_b64 exec, 0x3
    s_mov_b32 s31, 0
L_poll_45:
    buffer_load_dword v251, v250, s[4:7], 0 offen sc0 sc1
    s_add_u32 s31, s31, 1
    s_waitcnt vmcnt(0)
    v_cmp_le_u32 vcc, 0xb, v251
    s_nop 0
    s_cmp_eq_u64 vcc, exec
    s_nop 1
    s_cbranch_scc1 L_polld_46
    s_cmp_lt_u32 s31, 1048576
    s_cbranch_scc1 L_poll_45
L_polld_46:
    s_mov_b64 exec, -1
L_wt_44:
    s_barrier
    s_cmp_ge_u32 s20, 2
    s_cbranch_scc1 L_g5l_47
    s_add_u32 s24, s25, 20480
    buffer_load_dwordx4 v[188:191], v196, s[8:11], s24 offen offset:1024
    s_add_u32 s24, s25, 108544
    buffer_load_dwordx4 v[192:195], v196, s[8:11], s24 offen offset:1024
L_g5l_47:
    s_add_u32 s24, s25, 0
    buffer_load_dwordx4 v[20:23], v196, s[8:11], s24 offen offset:0
    s_add_u32 s24, s25, 88064
    buffer_load_dwordx4 v[24:27], v196, s[8:11], s24 offen offset:0
    s_add_u32 s24, s25, 0
    buffer_load_dwordx4 v[28:31], v196, s[8:11], s24 offen offset:1024
    s_add_u32 s24, s25, 88064
    buffer_load_dwordx4 v[32:35], v196, s[8:11], s24 offen offset:1024
    s_add_u32 s24, s25, 0
    buffer_load_dwordx4 v[36:39], v196, s[8:11], s24 offen offset:2048
    s_add_u32 s24, s25, 88064
    buffer_load_dwordx4 v[40:43], v196, s[8:11], s24 offen offset:2048
    s_add_u32 s24, s25, 0
    buffer_load_dwordx4 v[44:47], v196, s[8:11], s24 offen offset:3072
    s_add_u32 s24, s25, 88064
    buffer_load_dwordx4 v[48:51], v196, s[8:11], s24 offen offset:3072
    s_add_u32 s24, s25, 4096
    buffer_load_dwordx4 v[52:55], v196, s[8:11], s24 offen offset:0
    s_add_u32 s24, s25, 92160
    buffer_load_dwordx4 v[56:59], v196, s[8:11], s24 offen offset:0
    s_add_u32 s24, s25, 4096
    buffer_load_dwordx4 v[60:63], v196, s[8:11], s24 offen offset:1024
    s_add_u32 s24, s25, 92160
    buffer_load_dwordx4 v[64:67], v196, s[8:11], s24 offen offset:1024
    s_waitcnt vmcnt(10)
    v_mfma_f32_32x32x16_bf16 a[176:191], v[20:23], a[0:3], 0
    v_mfma_f32_32x32x16_bf16 a[192:207], v[20:23], a[4:7], 0
    s_add_u32 s24, s25, 4096
    buffer_load_dwordx4 v[68:71], v196, s[8:11], s24 offen offset:2048
    s_add_u32 s24, s25, 92160
    buffer_load_dwordx4 v[72:75], v196, s[8:11], s24 offen offset:2048
    v_mfma_f32_32x32x16_bf16 a[208:223], v[24:27], a[0:3], 0
    v_mfma_f32_32x32x16_bf16 a[224:239], v[24:27], a[4:7], 0
    s_waitcnt vmcnt(10)
    v_mfma_f32_32x32x16_bf16 a[176:191], v[28:31], a[8:11], a[176:191]
    v_mfma_f32_32x32x16_bf16 a[192:207], v[28:31], a[12:15], a[192:207]
    s_add_u32 s24, s25, 4096
    buffer_load_dwordx4 v[76:79], v196, s[8:11], s24 offen offset:3072
    s_add_u32 s24, s25, 92160
    buffer_load_dwordx4 v[80:83], v196, s[8:11], s24 offen offset:3072
    v_mfma_f32_32x32x16_bf16 a[208:223], v[32:35], a[8:11], a[208:223]
    v_mfma_f32_32x32x16_bf16 a[224:239], v[32:35], a[12:15], a[224:239]
    s_waitcnt vmcnt(10)
    v_mfma_f32_32x32x16_bf16 a[176:191], v[36:39], a[16:19], a[176:191]
    v_mfma_f32_32x32x16_bf16 a[192:207], v[36:39], a[20:23], a[192:207]
    s_add_u32 s24, s25, 8192
    buffer_load_dwordx4 v[84:87], v196, s[8:11], s24 offen offset:0
    s_add_u32 s24, s25, 96256
    buffer_load_dwordx4 v[88:91], v196, s[8:11], s24 offen offset:0
    v_mfma_f32_32x32x16_bf16 a[208:223], v[40:43], a[16:19], a[208:223]
    v_mfma_f32_32x32x16_bf16 a[224:239], v[40:43], a[20:23], a[224:239]
    s_waitcnt vmcnt(10)
    v_mfma_f32_32x32x16_bf16 a[176:191], v[44:47], a[24:27], a[176:191]
    v_mfma_f32_32x32x16_bf16 a[192:207], v[44:47], a[28:31], a[192:207]
    s_add_u32 s24, s25, 8192
    buffer_load_dwordx4 v[92:95], v196, s[8:11], s24 offen offset:1024
    s_add_u32 s24, s25, 96256
    buffer_load_dwordx4 v[96:99], v196, s[8:11], s24 offen offset:1024
    v_mfma_f32_32x32x16_bf16 a[208:223], v[48:51], a[24:27], a[208:223]
    v_mfma_f32_32x32x16_bf16 a[224:239], v[48:51], a[28:31], a[224:239]
    s_waitcnt vmcnt(10)
    v_mfma_f32_32x32x16_bf16 a[176:191], v[52:55], a[32:35], a[176:191]
    v_mfma_f32_32x32x16_bf16 a[192:207], v[52:55], a[36:39], a[192:207]
    s_add_u32 s24, s25, 8192
    buffer_load_dwordx4 v[100:103], v196, s[8:11], s24 offen offset:2048
    s_add_u32 s24, s25, 96256
    buffer_load_dwordx4 v[104:107], v196, s[8:11], s24 offen offset:2048
    v_mfma_f32_32x32x16_bf16 a[208:223], v[56:59], a[32:35], a[208:223]
    v_mfma_f32_32x32x16_bf16 a[224:239], v[56:59], a[36:39], a[224:239]
    s_waitcnt vmcnt(10)
    v_mfma_f32_32x32x16_bf16 a[176:191], v[60:63], a[40:43], a[176:191]
    v_mfma_f32_32x32x16_bf16 a[192:207], v[60:63], a[44:47], a[192:207]
    s_add_u32 s24, s25, 8192
    buffer_load_dwordx4 v[108:111], v196, s[8:11], s24 offen offset:3072
    s_add_u32 s24, s25, 96256
    buffer_load_dwordx4 v[112:115], v196, s[8:11], s24 offen offset:3072
    v_mfma_f32_32x32x16_bf16 a[208:223], v[64:67], a[40:43], a[208:223]
    v_mfma_f32_32x32x16_bf16 a[224:239], v[64:67], a[44:47], a[224:239]
    s_waitcnt vmcnt(10)
    v_mfma_f32_32x32x16_bf16 a[176:191], v[68:71], a[48:51], a[176:191]
    v_mfma_f32_32x32x16_bf16 a[192:207], v[68:71], a[52:55], a[192:207]
    s_add_u32 s24, s25, 12288
    buffer_load_dwordx4 v[116:119], v196, s[8:11], s24 offen offset:0
    s_add_u32 s24, s25, 100352
    buffer_load_dwordx4 v[120:123], v196, s[8:11], s24 offen offset:0
    v_mfma_f32_32x32x16_bf16 a[208:223], v[72:75], a[48:51], a[208:223]
    v_mfma_f32_32x32x16_bf16 a[224:239], v[72:75], a[52:55], a[224:239]
    s_waitcnt vmcnt(10)
    v_mfma_f32_32x32x16_bf16 a[176:191], v[76:79], a[56:59], a[176:191]
    v_mfma_f32_32x32x16_bf16 a[192:207], v[76:79], a[60:63], a[192:207]
    s_add_u32 s24, s25, 12288
    buffer_load_dwordx4 v[124:127], v196, s[8:11], s24 offen offset:1024
    s_add_u32 s24, s25, 100352
    buffer_load_dwordx4 v[128:131], v196, s[8:11], s24 offen offset:1024
    v_mfma_f32_32x32x16_bf16 a[208:223], v[80:83], a[56:59], a[208:223]
    v_mfma_f32_32x32x16_bf16 a[224:239], v[80:83], a[60:63], a[224:239]
    s_waitcnt vmcnt(10)
    v_mfma_f32_32x32x16_bf16 a[176:191], v[84:87], a[64:67], a[176:191]
    v_mfma_f32_32x32x16_bf16 a[192:207], v[84:87], a[68:71], a[192:207]
    s_add_u32 s24, s25, 12288
    buffer_load_dwordx4 v[132:135], v196, s[8:11], s24 offen offset:2048
    s_add_u32 s24, s25, 100352
    buffer_load_dwordx4 v[136:139], v196, s[8:11], s24 offen offset:2048
    v_mfma_f32_32x32x16_bf16 a[208:223], v[88:91], a[64:67], a[208:223]
    v_mfma_f32_32x32x16_bf16 a[224:239], v[88:91], a[68:71], a[224:239]
    s_waitcnt vmcnt(10)
    v_mfma_f32_32x32x16_bf16 a[176:191], v[92:95], a[72:75], a[176:191]
    v_mfma_f32_32x32x16_bf16 a[192:207], v[92:95], a[76:79], a[192:207]
    s_add_u32 s24, s25, 12288
    buffer_load_dwordx4 v[140:143], v196, s[8:11], s24 offen offset:3072
    s_add_u32 s24, s25, 100352
    buffer_load_dwordx4 v[144:147], v196, s[8:11], s24 offen offset:3072
    v_mfma_f32_32x32x16_bf16 a[208:223], v[96:99], a[72:75], a[208:223]
    v_mfma_f32_32x32x16_bf16 a[224:239], v[96:99], a[76:79], a[224:239]
    s_waitcnt vmcnt(10)
    v_mfma_f32_32x32x16_bf16 a[176:191], v[100:103], a[80:83], a[176:191]
    v_mfma_f32_32x32x16_bf16 a[192:207], v[100:103], a[84:87], a[192:207]
    s_add_u32 s24, s25, 16384
    buffer_load_dwordx4 v[148:151], v196, s[8:11], s24 offen offset:0
    s_add_u32 s24, s25, 104448
    buffer_load_dwordx4 v[152:155], v196, s[8:11], s24 offen offset:0
    v_mfma_f32_32x32x16_bf16 a[208:223], v[104:107], a[80:83], a[208:223]
    v_mfma_f32_32x32x16_bf16 a[224:239], v[104:107], a[84:87], a[224:239]
    s_waitcnt vmcnt(10)
    v_mfma_f32_32x32x16_bf16 a[176:191], v[108:111], a[88:91], a[176:191]
    v_mfma_f32_32x32x16_bf16 a[192:207], v[108:111], a[92:95], a[192:207]
    s_add_u32 s24, s25, 16384
    buffer_load_dwordx4 v[156:159], v196, s[8:11], s24 offen offset:1024
    s_add_u32 s24, s25, 104448
    buffer_load_dwordx4 v[160:163], v196, s[8:11], s24 offen offset:1024
    v_mfma_f32_32x32x16_bf16 a[208:223], v[112:115], a[88:91], a[208:223]
    v_mfma_f32_32x32x16_bf16 a[224:239], v[112:115], a[92:95], a[224:239]
    s_waitcnt vmcnt(10)
    v_mfma_f32_32x32x16_bf16 a[176:191], v[116:119], a[96:99], a[176:191]
    v_mfma_f32_32x32x16_bf16 a[192:207], v[116:119], a[100:103], a[192:207]
    s_add_u32 s24, s25, 16384
    buffer_load_dwordx4 v[164:167], v196, s[8:11], s24 offen offset:2048
    s_add_u32 s24, s25, 104448
    buffer_load_dwordx4 v[168:171], v196, s[8:11], s24 offen offset:2048
    v_mfma_f32_32x32x16_bf16 a[208:223], v[120:123], a[96:99], a[208:223]
    v_mfma_f32_32x32x16_bf16 a[224:239], v[120:123], a[100:103], a[224:239]
    s_waitcnt vmcnt(10)
    v_mfma_f32_32x32x16_bf16 a[176:191], v[124:127], a[104:107], a[176:191]
    v_mfma_f32_32x32x16_bf16 a[192:207], v[124:127], a[108:111], a[192:207]
    s_add_u32 s24, s25, 16384
    buffer_load_dwordx4 v[172:175], v196, s[8:11], s24 offen offset:3072
    s_add_u32 s24, s25, 104448
    buffer_load_dwordx4 v[176:179], v196, s[8:11], s24 offen offset:3072
    v_mfma_f32_32x32x16_bf16 a[208:223], v[128:131], a[104:107], a[208:223]
    v_mfma_f32_32x32x16_bf16 a[224:239], v[128:131], a[108:111], a[224:239]
    s_waitcnt vmcnt(10)
    v_mfma_f32_32x32x16_bf16 a[176:191], v[132:135], a[112:115], a[176:191]
    v_mfma_f32_32x32x16_bf16 a[192:207], v[132:135], a[116:119], a[192:207]
    s_add_u32 s24, s25, 20480
    buffer_load_dwordx4 v[180:183], v196, s[8:11], s24 offen offset:0
    s_add_u32 s24, s25, 108544
    buffer_load_dwordx4 v[184:187], v196, s[8:11], s24 offen offset:0
    v_mfma_f32_32x32x16_bf16 a[208:223], v[136:139], a[112:115], a[208:223]
    v_mfma_f32_32x32x16_bf16 a[224:239], v[136:139], a[116:119], a[224:239]
    s_waitcnt vmcnt(10)
    v_mfma_f32_32x32x16_bf16 a[176:191], v[140:143], a[120:123], a[176:191]
    v_mfma_f32_32x32x16_bf16 a[192:207], v[140:143], a[124:127], a[192:207]
    v_mfma_f32_32x32x16_bf16 a[208:223], v[144:147], a[120:123], a[208:223]
    v_mfma_f32_32x32x16_bf16 a[224:239], v[144:147], a[124:127], a[224:239]
    s_waitcnt vmcnt(8)
    v_mfma_f32_32x32x16_bf16 a[176:191], v[148:151], a[128:131], a[176:191]
    v_mfma_f32_32x32x16_bf16 a[192:207], v[148:151], a[132:135], a[192:207]
    v_mfma_f32_32x32x16_bf16 a[208:223], v[152:155], a[128:131], a[208:223]
    v_mfma_f32_32x32x16_bf16 a[224:239], v[152:155], a[132:135], a[224:239]
    s_waitcnt vmcnt(6)
    v_mfma_f32_32x32x16_bf16 a[176:191], v[156:159], a[136:139], a[176:191]
    v_mfma_f32_32x32x16_bf16 a[192:207], v[156:159], a[140:143], a[192:207]
    v_mfma_f32_32x32x16_bf16 a[208:223], v[160:163], a[136:139], a[208:223]
    v_mfma_f32_32x32x16_bf16 a[224:239], v[160:163], a[140:143], a[224:239]
    s_waitcnt vmcnt(4)
    v_mfma_f32_32x32x16_bf16 a[176:191], v[164:167], a[144:147], a[176:191]
    v_mfma_f32_32x32x16_bf16 a[192:207], v[164:167], a[148:151], a[192:207]
    v_mfma_f32_32x32x16_bf16 a[208:223], v[168:171], a[144:147], a[208:223]
    v_mfma_f32_32x32x16_bf16 a[224:239], v[168:171], a[148:151], a[224:239]
    s_waitcnt vmcnt(2)
    v_mfma_f32_32x32x16_bf16 a[176:191], v[172:175], a[152:155], a[176:191]
    v_mfma_f32_32x32x16_bf16 a[192:207], v[172:175], a[156:159], a[192:207]
    v_mfma_f32_32x32x16_bf16 a[208:223], v[176:179], a[152:155], a[208:223]
    v_mfma_f32_32x32x16_bf16 a[224:239], v[176:179], a[156:159], a[224:239]
    s_waitcnt vmcnt(0)
    v_mfma_f32_32x32x16_bf16 a[176:191], v[180:183], a[160:163], a[176:191]
    v_mfma_f32_32x32x16_bf16 a[192:207], v[180:183], a[164:167], a[192:207]
    v_mfma_f32_32x32x16_bf16 a[208:223], v[184:187], a[160:163], a[208:223]
    v_mfma_f32_32x32x16_bf16 a[224:239], v[184:187], a[164:167], a[224:239]
    s_cmp_ge_u32 s20, 2
    s_nop 9
    s_cbranch_scc1 L_g5m_48
    v_mfma_f32_32x32x16_bf16 a[176:191], v[188:191], a[168:171], a[176:191]
    v_mfma_f32_32x32x16_bf16 a[192:207], v[188:191], a[172:175], a[192:207]
    v_mfma_f32_32x32x16_bf16 a[208:223], v[192:195], a[168:171], a[208:223]
    v_mfma_f32_32x32x16_bf16 a[224:239], v[192:195], a[172:175], a[224:239]
    s_nop 11
L_g5m_48:
    v_lshlrev_b32 v200, 4, v1
    s_xor_b32 s24, s20, 1
    s_mul_i32 s24, s24, 12288
    s_add_u32 s24, s24, 0
    v_add_u32 v197, s24, v200
    s_xor_b32 s24, s20, 2
    s_mul_i32 s24, s24, 12288
    s_add_u32 s24, s24, 4096
    v_add_u32 v198, s24, v200
    s_xor_b32 s24, s20, 3
    s_mul_i32 s24, s24, 12288
    s_add_u32 s24, s24, 8192
    v_add_u32 v199, s24, v200
    ds_write_b128 v197, a[180:183] offset:0
    ds_write_b128 v197, a[196:199] offset:1024
    ds_write_b128 v197, a[212:215] offset:2048
    ds_write_b128 v197, a[228:231] offset:3072
    ds_write_b128 v198, a[184:187] offset:0
    ds_write_b128 v198, a[200:203] offset:1024
    ds_write_b128 v198, a[216:219] offset:2048
    ds_write_b128 v198, a[232:235] offset:3072
    ds_write_b128 v199, a[188:191] offset:0
    ds_write_b128 v199, a[204:207] offset:1024
    ds_write_b128 v199, a[220:223] offset:2048
    ds_write_b128 v199, a[236:239] offset:3072
    s_waitcnt lgkmcnt(0)
    s_barrier
    s_mul_i32 s24, s20, 12288
    s_add_u32 s24, s24, 0
    v_lshlrev_b32 v201, 4, v1
    v_add_u32 v201, s24, v201
    ds_read_b128 v[20:23], v201 offset:0
    ds_read_b128 v[24:27], v201 offset:1024
    ds_read_b128 v[28:31], v201 offset:2048
    ds_read_b128 v[32:35], v201 offset:3072
    ds_read_b128 v[36:39], v201 offset:4096
    ds_read_b128 v[40:43], v201 offset:5120
    ds_read_b128 v[44:47], v201 offset:6144
    ds_read_b128 v[48:51], v201 offset:7168
    ds_read_b128 v[52:55], v201 offset:8192
    ds_read_b128 v[56:59], v201 offset:9216
    ds_read_b128 v[60:63], v201 offset:10240
    ds_read_b128 v[64:67], v201 offset:11264
    v_accvgpr_read_b32 v84, a176
    v_accvgpr_read_b32 v85, a177
    v_accvgpr_read_b32 v86, a178
    v_accvgpr_read_b32 v87, a179
    v_accvgpr_read_b32 v88, a192
    v_accvgpr_read_b32 v89, a193
    v_accvgpr_read_b32 v90, a194
    v_accvgpr_read_b32 v91, a195
    v_accvgpr_read_b32 v92, a208
    v_accvgpr_read_b32 v93, a209
    v_accvgpr_read_b32 v94, a210
    v_accvgpr_read_b32 v95, a211
    v_accvgpr_read_b32 v96, a224
    v_accvgpr_read_b32 v97, a225
    v_accvgpr_read_b32 v98, a226
    v_accvgpr_read_b32 v99, a227
    v_lshlrev_b32 v100, 16, v8
    v_and_b32 v101, 0xffff0000, v8
    v_lshlrev_b32 v102, 16, v9
    v_and_b32 v103, 0xffff0000, v9
    v_lshlrev_b32 v104, 16, v10
    v_and_b32 v105, 0xffff0000, v10
    v_lshlrev_b32 v106, 16, v11
    v_and_b32 v107, 0xffff0000, v11
    v_lshlrev_b32 v108, 16, v12
    v_and_b32 v109, 0xffff0000, v12
    v_lshlrev_b32 v110, 16, v13
    v_and_b32 v111, 0xffff0000, v13
    v_lshlrev_b32 v112, 16, v14
    v_and_b32 v113, 0xffff0000, v14
    v_lshlrev_b32 v114, 16, v15
    v_and_b32 v115, 0xffff0000, v15
    v_pk_add_f32 v[84:85], v[84:85], v[100:101]
    v_pk_add_f32 v[86:87], v[86:87], v[102:103]
    v_pk_add_f32 v[88:89], v[88:89], v[104:105]
    v_pk_add_f32 v[90:91], v[90:91], v[106:107]
    v_pk_add_f32 v[92:93], v[92:93], v[108:109]
    v_pk_add_f32 v[94:95], v[94:95], v[110:111]
    v_pk_add_f32 v[96:97], v[96:97], v[112:113]
    v_pk_add_f32 v[98:99], v[98:99], v[114:115]
    s_waitcnt lgkmcnt(0)
    v_pk_add_f32 v[68:69], v[84:85], v[20:21]
    v_pk_add_f32 v[36:37], v[36:37], v[52:53]
    v_pk_add_f32 v[70:71], v[86:87], v[22:23]
    v_pk_add_f32 v[38:39], v[38:39], v[54:55]
    v_pk_add_f32 v[72:73], v[88:89], v[24:25]
    v_pk_add_f32 v[40:41], v[40:41], v[56:57]
    v_pk_add_f32 v[74:75], v[90:91], v[26:27]
    v_pk_add_f32 v[42:43], v[42:43], v[58:59]
    v_pk_add_f32 v[76:77], v[92:93], v[28:29]
    v_pk_add_f32 v[44:45], v[44:45], v[60:61]
    v_pk_add_f32 v[78:79], v[94:95], v[30:31]
    v_pk_add_f32 v[46:47], v[46:47], v[62:63]
    v_pk_add_f32 v[80:81], v[96:97], v[32:33]
    v_pk_add_f32 v[48:49], v[48:49], v[64:65]
    v_pk_add_f32 v[82:83], v[98:99], v[34:35]
    v_pk_add_f32 v[50:51], v[50:51], v[66:67]
    v_pk_add_f32 v[68:69], v[68:69], v[36:37]
    v_pk_add_f32 v[70:71], v[70:71], v[38:39]
    v_pk_add_f32 v[72:73], v[72:73], v[40:41]
    v_pk_add_f32 v[74:75], v[74:75], v[42:43]
    v_pk_add_f32 v[76:77], v[76:77], v[44:45]
    v_pk_add_f32 v[78:79], v[78:79], v[46:47]
    v_pk_add_f32 v[80:81], v[80:81], v[48:49]
    v_pk_add_f32 v[82:83], v[82:83], v[50:51]
    s_add_u32 s8, s82, 0x400000
    s_addc_u32 s9, s83, 0
    s_mov_b32 s10, 0x200000
    s_mov_b32 s11, 0x00020000
    v_cvt_pk_bf16_f32 v116, v68, v69
    v_cvt_pk_bf16_f32 v117, v70, v71
    v_cvt_pk_bf16_f32 v118, v72, v73
    v_cvt_pk_bf16_f32 v119, v74, v75
    v_cvt_pk_bf16_f32 v120, v76, v77
    v_cvt_pk_bf16_f32 v121, v78, v79
    v_cvt_pk_bf16_f32 v122, v80, v81
    v_cvt_pk_bf16_f32 v123, v82, v83
    v_mul_u32_u24 v124, 144, v2
    v_lshl_add_u32 v124, v3, 3, v124
    s_lshl_b32 s24, s20, 4
    s_add_u32 s24, s24, 49152
    v_add_u32 v124, s24, v124
    ds_write_b64 v124, v[116:117] offset:0
    ds_write_b64 v124, v[118:119] offset:4608
    ds_write_b64 v124, v[120:121] offset:64
    ds_write_b64 v124, v[122:123] offset:4672
    s_lshl_b32 s28, s40, 6
    v_cmp_eq_u32 vcc, 0, v2
    s_cmp_eq_u32 s41, 0
    s_cselect_b64 s[26:27], vcc, 0
    v_cndmask_b32 v144, 1.0, 0, s[26:27]
    v_mul_f32 v136, v68, v144
    v_mul_f32 v128, v72, v72
    v_fmac_f32 v128, v136, v136
    v_mul_f32 v137, v69, v144
    v_mul_f32 v129, v73, v73
    v_fmac_f32 v129, v137, v137
    v_mul_f32 v138, v70, v144
    v_mul_f32 v130, v74, v74
    v_fmac_f32 v130, v138, v138
    v_mul_f32 v139, v71, v144
    v_mul_f32 v131, v75, v75
    v_fmac_f32 v131, v139, v139
    v_mul_f32 v140, v76, v144
    v_mul_f32 v132, v80, v80
    v_fmac_f32 v132, v140, v140
    v_mul_f32 v141, v77, v144
    v_mul_f32 v133, v81, v81
    v_fmac_f32 v133, v141, v141
    v_mul_f32 v142, v78, v144
    v_mul_f32 v134, v82, v82
    v_fmac_f32 v134, v142, v142
    v_mul_f32 v143, v79, v144
    v_mul_f32 v135, v83, v83
    v_fmac_f32 v135, v143, v143
    v_add_f32_dpp v128, v128, v128 row_ror:8 row_mask:0xf bank_mask:0xf
    v_add_f32_dpp v129, v129, v129 row_ror:8 row_mask:0xf bank_mask:0xf
    v_add_f32_dpp v130, v130, v130 row_ror:8 row_mask:0xf bank_mask:0xf
    v_add_f32_dpp v131, v131, v131 row_ror:8 row_mask:0xf bank_mask:0xf
    v_add_f32_dpp v132, v132, v132 row_ror:8 row_mask:0xf bank_mask:0xf
    v_add_f32_dpp v133, v133, v133 row_ror:8 row_mask:0xf bank_mask:0xf
    v_add_f32_dpp v134, v134, v134 row_ror:8 row_mask:0xf bank_mask:0xf
    v_add_f32_dpp v135, v135, v135 row_ror:8 row_mask:0xf bank_mask:0xf
    v_add_f32_dpp v128, v128, v128 row_ror:4 row_mask:0xf bank_mask:0xf
    v_add_f32_dpp v129, v129, v129 row_ror:4 row_mask:0xf bank_mask:0xf
    v_add_f32_dpp v130, v130, v130 row_ror:4 row_mask:0xf bank_mask:0xf
    v_add_f32_dpp v131, v131, v131 row_ror:4 row_mask:0xf bank_mask:0xf
    v_add_f32_dpp v132, v132, v132 row_ror:4 row_mask:0xf bank_mask:0xf
    v_add_f32_dpp v133, v133, v133 row_ror:4 row_mask:0xf bank_mask:0xf
    v_add_f32_dpp v134, v134, v134 row_ror:4 row_mask:0xf bank_mask:0xf
    v_add_f32_dpp v135, v135, v135 row_ror:4 row_mask:0xf bank_mask:0xf
    v_add_f32_dpp v128, v128, v128 row_ror:2 row_mask:0xf bank_mask:0xf
    v_add_f32_dpp v129, v129, v129 row_ror:2 row_mask:0xf bank_mask:0xf
    v_add_f32_dpp v130, v130, v130 row_ror:2 row_mask:0xf bank_mask:0xf
    v_add_f32_dpp v131, v131, v131 row_ror:2 row_mask:0xf bank_mask:0xf
    v_add_f32_dpp v132, v132, v132 row_ror:2 row_mask:0xf bank_mask:0xf
    v_add_f32_dpp v133, v133, v133 row_ror:2 row_mask:0xf bank_mask:0xf
    v_add_f32_dpp v134, v134, v134 row_ror:2 row_mask:0xf bank_mask:0xf
    v_add_f32_dpp v135, v135, v135 row_ror:2 row_mask:0xf bank_mask:0xf
    v_add_f32_dpp v128, v128, v128 row_ror:1 row_mask:0xf bank_mask:0xf
    v_add_f32_dpp v129, v129, v129 row_ror:1 row_mask:0xf bank_mask:0xf
    v_add_f32_dpp v130, v130, v130 row_ror:1 row_mask:0xf bank_mask:0xf
    v_add_f32_dpp v131, v131, v131 row_ror:1 row_mask:0xf bank_mask:0xf
    v_add_f32_dpp v132, v132, v132 row_ror:1 row_mask:0xf bank_mask:0xf
    v_add_f32_dpp v133, v133, v133 row_ror:1 row_mask:0xf bank_mask:0xf
    v_add_f32_dpp v134, v134, v134 row_ror:1 row_mask:0xf bank_mask:0xf
    v_add_f32_dpp v135, v135, v135 row_ror:1 row_mask:0xf bank_mask:0xf
    v_mov_b32 v136, v128
    v_mov_b32 v137, v129
    v_mov_b32 v138, v130
    v_mov_b32 v139, v131
    v_mov_b32 v140, v132
    v_mov_b32 v141, v133
    v_mov_b32 v142, v134
    v_mov_b32 v143, v135
    v_permlane16_swap_b32 v128, v136
    v_permlane16_swap_b32 v129, v137
    v_permlane16_swap_b32 v130, v138
    v_permlane16_swap_b32 v131, v139
    v_permlane16_swap_b32 v132, v140
    v_permlane16_swap_b32 v133, v141
    v_permlane16_swap_b32 v134, v142
    v_permlane16_swap_b32 v135, v143
    v_add_f32 v128, v128, v136
    v_add_f32 v129, v129, v137
    v_add_f32 v130, v130, v138
    v_add_f32 v131, v131, v139
    v_add_f32 v132, v132, v140
    v_add_f32 v133, v133, v141
    v_add_f32 v134, v134, v142
    v_add_f32 v135, v135, v143
    s_add_u32 s12, s82, 0x1410000
    s_addc_u32 s13, s83, 0
    s_mov_b32 s14, 0x10000
    s_mov_b32 s15, 0x00020000
    v_lshlrev_b32 v145, 4, v3
    s_lshl_b32 s24, s41, 13
    s_lshl_b32 s25, s28, 2
    s_add_u32 s24, s24, s25
    s_lshl_b32 s25, s20, 5
    s_add_u32 s24, s24, s25
    s_mov_b32 s26, 1
    s_mov_b32 s27, 1
    s_mov_b64 exec, s[26:27]
    buffer_store_dwordx4 v[128:131], v145, s[12:15], s24 offen sc1
    buffer_store_dwordx4 v[132:135], v145, s[12:15], s24 offen offset:128 sc1
    s_mov_b64 exec, -1
    s_waitcnt lgkmcnt(0)
    s_barrier
    v_lshrrev_b32 v125, 2, v0
    v_mul_u32_u24 v146, 144, v125
    v_and_b32 v125, 3, v0
    v_lshl_add_u32 v146, v125, 4, v146
    v_add_u32 v146, 49152, v146
    ds_read_b128 v[148:151], v146
    ds_read_b128 v[152:155], v146 offset:64
    v_lshlrev_b32 v156, 4, v0
    s_lshl_b32 s24, s41, 12
    s_lshl_b32 s25, s40, 16
    s_add_u32 s24, s24, s25
    s_add_u32 s25, s24, 32768
    s_waitcnt lgkmcnt(1)
    buffer_store_dwordx4 v[148:151], v156, s[8:11], s24 offen sc1
    s_waitcnt lgkmcnt(0)
    buffer_store_dwordx4 v[152:155], v156, s[8:11], s25 offen sc1
    s_add_u32 s4, s82, 0x1f00000
    s_addc_u32 s5, s83, 0
    s_mov_b32 s6, 0x5000
    s_mov_b32 s7, 0x00020000
    v_lshlrev_b32 v250, 3, v1
    v_add_u32 v250, s21, v250
    v_lshlrev_b32 v250, 7, v250
    v_mov_b32 v251, 1
    s_waitcnt vmcnt(0) lgkmcnt(0)
    s_barrier
    s_cmp_lg_u32 s20, 0
    s_cbranch_scc1 L_arr_49
    s_mov_b64 exec, 0xffff
    buffer_atomic_add v251, v250, s[4:7], 0 offen offset:12 sc1
    s_mov_b64 exec, -1
L_arr_49:
    s_cmp_ge_u32 s20, 2
    s_cbranch_scc1 L_j5skip_50
    s_lshl_b32 s24, s2, 1
    s_add_u32 s24, s24, s20
    s_lshr_b32 s25, s24, 5
    s_and_b32 s26, s24, 31
    s_lshl_b32 s27, s25, 5
    v_add_u32 v4, s27, v2
    s_lshl_b32 s27, s26, 4
    v_lshl_add_u32 v16, v3, 2, s27
    v_add_u32 v16, 0, v16
    v_lshrrev_b32 v17, 1, v16
    v_and_b32 v18, 1, v16
    v_cmp_eq_u32 vcc, 1, v16
    v_mov_b32 v19, 256
    s_nop 0
    v_cndmask_b32 v17, v17, v19, vcc
    v_mov_b32 v19, 0
    v_cndmask_b32 v18, v18, v19, vcc
    v_mul_lo_u32 v17, v17, v4
    v_lshl_add_u32 v17, v18, 7, v17
    v_and_b32 v17, 511, v17
    v_cvt_f32_u32 v17, v17
    v_mul_f32 v17, 0x3b000000, v17
    v_cos_f32 v8, v17
    v_cmp_gt_u32 vcc, 2, v16
    v_mov_b32 v20, 0x3d800000
    v_mov_b32 v19, 0x3d3504f3
    v_cndmask_b32 v20, v20, v19, vcc
    v_mul_f32 v8, v8, v20
    v_lshl_add_u32 v16, v3, 2, s27
    v_add_u32 v16, 1, v16
    v_lshrrev_b32 v17, 1, v16
    v_and_b32 v18, 1, v16
    v_cmp_eq_u32 vcc, 1, v16
    v_mov_b32 v19, 256
    s_nop 0
    v_cndmask_b32 v17, v17, v19, vcc
    v_mov_b32 v19, 0
    v_cndmask_b32 v18, v18, v19, vcc
    v_mul_lo_u32 v17, v17, v4
    v_lshl_add_u32 v17, v18, 7, v17
    v_and_b32 v17, 511, v17
    v_cvt_f32_u32 v17, v17
    v_mul_f32 v17, 0x3b000000, v17
    v_cos_f32 v9, v17
    v_cmp_gt_u32 vcc, 2, v16
    v_mov_b32 v20, 0x3d800000
    v_mov_b32 v19, 0x3d3504f3
    v_cndmask_b32 v20, v20, v19, vcc
    v_mul_f32 v9, v9, v20
    v_lshl_add_u32 v16, v3, 2, s27
    v_add_u32 v16, 2, v16
    v_lshrrev_b32 v17, 1, v16
    v_and_b32 v18, 1, v16
    v_cmp_eq_u32 vcc, 1, v16
    v_mov_b32 v19, 256
    s_nop 0
    v_cndmask_b32 v17, v17, v19, vcc
    v_mov_b32 v19, 0
    v_cndmask_b32 v18, v18, v19, vcc
    v_mul_lo_u32 v17, v17, v4
    v_lshl_add_u32 v17, v18, 7, v17
    v_and_b32 v17, 511, v17
    v_cvt_f32_u32 v17, v17
    v_mul_f32 v17, 0x3b000000, v17
    v_cos_f32 v10, v17
    v_cmp_gt_u32 vcc, 2, v16
    v_mov_b32 v20, 0x3d800000
    v_mov_b32 v19, 0x3d3504f3
    v_cndmask_b32 v20, v20, v19, vcc
    v_mul_f32 v10, v10, v20
    v_lshl_add_u32 v16, v3, 2, s27
    v_add_u32 v16, 3, v16
    v_lshrrev_b32 v17, 1, v16
    v_and_b32 v18, 1, v16
    v_cmp_eq_u32 vcc, 1, v16
    v_mov_b32 v19, 256
    s_nop 0
    v_cndmask_b32 v17, v17, v19, vcc
    v_mov_b32 v19, 0
    v_cndmask_b32 v18, v18, v19, vcc
    v_mul_lo_u32 v17, v17, v4
    v_lshl_add_u32 v17, v18, 7, v17
    v_and_b32 v17, 511, v17
    v_cvt_f32_u32 v17, v17
    v_mul_f32 v17, 0x3b000000, v17
    v_cos_f32 v11, v17
    v_cmp_gt_u32 vcc, 2, v16
    v_mov_b32 v20, 0x3d800000
    v_mov_b32 v19, 0x3d3504f3
    v_cndmask_b32 v20, v20, v19, vcc
    v_mul_f32 v11, v11, v20
    v_lshl_add_u32 v16, v3, 2, s27
    v_add_u32 v16, 8, v16
    v_lshrrev_b32 v17, 1, v16
    v_and_b32 v18, 1, v16
    v_cmp_eq_u32 vcc, 1, v16
    v_mov_b32 v19, 256
    s_nop 0
    v_cndmask_b32 v17, v17, v19, vcc
    v_mov_b32 v19, 0
    v_cndmask_b32 v18, v18, v19, vcc
    v_mul_lo_u32 v17, v17, v4
    v_lshl_add_u32 v17, v18, 7, v17
    v_and_b32 v17, 511, v17
    v_cvt_f32_u32 v17, v17
    v_mul_f32 v17, 0x3b000000, v17
    v_cos_f32 v12, v17
    v_cmp_gt_u32 vcc, 2, v16
    v_mov_b32 v20, 0x3d800000
    v_mov_b32 v19, 0x3d3504f3
    v_cndmask_b32 v20, v20, v19, vcc
    v_mul_f32 v12, v12, v20
    v_lshl_add_u32 v16, v3, 2, s27
    v_add_u32 v16, 9, v16
    v_lshrrev_b32 v17, 1, v16
    v_and_b32 v18, 1, v16
    v_cmp_eq_u32 vcc, 1, v16
    v_mov_b32 v19, 256
    s_nop 0
    v_cndmask_b32 v17, v17, v19, vcc
    v_mov_b32 v19, 0
    v_cndmask_b32 v18, v18, v19, vcc
    v_mul_lo_u32 v17, v17, v4
    v_lshl_add_u32 v17, v18, 7, v17
    v_and_b32 v17, 511, v17
    v_cvt_f32_u32 v17, v17
    v_mul_f32 v17, 0x3b000000, v17
    v_cos_f32 v13, v17
    v_cmp_gt_u32 vcc, 2, v16
    v_mov_b32 v20, 0x3d800000
    v_mov_b32 v19, 0x3d3504f3
    v_cndmask_b32 v20, v20, v19, vcc
    v_mul_f32 v13, v13, v20
    v_lshl_add_u32 v16, v3, 2, s27
    v_add_u32 v16, 10, v16
    v_lshrrev_b32 v17, 1, v16
    v_and_b32 v18, 1, v16
    v_cmp_eq_u32 vcc, 1, v16
    v_mov_b32 v19, 256
    s_nop 0
    v_cndmask_b32 v17, v17, v19, vcc
    v_mov_b32 v19, 0
    v_cndmask_b32 v18, v18, v19, vcc
    v_mul_lo_u32 v17, v17, v4
    v_lshl_add_u32 v17, v18, 7, v17
    v_and_b32 v17, 511, v17
    v_cvt_f32_u32 v17, v17
    v_mul_f32 v17, 0x3b000000, v17
    v_cos_f32 v14, v17
    v_cmp_gt_u32 vcc, 2, v16
    v_mov_b32 v20, 0x3d800000
    v_mov_b32 v19, 0x3d3504f3
    v_cndmask_b32 v20, v20, v19, vcc
    v_mul_f32 v14, v14, v20
    v_lshl_add_u32 v16, v3, 2, s27
    v_add_u32 v16, 11, v16
    v_lshrrev_b32 v17, 1, v16
    v_and_b32 v18, 1, v16
    v_cmp_eq_u32 vcc, 1, v16
    v_mov_b32 v19, 256
    s_nop 0
    v_cndmask_b32 v17, v17, v19, vcc
    v_mov_b32 v19, 0
    v_cndmask_b32 v18, v18, v19, vcc
    v_mul_lo_u32 v17, v17, v4
    v_lshl_add_u32 v17, v18, 7, v17
    v_and_b32 v17, 511, v17
    v_cvt_f32_u32 v17, v17
    v_mul_f32 v17, 0x3b000000, v17
    v_cos_f32 v15, v17
    v_cmp_gt_u32 vcc, 2, v16
    v_mov_b32 v20, 0x3d800000
    v_mov_b32 v19, 0x3d3504f3
    v_cndmask_b32 v20, v20, v19, vcc
    v_mul_f32 v15, v15, v20
    v_cvt_pk_bf16_f32 v24, v8, v9
    v_cvt_pk_bf16_f32 v25, v10, v11
    v_cvt_pk_bf16_f32 v26, v12, v13
    v_cvt_pk_bf16_f32 v27, v14, v15
    s_add_u32 s8, s82, 0x1c00000
    s_addc_u32 s9, s83, 0
    s_mov_b32 s10, 0x80000
    s_mov_b32 s11, 0x00020000
    s_lshl_b32 s24, s24, 10
    v_lshlrev_b32 v19, 4, v1
    buffer_store_dwordx4 v[24:27], v19, s[8:11], s24 offen sc1
    s_nop 1
L_j5skip_50:
    s_mov_b32 s12, s76
    s_mov_b32 s13, s77
    s_mov_b32 s14, 0x158000
    s_mov_b32 s15, 0x00020000
    s_add_u32 s8, s82, 0x1a00000
    s_addc_u32 s9, s83, 0
    s_mov_b32 s10, 0x158000
    s_mov_b32 s11, 0x00020000
    v_lshrrev_b32 v6, 2, v1
    v_lshlrev_b32 v4, 10, v6
    v_and_b32 v6, 3, v1
    v_lshl_add_u32 v4, v6, 4, v4
    v_and_b32 v6, 15, v1
    v_lshrrev_b32 v5, 2, v6
    v_lshl_add_u32 v5, v3, 2, v5
    v_lshlrev_b32 v5, 6, v5
    v_and_b32 v6, 3, v6
    v_lshl_add_u32 v5, v6, 3, v5
    v_lshrrev_b32 v6, 4, v1
    v_and_b32 v6, 1, v6
    v_lshl_add_u32 v5, v6, 5, v5
    s_lshl_b32 s26, s20, 10
    s_add_u32 s26, s26, 65536
    v_add_u32 v5, s26, v5
    v_lshlrev_b32 v6, 4, v1
    s_lshl_b32 s24, s2, 2
    s_add_u32 s24, s24, s20
    s_mul_hi_u32 s25, s24, 0x2fa0be9
    s_mul_i32 s27, s25, 86
    s_sub_u32 s27, s24, s27
    s_lshl_b32 s27, s27, 14
    s_lshl_b32 s25, s25, 6
    s_add_u32 s27, s27, s25
    s_add_u32 m0, s26, 0
    s_nop 0
    buffer_load_dwordx4 v4, s[12:15], s27 offen lds
    s_lshl_b32 s24, s2, 2
    s_add_u32 s24, s24, s20
    s_add_u32 s24, s24, 1024
    s_cmp_ge_u32 s24, 1376
    s_cbranch_scc1 L_j6one_51
    s_mul_hi_u32 s25, s24, 0x2fa0be9
    s_mul_i32 s27, s25, 86
    s_sub_u32 s27, s24, s27
    s_lshl_b32 s27, s27, 14
    s_lshl_b32 s25, s25, 6
    s_add_u32 s27, s27, s25
    s_add_u32 m0, s26, 4096
    s_nop 0
    buffer_load_dwordx4 v4, s[12:15], s27 offen lds
L_j6one_51:
    s_waitcnt vmcnt(0)
    s_lshl_b32 s24, s2, 2
    s_add_u32 s24, s24, s20
    ds_read_b64_tr_b16 v[8:9], v5 offset:0
    ds_read_b64_tr_b16 v[10:11], v5 offset:512
    s_lshl_b32 s24, s24, 10
    s_waitcnt lgkmcnt(0)
    buffer_store_dwordx4 v[8:11], v6, s[8:11], s24 offen sc1
    s_lshl_b32 s24, s2, 2
    s_add_u32 s24, s24, s20
    s_add_u32 s24, s24, 1024
    s_cmp_ge_u32 s24, 1376
    s_cbranch_scc1 L_j6end_52
    ds_read_b64_tr_b16 v[12:13], v5 offset:4096
    ds_read_b64_tr_b16 v[14:15], v5 offset:4608
    s_lshl_b32 s24, s24, 10
    s_waitcnt lgkmcnt(0)
    buffer_store_dwordx4 v[12:15], v6, s[8:11], s24 offen sc1
    s_nop 1
L_j6end_52:
    s_add_u32 s4, s82, 0x1f00000
    s_addc_u32 s5, s83, 0
    s_mov_b32 s6, 0x5000
    s_mov_b32 s7, 0x00020000
    v_lshlrev_b32 v250, 3, v1
    v_add_u32 v250, s21, v250
    v_lshlrev_b32 v250, 7, v250
    v_mov_b32 v251, 1
    s_waitcnt vmcnt(0) lgkmcnt(0)
    s_barrier
    s_cmp_lg_u32 s20, 0
    s_cbranch_scc1 L_arr_53
    s_mov_b64 exec, 0xffff
    buffer_atomic_add v251, v250, s[4:7], 0 offen offset:20 sc1
    s_mov_b64 exec, -1
L_arr_53:
    v_and_b32 v5, 15, v1
    v_lshrrev_b32 v6, 4, v1
    v_cvt_f32_u32 v111, v5
    v_cvt_f32_u32 v110, v6
    s_lshl_b32 s24, s20, 4
    v_cvt_f32_u32 v7, s24
    v_add_f32 v108, v7, v111
    v_mul_f32 v109, v108, v110
    v_mul_f32 v109, 0x3e000000, v109
    v_fmamk_f32 v92, v108, 0x00000000, v109
    v_fmamk_f32 v93, v108, 0x3c800000, v109
    v_fmamk_f32 v94, v108, 0x3d000000, v109
    v_fmamk_f32 v95, v108, 0x3d400000, v109
    v_fmamk_f32 v96, v108, 0x3d800000, v109
    v_fmamk_f32 v97, v108, 0x3da00000, v109
    v_fmamk_f32 v98, v108, 0x3dc00000, v109
    v_fmamk_f32 v99, v108, 0x3de00000, v109
    v_cos_f32 v100, v92
    v_cos_f32 v101, v93
    v_cos_f32 v102, v94
    v_cos_f32 v103, v95
    v_cos_f32 v104, v96
    v_cos_f32 v105, v97
    v_cos_f32 v106, v98
    v_cos_f32 v107, v99
    v_sin_f32 v92, v92
    v_sin_f32 v93, v93
    v_sin_f32 v94, v94
    v_sin_f32 v95, v95
    v_sin_f32 v96, v96
    v_sin_f32 v97, v97
    v_sin_f32 v98, v98
    v_sin_f32 v99, v99
    v_cvt_pk_bf16_f32 v12, v100, v101
    v_cvt_pk_bf16_f32 v13, v102, v103
    v_cvt_pk_bf16_f32 v14, v104, v105
    v_cvt_pk_bf16_f32 v15, v106, v107
    v_cvt_pk_bf16_f32 v20, v92, v93
    v_cvt_pk_bf16_f32 v21, v94, v95
    v_cvt_pk_bf16_f32 v22, v96, v97
    v_cvt_pk_bf16_f32 v23, v98, v99
    v_xor_b32 v28, 0x80008000, v20
    v_xor_b32 v29, 0x80008000, v21
    v_xor_b32 v30, 0x80008000, v22
    v_xor_b32 v31, 0x80008000, v23
    v_fmamk_f32 v92, v108, 0x3f000000, v109
    v_fmamk_f32 v93, v108, 0x3f040000, v109
    v_fmamk_f32 v94, v108, 0x3f080000, v109
    v_fmamk_f32 v95, v108, 0x3f0c0000, v109
    v_fmamk_f32 v96, v108, 0x3f100000, v109
    v_fmamk_f32 v97, v108, 0x3f140000, v109
    v_fmamk_f32 v98, v108, 0x3f180000, v109
    v_fmamk_f32 v99, v108, 0x3f1c0000, v109
    v_cos_f32 v100, v92
    v_cos_f32 v101, v93
    v_cos_f32 v102, v94
    v_cos_f32 v103, v95
    v_cos_f32 v104, v96
    v_cos_f32 v105, v97
    v_cos_f32 v106, v98
    v_cos_f32 v107, v99
    v_sin_f32 v92, v92
    v_sin_f32 v93, v93
    v_sin_f32 v94, v94
    v_sin_f32 v95, v95
    v_sin_f32 v96, v96
    v_sin_f32 v97, v97
    v_sin_f32 v98, v98
    v_sin_f32 v99, v99
    v_cvt_pk_bf16_f32 v16, v100, v101
    v_cvt_pk_bf16_f32 v17, v102, v103
    v_cvt_pk_bf16_f32 v18, v104, v105
    v_cvt_pk_bf16_f32 v19, v106, v107
    v_cvt_pk_bf16_f32 v24, v92, v93
    v_cvt_pk_bf16_f32 v25, v94, v95
    v_cvt_pk_bf16_f32 v26, v96, v97
    v_cvt_pk_bf16_f32 v27, v98, v99
    v_xor_b32 v32, 0x80008000, v24
    v_xor_b32 v33, 0x80008000, v25
    v_xor_b32 v34, 0x80008000, v26
    v_xor_b32 v35, 0x80008000, v27
    v_mov_b32 v7, v111
    v_mul_f32 v109, v7, v110
    v_mul_f32 v109, 0x3e000000, v109
    v_fmamk_f32 v92, v7, 0x00000000, v109
    v_fmamk_f32 v93, v7, 0x3d000000, v109
    v_fmamk_f32 v94, v7, 0x3d800000, v109
    v_fmamk_f32 v95, v7, 0x3dc00000, v109
    v_fmamk_f32 v96, v7, 0x3f000000, v109
    v_fmamk_f32 v97, v7, 0x3f080000, v109
    v_fmamk_f32 v98, v7, 0x3f100000, v109
    v_fmamk_f32 v99, v7, 0x3f180000, v109
    v_cos_f32 v100, v92
    v_cos_f32 v101, v93
    v_cos_f32 v102, v94
    v_cos_f32 v103, v95
    v_cos_f32 v104, v96
    v_cos_f32 v105, v97
    v_cos_f32 v106, v98
    v_cos_f32 v107, v99
    v_sin_f32 v92, v92
    v_sin_f32 v93, v93
    v_sin_f32 v94, v94
    v_sin_f32 v95, v95
    v_sin_f32 v96, v96
    v_sin_f32 v97, v97
    v_sin_f32 v98, v98
    v_sin_f32 v99, v99
    v_cvt_pk_bf16_f32 v36, v100, v101
    v_cvt_pk_bf16_f32 v37, v102, v103
    v_cvt_pk_bf16_f32 v38, v104, v105
    v_cvt_pk_bf16_f32 v39, v106, v107
    v_cvt_pk_bf16_f32 v44, v92, v93
    v_cvt_pk_bf16_f32 v45, v94, v95
    v_cvt_pk_bf16_f32 v46, v96, v97
    v_cvt_pk_bf16_f32 v47, v98, v99
    v_xor_b32 v52, 0x80008000, v44
    v_xor_b32 v53, 0x80008000, v45
    v_xor_b32 v54, 0x80008000, v46
    v_xor_b32 v55, 0x80008000, v47
    v_add_f32 v7, 0x41800000, v111
    v_mul_f32 v109, v7, v110
    v_mul_f32 v109, 0x3e000000, v109
    v_fmamk_f32 v92, v7, 0x00000000, v109
    v_fmamk_f32 v93, v7, 0x3d000000, v109
    v_fmamk_f32 v94, v7, 0x3d800000, v109
    v_fmamk_f32 v95, v7, 0x3dc00000, v109
    v_fmamk_f32 v96, v7, 0x3f000000, v109
    v_fmamk_f32 v97, v7, 0x3f080000, v109
    v_fmamk_f32 v98, v7, 0x3f100000, v109
    v_fmamk_f32 v99, v7, 0x3f180000, v109
    v_cos_f32 v100, v92
    v_cos_f32 v101, v93
    v_cos_f32 v102, v94
    v_cos_f32 v103, v95
    v_cos_f32 v104, v96
    v_cos_f32 v105, v97
    v_cos_f32 v106, v98
    v_cos_f32 v107, v99
    v_sin_f32 v92, v92
    v_sin_f32 v93, v93
    v_sin_f32 v94, v94
    v_sin_f32 v95, v95
    v_sin_f32 v96, v96
    v_sin_f32 v97, v97
    v_sin_f32 v98, v98
    v_sin_f32 v99, v99
    v_cvt_pk_bf16_f32 v40, v100, v101
    v_cvt_pk_bf16_f32 v41, v102, v103
    v_cvt_pk_bf16_f32 v42, v104, v105
    v_cvt_pk_bf16_f32 v43, v106, v107
    v_cvt_pk_bf16_f32 v48, v92, v93
    v_cvt_pk_bf16_f32 v49, v94, v95
    v_cvt_pk_bf16_f32 v50, v96, v97
    v_cvt_pk_bf16_f32 v51, v98, v99
    v_xor_b32 v56, 0x80008000, v48
    v_xor_b32 v57, 0x80008000, v49
    v_xor_b32 v58, 0x80008000, v50
    v_xor_b32 v59, 0x80008000, v51
    v_mul_f32 v109, v108, v110
    v_mul_f32 v109, 0x3b000000, v109
    v_fmamk_f32 v92, v108, 0x00000000, v109
    v_fmamk_f32 v93, v108, 0x3a000000, v109
    v_fmamk_f32 v94, v108, 0x3a800000, v109
    v_fmamk_f32 v95, v108, 0x3ac00000, v109
    v_fmamk_f32 v96, v108, 0x3c000000, v109
    v_fmamk_f32 v97, v108, 0x3c080000, v109
    v_fmamk_f32 v98, v108, 0x3c100000, v109
    v_fmamk_f32 v99, v108, 0x3c180000, v109
    v_cos_f32 v60, v92
    v_cos_f32 v61, v93
    v_cos_f32 v62, v94
    v_cos_f32 v63, v95
    v_cos_f32 v64, v96
    v_cos_f32 v65, v97
    v_cos_f32 v66, v98
    v_cos_f32 v67, v99
    v_sin_f32 v68, v92
    v_sin_f32 v69, v93
    v_sin_f32 v70, v94
    v_sin_f32 v71, v95
    v_sin_f32 v72, v96
    v_sin_f32 v73, v97
    v_sin_f32 v74, v98
    v_sin_f32 v75, v99
    s_lshl_b32 s24, s20, 4
    v_cvt_f32_u32 v7, s24
    v_fmamk_f32 v7, v110, 0x40800000, v7
    v_mov_b32 v8, v111
    v_mul_f32 v8, 0x3a000000, v8
    v_mul_f32 v109, v8, v7
    v_mov_b32 v92, v109
    v_fmamk_f32 v93, v8, 0x3f800000, v109
    v_fmamk_f32 v94, v8, 0x40000000, v109
    v_fmamk_f32 v95, v8, 0x40400000, v109
    v_add_f32 v8, 0x41800000, v111
    v_mul_f32 v8, 0x3a000000, v8
    v_mul_f32 v109, v8, v7
    v_mov_b32 v96, v109
    v_fmamk_f32 v97, v8, 0x3f800000, v109
    v_fmamk_f32 v98, v8, 0x40000000, v109
    v_fmamk_f32 v99, v8, 0x40400000, v109
    v_cos_f32 v76, v92
    v_cos_f32 v77, v93
    v_cos_f32 v78, v94
    v_cos_f32 v79, v95
    v_cos_f32 v80, v96
    v_cos_f32 v81, v97
    v_cos_f32 v82, v98
    v_cos_f32 v83, v99
    v_sin_f32 v84, v92
    v_sin_f32 v85, v93
    v_sin_f32 v86, v94
    v_sin_f32 v87, v95
    v_sin_f32 v88, v96
    v_sin_f32 v89, v97
    v_sin_f32 v90, v98
    v_sin_f32 v91, v99
    v_mul_f32 v76, 0x3a000000, v76
    v_mul_f32 v77, 0x3a000000, v77
    v_mul_f32 v78, 0x3a000000, v78
    v_mul_f32 v79, 0x3a000000, v79
    v_mul_f32 v80, 0x3a000000, v80
    v_mul_f32 v81, 0x3a000000, v81
    v_mul_f32 v82, 0x3a000000, v82
    v_mul_f32 v83, 0x3a000000, v83
    v_mul_f32 v84, 0x3a000000, v84
    v_mul_f32 v85, 0x3a000000, v85
    v_mul_f32 v86, 0x3a000000, v86
    v_mul_f32 v87, 0x3a000000, v87
    v_mul_f32 v88, 0x3a000000, v88
    v_mul_f32 v89, 0x3a000000, v89
    v_mul_f32 v90, 0x3a000000, v90
    v_mul_f32 v91, 0x3a000000, v91
    s_add_u32 s16, s82, 0x1d00000
    s_addc_u32 s17, s83, 0
    s_mov_b32 s18, 0x200000
    s_mov_b32 s19, 0x00020000
    v_lshlrev_b32 v116, 2, v5
    v_add_u32 v116, v116, v6
    v_lshlrev_b32 v116, 5, v116
    s_lshl_b32 s24, s2, 13
    s_lshl_b32 s25, s20, 11
    s_add_u32 s24, s24, s25
    buffer_load_dwordx4 v[108:111], v116, s[16:19], s24 offen
    buffer_load_dwordx4 v[112:115], v116, s[16:19], s24 offen offset:16
    s_add_u32 s8, s82, 0x400000
    s_addc_u32 s9, s83, 0
    s_mov_b32 s10, 0x200000
    s_mov_b32 s11, 0x00020000
    s_add_u32 s12, s82, 0x1410000
    s_addc_u32 s13, s83, 0
    s_mov_b32 s14, 0x10000
    s_mov_b32 s15, 0x00020000
    s_lshl_b32 s28, s2, 7
    s_add_u32 s29, s28, 64
    s_lshl_b32 s23, s2, 7
    s_mov_b32 s30, 1.0
    s_cmp_lg_u32 s2, 0
    s_cselect_b32 s28, s28, 64
    s_cselect_b32 s29, s29, 0
    s_cselect_b32 s30, s30, 0
    v_lshrrev_b32 v7, 2, v0
    v_lshlrev_b32 v200, 15, v7
    v_and_b32 v7, 3, v0
    v_lshl_add_u32 v200, v7, 4, v200
    v_lshlrev_b32 v201, 5, v0
    v_lshrrev_b32 v7, 3, v1
    s_lshl_b32 s24, s20, 4
    v_add_u32 v7, s24, v7
    v_lshlrev_b32 v202, 15, v7
    v_and_b32 v7, 7, v1
    v_lshl_add_u32 v202, v7, 4, v202
    s_cmp_lg_u32 s20, 0
    s_cbranch_scc1 L_wt_54
    s_add_u32 s4, s82, 0x1f0000c
    s_addc_u32 s5, s83, 0
    s_mov_b32 s6, 0x4ff4
    s_mov_b32 s7, 0x00020000
    s_and_b32 s24, s22, 15
    s_lshl_b32 s24, s24, 3
    v_add_u32 v250, s24, v1
    v_lshlrev_b32 v250, 7, v250
    s_mov_b64 exec, 0xff
    s_mov_b32 s31, 0
L_poll_55:
    buffer_load_dword v251, v250, s[4:7], 0 offen sc0 sc1
    s_add_u32 s31, s31, 1
    s_waitcnt vmcnt(0)
    v_cmp_le_u32 vcc, 0x20, v251
    s_nop 0
    s_cmp_eq_u64 vcc, exec
    s_nop 1
    s_cbranch_scc1 L_polld_56
    s_cmp_lt_u32 s31, 1048576
    s_cbranch_scc1 L_poll_55
L_polld_56:
    s_mov_b64 exec, -1
L_wt_54:
    s_barrier
    buffer_load_dwordx4 v[120:123], v200, s[8:11], s28 offen
    buffer_load_dwordx4 v[124:127], v200, s[8:11], s29 offen
    buffer_load_dwordx4 v[192:195], v202, s[8:11], s23 offen
    s_add_u32 s24, s23, 262144
    buffer_load_dwordx4 v[196:199], v202, s[8:11], s24 offen
    s_mov_b32 s24, 0
    buffer_load_dwordx4 v[128:131], v201, s[12:15], s24 offen
    buffer_load_dwordx4 v[132:135], v201, s[12:15], s24 offen offset:16
    s_add_u32 s24, s24, 8192
    buffer_load_dwordx4 v[136:139], v201, s[12:15], s24 offen
    buffer_load_dwordx4 v[140:143], v201, s[12:15], s24 offen offset:16
    s_add_u32 s24, s24, 8192
    buffer_load_dwordx4 v[144:147], v201, s[12:15], s24 offen
    buffer_load_dwordx4 v[148:151], v201, s[12:15], s24 offen offset:16
    s_add_u32 s24, s24, 8192
    buffer_load_dwordx4 v[152:155], v201, s[12:15], s24 offen
    buffer_load_dwordx4 v[156:159], v201, s[12:15], s24 offen offset:16
    s_add_u32 s24, s24, 8192
    buffer_load_dwordx4 v[160:163], v201, s[12:15], s24 offen
    buffer_load_dwordx4 v[164:167], v201, s[12:15], s24 offen offset:16
    s_add_u32 s24, s24, 8192
    buffer_load_dwordx4 v[168:171], v201, s[12:15], s24 offen
    buffer_load_dwordx4 v[172:175], v201, s[12:15], s24 offen offset:16
    s_add_u32 s24, s24, 8192
    buffer_load_dwordx4 v[176:179], v201, s[12:15], s24 offen
    buffer_load_dwordx4 v[180:183], v201, s[12:15], s24 offen offset:16
    s_add_u32 s24, s24, 8192
    buffer_load_dwordx4 v[184:187], v201, s[12:15], s24 offen
    buffer_load_dwordx4 v[188:191], v201, s[12:15], s24 offen offset:16
    v_lshrrev_b32 v7, 3, v0
    v_mul_u32_u24 v206, 144, v7
    v_and_b32 v7, 7, v0
    v_lshl_add_u32 v206, v7, 4, v206
    v_mul_u32_u24 v207, 144, v5
    v_lshl_add_u32 v207, v6, 4, v207
    v_mul_u32_u24 v208, 144, v5
    v_lshl_add_u32 v208, v6, 3, v208
    s_lshl_b32 s24, s20, 5
    v_add_u32 v208, s24, v208
    s_waitcnt vmcnt(12)
    v_pk_add_f32 v[128:129], v[128:129], v[136:137]
    v_pk_add_f32 v[130:131], v[130:131], v[138:139]
    v_pk_add_f32 v[132:133], v[132:133], v[140:141]
    v_pk_add_f32 v[134:135], v[134:135], v[142:143]
    s_waitcnt vmcnt(10)
    v_pk_add_f32 v[128:129], v[128:129], v[144:145]
    v_pk_add_f32 v[130:131], v[130:131], v[146:147]
    v_pk_add_f32 v[132:133], v[132:133], v[148:149]
    v_pk_add_f32 v[134:135], v[134:135], v[150:151]
    s_waitcnt vmcnt(8)
    v_pk_add_f32 v[128:129], v[128:129], v[152:153]
    v_pk_add_f32 v[130:131], v[130:131], v[154:155]
    v_pk_add_f32 v[132:133], v[132:133], v[156:157]
    v_pk_add_f32 v[134:135], v[134:135], v[158:159]
    s_waitcnt vmcnt(6)
    v_pk_add_f32 v[128:129], v[128:129], v[160:161]
    v_pk_add_f32 v[130:131], v[130:131], v[162:163]
    v_pk_add_f32 v[132:133], v[132:133], v[164:165]
    v_pk_add_f32 v[134:135], v[134:135], v[166:167]
    s_waitcnt vmcnt(4)
    v_pk_add_f32 v[128:129], v[128:129], v[168:169]
    v_pk_add_f32 v[130:131], v[130:131], v[170:171]
    v_pk_add_f32 v[132:133], v[132:133], v[172:173]
    v_pk_add_f32 v[134:135], v[134:135], v[174:175]
    s_waitcnt vmcnt(2)
    v_pk_add_f32 v[128:129], v[128:129], v[176:177]
    v_pk_add_f32 v[130:131], v[130:131], v[178:179]
    v_pk_add_f32 v[132:133], v[132:133], v[180:181]
    v_pk_add_f32 v[134:135], v[134:135], v[182:183]
    s_waitcnt vmcnt(0)
    v_pk_add_f32 v[128:129], v[128:129], v[184:185]
    v_pk_add_f32 v[130:131], v[130:131], v[186:187]
    v_pk_add_f32 v[132:133], v[132:133], v[188:189]
    v_pk_add_f32 v[134:135], v[134:135], v[190:191]
    v_mul_f32 v128, 0x3b000000, v128
    v_mul_f32 v129, 0x3b000000, v129
    v_mul_f32 v130, 0x3b000000, v130
    v_mul_f32 v131, 0x3b000000, v131
    v_mul_f32 v132, 0x3b000000, v132
    v_mul_f32 v133, 0x3b000000, v133
    v_mul_f32 v134, 0x3b000000, v134
    v_mul_f32 v135, 0x3b000000, v135
    v_add_f32 v128, 0x3727c5ac, v128
    v_add_f32 v129, 0x3727c5ac, v129
    v_add_f32 v130, 0x3727c5ac, v130
    v_add_f32 v131, 0x3727c5ac, v131
    v_add_f32 v132, 0x3727c5ac, v132
    v_add_f32 v133, 0x3727c5ac, v133
    v_add_f32 v134, 0x3727c5ac, v134
    v_add_f32 v135, 0x3727c5ac, v135
    v_rsq_f32 v128, v128
    v_rsq_f32 v129, v129
    v_rsq_f32 v130, v130
    v_rsq_f32 v131, v131
    v_rsq_f32 v132, v132
    v_rsq_f32 v133, v133
    v_rsq_f32 v134, v134
    v_rsq_f32 v135, v135
    v_mul_f32 v136, s30, v128
    v_mul_f32 v137, s30, v129
    v_mul_f32 v138, s30, v130
    v_mul_f32 v139, s30, v131
    v_mul_f32 v140, s30, v132
    v_mul_f32 v141, s30, v133
    v_mul_f32 v142, s30, v134
    v_mul_f32 v143, s30, v135
    v_lshlrev_b32 v92, 16, v120
    v_and_b32 v93, 0xffff0000, v120
    v_lshlrev_b32 v94, 16, v121
    v_and_b32 v95, 0xffff0000, v121
    v_lshlrev_b32 v96, 16, v122
    v_and_b32 v97, 0xffff0000, v122
    v_lshlrev_b32 v98, 16, v123
    v_and_b32 v99, 0xffff0000, v123
    v_pk_mul_f32 v[92:93], v[92:93], v[128:129]
    v_pk_mul_f32 v[94:95], v[94:95], v[130:131]
    v_pk_mul_f32 v[96:97], v[96:97], v[132:133]
    v_pk_mul_f32 v[98:99], v[98:99], v[134:135]
    v_cvt_pk_bf16_f32 v144, v92, v93
    v_cvt_pk_bf16_f32 v145, v94, v95
    v_cvt_pk_bf16_f32 v146, v96, v97
    v_cvt_pk_bf16_f32 v147, v98, v99
    ds_write_b128 v206, v[144:147] offset:0
    v_lshlrev_b32 v92, 16, v124
    v_and_b32 v93, 0xffff0000, v124
    v_lshlrev_b32 v94, 16, v125
    v_and_b32 v95, 0xffff0000, v125
    v_lshlrev_b32 v96, 16, v126
    v_and_b32 v97, 0xffff0000, v126
    v_lshlrev_b32 v98, 16, v127
    v_and_b32 v99, 0xffff0000, v127
    v_pk_mul_f32 v[92:93], v[92:93], v[136:137]
    v_pk_mul_f32 v[94:95], v[94:95], v[138:139]
    v_pk_mul_f32 v[96:97], v[96:97], v[140:141]
    v_pk_mul_f32 v[98:99], v[98:99], v[142:143]
    v_cvt_pk_bf16_f32 v148, v92, v93
    v_cvt_pk_bf16_f32 v149, v94, v95
    v_cvt_pk_bf16_f32 v150, v96, v97
    v_cvt_pk_bf16_f32 v151, v98, v99
    ds_write_b128 v206, v[148:151] offset:4608
    s_waitcnt lgkmcnt(0)
    s_barrier
    ds_read_b128 v[160:163], v207 offset:0
    ds_read_b128 v[168:171], v207 offset:2304
    ds_read_b128 v[176:179], v207 offset:4608
    ds_read_b128 v[184:187], v207 offset:6912
    ds_read_b128 v[164:167], v207 offset:64
    ds_read_b128 v[172:175], v207 offset:2368
    ds_read_b128 v[180:183], v207 offset:4672
    ds_read_b128 v[188:191], v207 offset:6976
    s_waitcnt lgkmcnt(4)
    s_add_u32 s16, s82, 0x1500000
    s_addc_u32 s17, s83, 0
    s_mov_b32 s18, 0x2b0000
    s_mov_b32 s19, 0x00020000
    v_lshlrev_b32 v4, 4, v1
    s_add_u32 s60, s20, 0
    s_and_b32 s60, s60, 3
    s_lshl_b32 s60, s60, 13
    s_lshl_b32 s61, s34, 16
    s_add_u32 s61, s61, s60
    s_add_u32 s60, s61, 0
    buffer_load_dwordx4 a[0:3], v4, s[16:19], s60 offen offset:0
    v_mfma_f32_16x16x32_bf16 v[212:215], v[160:163], v[12:15], 0
    v_mfma_f32_16x16x32_bf16 v[220:223], v[176:179], v[12:15], 0
    v_mfma_f32_16x16x32_bf16 v[216:219], v[168:171], v[12:15], 0
    v_mfma_f32_16x16x32_bf16 v[224:227], v[184:187], v[12:15], 0
    v_mfma_f32_16x16x32_bf16 v[212:215], v[176:179], v[20:23], v[212:215]
    s_add_u32 s60, s61, 32768
    buffer_load_dwordx4 a[4:7], v4, s[16:19], s60 offen offset:0
    v_mfma_f32_16x16x32_bf16 v[220:223], v[160:163], v[28:31], v[220:223]
    v_mfma_f32_16x16x32_bf16 v[216:219], v[184:187], v[20:23], v[216:219]
    v_mfma_f32_16x16x32_bf16 v[224:227], v[168:171], v[28:31], v[224:227]
    s_waitcnt lgkmcnt(0)
    v_mfma_f32_16x16x32_bf16 v[212:215], v[164:167], v[16:19], v[212:215]
    s_add_u32 s60, s61, 0
    buffer_load_dwordx4 a[8:11], v4, s[16:19], s60 offen offset:1024
    v_mfma_f32_16x16x32_bf16 v[220:223], v[180:183], v[16:19], v[220:223]
    v_mfma_f32_16x16x32_bf16 v[216:219], v[172:175], v[16:19], v[216:219]
    v_mfma_f32_16x16x32_bf16 v[224:227], v[188:191], v[16:19], v[224:227]
    v_mfma_f32_16x16x32_bf16 v[212:215], v[180:183], v[24:27], v[212:215]
    v_mfma_f32_16x16x32_bf16 v[220:223], v[164:167], v[32:35], v[220:223]
    s_add_u32 s60, s61, 32768
    buffer_load_dwordx4 a[12:15], v4, s[16:19], s60 offen offset:1024
    v_mfma_f32_16x16x32_bf16 v[216:219], v[188:191], v[24:27], v[216:219]
    v_mfma_f32_16x16x32_bf16 v[224:227], v[172:175], v[32:35], v[224:227]
    s_nop 2
    v_pk_mul_f32 v[92:93], v[212:213], v[60:61]
    v_pk_mul_f32 v[100:101], v[220:221], v[60:61]
    v_pk_mul_f32 v[94:95], v[214:215], v[62:63]
    s_add_u32 s60, s61, 0
    buffer_load_dwordx4 a[16:19], v4, s[16:19], s60 offen offset:2048
    v_pk_mul_f32 v[102:103], v[222:223], v[62:63]
    v_pk_mul_f32 v[96:97], v[216:217], v[64:65]
    v_pk_mul_f32 v[104:105], v[224:225], v[64:65]
    v_pk_mul_f32 v[98:99], v[218:219], v[66:67]
    v_pk_mul_f32 v[106:107], v[226:227], v[66:67]
    s_add_u32 s60, s61, 32768
    buffer_load_dwordx4 a[20:23], v4, s[16:19], s60 offen offset:2048
    v_pk_fma_f32 v[92:93], v[220:221], v[68:69], v[92:93]
    v_pk_fma_f32 v[100:101], v[212:213], v[68:69], v[100:101] neg_lo:[1,0,0] neg_hi:[1,0,0]
    v_pk_fma_f32 v[94:95], v[222:223], v[70:71], v[94:95]
    v_pk_fma_f32 v[102:103], v[214:215], v[70:71], v[102:103] neg_lo:[1,0,0] neg_hi:[1,0,0]
    v_pk_fma_f32 v[96:97], v[224:225], v[72:73], v[96:97]
    s_add_u32 s60, s61, 0
    buffer_load_dwordx4 a[24:27], v4, s[16:19], s60 offen offset:3072
    v_pk_fma_f32 v[104:105], v[216:217], v[72:73], v[104:105] neg_lo:[1,0,0] neg_hi:[1,0,0]
    v_pk_fma_f32 v[98:99], v[226:227], v[74:75], v[98:99]
    v_pk_fma_f32 v[106:107], v[218:219], v[74:75], v[106:107] neg_lo:[1,0,0] neg_hi:[1,0,0]
    v_cvt_pk_bf16_f32 v228, v92, v93
    v_cvt_pk_bf16_f32 v232, v100, v101
    s_add_u32 s60, s61, 32768
    buffer_load_dwordx4 a[28:31], v4, s[16:19], s60 offen offset:3072
    v_cvt_pk_bf16_f32 v229, v94, v95
    v_cvt_pk_bf16_f32 v233, v102, v103
    v_cvt_pk_bf16_f32 v230, v96, v97
    v_cvt_pk_bf16_f32 v234, v104, v105
    v_cvt_pk_bf16_f32 v231, v98, v99
    s_add_u32 s60, s61, 4096
    buffer_load_dwordx4 a[32:35], v4, s[16:19], s60 offen offset:0
    v_cvt_pk_bf16_f32 v235, v106, v107
    v_mfma_f32_16x16x32_bf16 v[128:131], v[36:39], v[228:231], 0
    s_nop 0
    v_mfma_f32_16x16x32_bf16 v[136:139], v[36:39], v[232:235], 0
    v_mfma_f32_16x16x32_bf16 v[132:135], v[40:43], v[228:231], 0
    v_mfma_f32_16x16x32_bf16 v[140:143], v[40:43], v[232:235], 0
    s_add_u32 s60, s61, 36864
    buffer_load_dwordx4 a[36:39], v4, s[16:19], s60 offen offset:0
    v_mfma_f32_16x16x32_bf16 v[128:131], v[44:47], v[232:235], v[128:131]
    v_mfma_f32_16x16x32_bf16 v[136:139], v[52:55], v[228:231], v[136:139]
    v_mfma_f32_16x16x32_bf16 v[132:135], v[48:51], v[232:235], v[132:135]
    v_mfma_f32_16x16x32_bf16 v[140:143], v[56:59], v[228:231], v[140:143]
    v_lshlrev_b32 v212, 16, v108
    s_add_u32 s60, s61, 4096
    buffer_load_dwordx4 a[40:43], v4, s[16:19], s60 offen offset:1024
    v_and_b32 v220, 0xffff0000, v108
    v_lshlrev_b32 v213, 16, v109
    v_and_b32 v221, 0xffff0000, v109
    v_lshlrev_b32 v214, 16, v110
    v_and_b32 v222, 0xffff0000, v110
    s_add_u32 s60, s61, 36864
    buffer_load_dwordx4 a[44:47], v4, s[16:19], s60 offen offset:1024
    v_lshlrev_b32 v215, 16, v111
    v_and_b32 v223, 0xffff0000, v111
    v_lshlrev_b32 v216, 16, v112
    v_and_b32 v224, 0xffff0000, v112
    v_lshlrev_b32 v217, 16, v113
    s_add_u32 s60, s61, 4096
    buffer_load_dwordx4 a[48:51], v4, s[16:19], s60 offen offset:2048
    v_and_b32 v225, 0xffff0000, v113
    v_lshlrev_b32 v218, 16, v114
    v_and_b32 v226, 0xffff0000, v114
    v_lshlrev_b32 v219, 16, v115
    v_and_b32 v227, 0xffff0000, v115
    s_add_u32 s60, s61, 36864
    buffer_load_dwordx4 a[52:55], v4, s[16:19], s60 offen offset:2048
    v_pk_mul_f32 v[92:93], v[128:129], v[212:213]
    v_pk_mul_f32 v[100:101], v[136:137], v[212:213]
    v_pk_mul_f32 v[94:95], v[130:131], v[214:215]
    v_pk_mul_f32 v[102:103], v[138:139], v[214:215]
    v_pk_mul_f32 v[96:97], v[132:133], v[216:217]
    s_add_u32 s60, s61, 4096
    buffer_load_dwordx4 a[56:59], v4, s[16:19], s60 offen offset:3072
    v_pk_mul_f32 v[104:105], v[140:141], v[216:217]
    v_pk_mul_f32 v[98:99], v[134:135], v[218:219]
    v_pk_mul_f32 v[106:107], v[142:143], v[218:219]
    v_pk_fma_f32 v[92:93], v[136:137], v[220:221], v[92:93] neg_lo:[1,0,0] neg_hi:[1,0,0]
    v_pk_fma_f32 v[100:101], v[128:129], v[220:221], v[100:101]
    s_add_u32 s60, s61, 36864
    buffer_load_dwordx4 a[60:63], v4, s[16:19], s60 offen offset:3072
    v_pk_fma_f32 v[94:95], v[138:139], v[222:223], v[94:95] neg_lo:[1,0,0] neg_hi:[1,0,0]
    v_pk_fma_f32 v[102:103], v[130:131], v[222:223], v[102:103]
    v_pk_fma_f32 v[96:97], v[140:141], v[224:225], v[96:97] neg_lo:[1,0,0] neg_hi:[1,0,0]
    v_pk_fma_f32 v[104:105], v[132:133], v[224:225], v[104:105]
    v_pk_fma_f32 v[98:99], v[142:143], v[226:227], v[98:99] neg_lo:[1,0,0] neg_hi:[1,0,0]
    s_add_u32 s60, s20, 1
    s_and_b32 s60, s60, 3
    s_lshl_b32 s60, s60, 13
    s_lshl_b32 s61, s34, 16
    s_add_u32 s61, s61, s60
    s_add_u32 s60, s61, 0
    buffer_load_dwordx4 a[64:67], v4, s[16:19], s60 offen offset:0
    v_pk_fma_f32 v[106:107], v[134:135], v[226:227], v[106:107]
    v_cvt_pk_bf16_f32 v228, v92, v93
    v_cvt_pk_bf16_f32 v232, v100, v101
    v_cvt_pk_bf16_f32 v229, v94, v95
    v_cvt_pk_bf16_f32 v233, v102, v103
    s_add_u32 s60, s61, 32768
    buffer_load_dwordx4 a[68:71], v4, s[16:19], s60 offen offset:0
    v_cvt_pk_bf16_f32 v230, v96, v97
    v_cvt_pk_bf16_f32 v234, v104, v105
    v_cvt_pk_bf16_f32 v231, v98, v99
    v_cvt_pk_bf16_f32 v235, v106, v107
    s_nop 0
    v_mfma_f32_16x16x32_bf16 v[128:131], v[228:231], v[36:39], 0
    s_add_u32 s60, s61, 0
    buffer_load_dwordx4 a[72:75], v4, s[16:19], s60 offen offset:1024
    v_mfma_f32_16x16x32_bf16 v[136:139], v[232:235], v[36:39], 0
    v_mfma_f32_16x16x32_bf16 v[132:135], v[228:231], v[40:43], 0
    v_mfma_f32_16x16x32_bf16 v[140:143], v[232:235], v[40:43], 0
    v_mfma_f32_16x16x32_bf16 v[128:131], v[232:235], v[52:55], v[128:131]
    v_mfma_f32_16x16x32_bf16 v[136:139], v[228:231], v[44:47], v[136:139]
    s_add_u32 s60, s61, 32768
    buffer_load_dwordx4 a[76:79], v4, s[16:19], s60 offen offset:1024
    v_mfma_f32_16x16x32_bf16 v[132:135], v[232:235], v[56:59], v[132:135]
    v_mfma_f32_16x16x32_bf16 v[140:143], v[228:231], v[48:51], v[140:143]
    s_nop 2
    v_pk_mul_f32 v[92:93], v[128:129], v[76:77]
    v_pk_mul_f32 v[100:101], v[136:137], v[76:77]
    v_pk_mul_f32 v[94:95], v[130:131], v[78:79]
    s_add_u32 s60, s61, 0
    buffer_load_dwordx4 a[80:83], v4, s[16:19], s60 offen offset:2048
    v_pk_mul_f32 v[102:103], v[138:139], v[78:79]
    v_pk_mul_f32 v[96:97], v[132:133], v[80:81]
    v_pk_mul_f32 v[104:105], v[140:141], v[80:81]
    v_pk_mul_f32 v[98:99], v[134:135], v[82:83]
    v_pk_mul_f32 v[106:107], v[142:143], v[82:83]
    s_add_u32 s60, s61, 32768
    buffer_load_dwordx4 a[84:87], v4, s[16:19], s60 offen offset:2048
    v_pk_fma_f32 v[92:93], v[136:137], v[84:85], v[92:93] neg_lo:[1,0,0] neg_hi:[1,0,0]
    v_pk_fma_f32 v[100:101], v[128:129], v[84:85], v[100:101]
    v_pk_fma_f32 v[94:95], v[138:139], v[86:87], v[94:95] neg_lo:[1,0,0] neg_hi:[1,0,0]
    v_pk_fma_f32 v[102:103], v[130:131], v[86:87], v[102:103]
    v_pk_fma_f32 v[96:97], v[140:141], v[88:89], v[96:97] neg_lo:[1,0,0] neg_hi:[1,0,0]
    s_add_u32 s60, s61, 0
    buffer_load_dwordx4 a[88:91], v4, s[16:19], s60 offen offset:3072
    v_pk_fma_f32 v[104:105], v[132:133], v[88:89], v[104:105]
    v_pk_fma_f32 v[98:99], v[142:143], v[90:91], v[98:99] neg_lo:[1,0,0] neg_hi:[1,0,0]
    v_pk_fma_f32 v[106:107], v[134:135], v[90:91], v[106:107]
    v_cvt_pk_bf16_f32 v228, v92, v93
    v_cvt_pk_bf16_f32 v232, v100, v101
    s_add_u32 s60, s61, 32768
    buffer_load_dwordx4 a[92:95], v4, s[16:19], s60 offen offset:3072
    v_cvt_pk_bf16_f32 v229, v94, v95
    v_cvt_pk_bf16_f32 v233, v102, v103
    v_cvt_pk_bf16_f32 v230, v96, v97
    v_cvt_pk_bf16_f32 v234, v104, v105
    v_cvt_pk_bf16_f32 v231, v98, v99
    s_add_u32 s60, s61, 4096
    buffer_load_dwordx4 a[96:99], v4, s[16:19], s60 offen offset:0
    v_cvt_pk_bf16_f32 v235, v106, v107
    ds_write_b64 v208, v[228:229] offset:9216
    ds_write_b64 v208, v[232:233] offset:13824
    ds_write_b64 v208, v[230:231] offset:11520
    ds_write_b64 v208, v[234:235] offset:16128
    s_add_u32 s60, s61, 36864
    buffer_load_dwordx4 a[100:103], v4, s[16:19], s60 offen offset:0
    s_waitcnt lgkmcnt(0)
    s_barrier
    ds_read_b128 v[160:163], v207 offset:9216
    ds_read_b128 v[168:171], v207 offset:11520
    ds_read_b128 v[176:179], v207 offset:13824
    s_add_u32 s60, s61, 4096
    buffer_load_dwordx4 a[104:107], v4, s[16:19], s60 offen offset:1024
    ds_read_b128 v[184:187], v207 offset:16128
    ds_read_b128 v[164:167], v207 offset:9280
    ds_read_b128 v[172:175], v207 offset:11584
    ds_read_b128 v[180:183], v207 offset:13888
    ds_read_b128 v[188:191], v207 offset:16192
    s_add_u32 s60, s61, 36864
    buffer_load_dwordx4 a[108:111], v4, s[16:19], s60 offen offset:1024
    s_waitcnt lgkmcnt(4)
    v_mfma_f32_16x16x32_bf16 v[212:215], v[12:15], v[160:163], 0
    v_mfma_f32_16x16x32_bf16 v[220:223], v[12:15], v[176:179], 0
    v_mfma_f32_16x16x32_bf16 v[216:219], v[12:15], v[168:171], 0
    v_mfma_f32_16x16x32_bf16 v[224:227], v[12:15], v[184:187], 0
    v_mfma_f32_16x16x32_bf16 v[212:215], v[28:31], v[176:179], v[212:215]
    v_mfma_f32_16x16x32_bf16 v[220:223], v[20:23], v[160:163], v[220:223]
    v_mfma_f32_16x16x32_bf16 v[216:219], v[28:31], v[184:187], v[216:219]
    v_mfma_f32_16x16x32_bf16 v[224:227], v[20:23], v[168:171], v[224:227]
    s_waitcnt lgkmcnt(0)
    v_mfma_f32_16x16x32_bf16 v[212:215], v[16:19], v[164:167], v[212:215]
    v_mfma_f32_16x16x32_bf16 v[220:223], v[16:19], v[180:183], v[220:223]
    v_mfma_f32_16x16x32_bf16 v[216:219], v[16:19], v[172:175], v[216:219]
    v_mfma_f32_16x16x32_bf16 v[224:227], v[16:19], v[188:191], v[224:227]
    v_mfma_f32_16x16x32_bf16 v[212:215], v[32:35], v[180:183], v[212:215]
    v_mfma_f32_16x16x32_bf16 v[220:223], v[24:27], v[164:167], v[220:223]
    v_mfma_f32_16x16x32_bf16 v[216:219], v[32:35], v[188:191], v[216:219]
    v_mfma_f32_16x16x32_bf16 v[224:227], v[24:27], v[172:175], v[224:227]
    v_mul_u32_u24 v236, 272, v5
    v_lshl_add_u32 v236, v6, 4, v236
    s_lshl_b32 s24, s20, 6
    v_add_u32 v236, s24, v236
    s_nop 0
    ds_write_b128 v236, v[212:215] offset:18432
    s_nop 0
    ds_write_b128 v236, v[216:219] offset:22784
    ds_write_b128 v236, v[220:223] offset:27136
    ds_write_b128 v236, v[224:227] offset:31488
    s_waitcnt lgkmcnt(0)
    s_barrier
    v_lshrrev_b32 v7, 2, v1
    v_and_b32 v7, 1, v7
    s_cmp_eq_u32 s2, 0
    s_cselect_b32 s24, 1, 0
    v_xor_b32 v237, s24, v7
    v_cmp_eq_u32 vcc, 0, v237
    v_mov_b32 v238, s30
    s_nop 0
    v_cndmask_b32 v238, v238, 1.0, vcc
    v_mul_u32_u24 v236, 8704, v237
    v_lshrrev_b32 v7, 4, v1
    s_lshl_b32 s24, s20, 3
    v_add_u32 v7, s24, v7
    v_mul_u32_u24 v7, 272, v7
    v_add_u32 v236, v236, v7
    v_lshrrev_b32 v7, 3, v1
    v_and_b32 v7, 1, v7
    v_lshl_add_u32 v236, v7, 7, v236
    v_and_b32 v7, 3, v1
    v_lshl_add_u32 v236, v7, 5, v236
    ds_read_b128 v[144:147], v236 offset:18432
    ds_read_b128 v[148:151], v236 offset:18448
    ds_read_b128 v[152:155], v236 offset:19520
    ds_read_b128 v[156:159], v236 offset:19536
    s_add_u32 s8, s82, 0x600000
    s_addc_u32 s9, s83, 0
    s_mov_b32 s10, 0x200000
    s_mov_b32 s11, 0x00020000
    v_lshlrev_b32 v92, 16, v192
    v_and_b32 v93, 0xffff0000, v192
    v_lshlrev_b32 v94, 16, v193
    v_and_b32 v95, 0xffff0000, v193
    v_lshlrev_b32 v96, 16, v194
    v_and_b32 v97, 0xffff0000, v194
    v_lshlrev_b32 v98, 16, v195
    v_and_b32 v99, 0xffff0000, v195
    s_waitcnt lgkmcnt(2)
    v_fma_f32 v92, v144, v238, v92
    v_fma_f32 v93, v145, v238, v93
    v_fma_f32 v94, v146, v238, v94
    v_fma_f32 v95, v147, v238, v95
    v_fma_f32 v96, v148, v238, v96
    v_fma_f32 v97, v149, v238, v97
    v_fma_f32 v98, v150, v238, v98
    v_fma_f32 v99, v151, v238, v99
    v_cvt_pk_bf16_f32 v100, v92, v93
    v_cvt_pk_bf16_f32 v101, v94, v95
    v_cvt_pk_bf16_f32 v102, v96, v97
    v_cvt_pk_bf16_f32 v103, v98, v99
    buffer_store_dwordx4 v[100:103], v202, s[8:11], s23 offen sc1
    v_lshlrev_b32 v92, 16, v196
    v_and_b32 v93, 0xffff0000, v196
    v_lshlrev_b32 v94, 16, v197
    v_and_b32 v95, 0xffff0000, v197
    v_lshlrev_b32 v96, 16, v198
    v_and_b32 v97, 0xffff0000, v198
    v_lshlrev_b32 v98, 16, v199
    v_and_b32 v99, 0xffff0000, v199
    s_waitcnt lgkmcnt(0)
    v_fma_f32 v92, v152, v238, v92
    v_fma_f32 v93, v153, v238, v93
    v_fma_f32 v94, v154, v238, v94
    v_fma_f32 v95, v155, v238, v95
    v_fma_f32 v96, v156, v238, v96
    v_fma_f32 v97, v157, v238, v97
    v_fma_f32 v98, v158, v238, v98
    v_fma_f32 v99, v159, v238, v99
    v_cvt_pk_bf16_f32 v104, v92, v93
    v_cvt_pk_bf16_f32 v105, v94, v95
    v_cvt_pk_bf16_f32 v106, v96, v97
    v_cvt_pk_bf16_f32 v107, v98, v99
    s_add_u32 s24, s23, 262144
    buffer_store_dwordx4 v[104:107], v202, s[8:11], s24 offen sc1
    s_add_u32 s60, s61, 4096
    buffer_load_dwordx4 a[112:115], v4, s[16:19], s60 offen offset:2048
    s_add_u32 s60, s61, 36864
    buffer_load_dwordx4 a[116:119], v4, s[16:19], s60 offen offset:2048
    s_add_u32 s60, s61, 4096
    buffer_load_dwordx4 a[120:123], v4, s[16:19], s60 offen offset:3072
    s_add_u32 s60, s61, 36864
    buffer_load_dwordx4 a[124:127], v4, s[16:19], s60 offen offset:3072
    s_add_u32 s60, s20, 2
    s_and_b32 s60, s60, 3
    s_lshl_b32 s60, s60, 13
    s_lshl_b32 s61, s34, 16
    s_add_u32 s61, s61, s60
    s_add_u32 s60, s61, 0
    buffer_load_dwordx4 a[128:131], v4, s[16:19], s60 offen offset:0
    s_add_u32 s60, s61, 32768
    buffer_load_dwordx4 a[132:135], v4, s[16:19], s60 offen offset:0
    s_add_u32 s60, s61, 0
    buffer_load_dwordx4 a[136:139], v4, s[16:19], s60 offen offset:1024
    s_add_u32 s60, s61, 32768
    buffer_load_dwordx4 a[140:143], v4, s[16:19], s60 offen offset:1024
    s_add_u32 s60, s61, 0
    buffer_load_dwordx4 a[144:147], v4, s[16:19], s60 offen offset:2048
    s_add_u32 s60, s61, 32768
    buffer_load_dwordx4 a[148:151], v4, s[16:19], s60 offen offset:2048
    s_add_u32 s60, s61, 0
    buffer_load_dwordx4 a[152:155], v4, s[16:19], s60 offen offset:3072
    s_add_u32 s60, s61, 32768
    buffer_load_dwordx4 a[156:159], v4, s[16:19], s60 offen offset:3072
    s_add_u32 s60, s61, 4096
    buffer_load_dwordx4 a[160:163], v4, s[16:19], s60 offen offset:0
    s_add_u32 s60, s61, 36864
    buffer_load_dwordx4 a[164:167], v4, s[16:19], s60 offen offset:0
    s_add_u32 s4, s82, 0x1f00000
    s_addc_u32 s5, s83, 0
    s_mov_b32 s6, 0x5000
    s_mov_b32 s7, 0x00020000
    v_lshlrev_b32 v250, 3, v1
    v_add_u32 v250, s21, v250
    v_lshlrev_b32 v250, 7, v250
    v_mov_b32 v251, 1
    s_waitcnt vmcnt(14) lgkmcnt(0)
    s_barrier
    s_cmp_lg_u32 s20, 0
    s_cbranch_scc1 L_arr_59
    s_mov_b64 exec, 0xffff
    buffer_atomic_add v251, v250, s[4:7], 0 offen offset:16 sc1
    s_mov_b64 exec, -1
L_arr_59:
    s_add_u32 s60, s61, 4096
    buffer_load_dwordx4 a[168:171], v4, s[16:19], s60 offen offset:1024
    s_add_u32 s60, s61, 36864
    buffer_load_dwordx4 a[172:175], v4, s[16:19], s60 offen offset:1024
    s_add_u32 s60, s61, 4096
    buffer_load_dwordx4 a[176:179], v4, s[16:19], s60 offen offset:2048
    s_add_u32 s60, s61, 36864
    buffer_load_dwordx4 a[180:183], v4, s[16:19], s60 offen offset:2048
    s_add_u32 s60, s61, 4096
    buffer_load_dwordx4 a[184:187], v4, s[16:19], s60 offen offset:3072
    s_add_u32 s60, s61, 36864
    buffer_load_dwordx4 a[188:191], v4, s[16:19], s60 offen offset:3072
    s_add_u32 s60, s20, 3
    s_and_b32 s60, s60, 3
    s_lshl_b32 s60, s60, 13
    s_lshl_b32 s61, s34, 16
    s_add_u32 s61, s61, s60
    s_add_u32 s60, s61, 0
    buffer_load_dwordx4 a[192:195], v4, s[16:19], s60 offen offset:0
    s_add_u32 s60, s61, 32768
    buffer_load_dwordx4 a[196:199], v4, s[16:19], s60 offen offset:0
    s_add_u32 s60, s61, 0
    buffer_load_dwordx4 a[200:203], v4, s[16:19], s60 offen offset:1024
    s_add_u32 s60, s61, 32768
    buffer_load_dwordx4 a[204:207], v4, s[16:19], s60 offen offset:1024
    s_add_u32 s60, s61, 0
    buffer_load_dwordx4 a[208:211], v4, s[16:19], s60 offen offset:2048
    s_add_u32 s60, s61, 32768
    buffer_load_dwordx4 a[212:215], v4, s[16:19], s60 offen offset:2048
    s_add_u32 s60, s61, 0
    buffer_load_dwordx4 a[216:219], v4, s[16:19], s60 offen offset:3072
    s_add_u32 s60, s61, 32768
    buffer_load_dwordx4 a[220:223], v4, s[16:19], s60 offen offset:3072
    s_add_u32 s60, s61, 4096
    buffer_load_dwordx4 a[224:227], v4, s[16:19], s60 offen offset:0
    s_add_u32 s60, s61, 36864
    buffer_load_dwordx4 a[228:231], v4, s[16:19], s60 offen offset:0
    s_add_u32 s60, s61, 4096
    buffer_load_dwordx4 a[232:235], v4, s[16:19], s60 offen offset:1024
    s_add_u32 s60, s61, 36864
    buffer_load_dwordx4 a[236:239], v4, s[16:19], s60 offen offset:1024
    s_add_u32 s60, s61, 4096
    buffer_load_dwordx4 a[240:243], v4, s[16:19], s60 offen offset:2048
    s_add_u32 s60, s61, 36864
    buffer_load_dwordx4 a[244:247], v4, s[16:19], s60 offen offset:2048
    s_add_u32 s60, s61, 4096
    buffer_load_dwordx4 a[248:251], v4, s[16:19], s60 offen offset:3072
    s_add_u32 s60, s61, 36864
    buffer_load_dwordx4 a[252:255], v4, s[16:19], s60 offen offset:3072
    s_add_u32 s84, s82, 0x1c00000
    s_addc_u32 s85, s83, 0
    s_mov_b32 s86, 0x80000
    s_mov_b32 s87, 0x00020000
    v_lshlrev_b32 v73, 4, v1
    s_lshl_b32 s92, s20, 13
    s_lshl_b32 s24, s40, 16
    s_add_u32 s92, s92, s24
    s_lshl_b32 s93, s20, 14
    s_cmp_ge_u32 s20, 2
    s_cselect_b32 s24, 68608, 0
    s_add_u32 s93, s93, s24
    s_lshl_b32 s24, s20, 3
    v_xor_b32 v72, s24, v1
    v_lshlrev_b32 v72, 4, v72
    s_lshl_b32 s94, s41, 16
    s_lshl_b32 s24, s20, 13
    s_add_u32 s94, s94, s24
    s_cmp_eq_u32 s90, 1
    s_cbranch_scc1 L_g4skip_57
    s_cmp_eq_u32 s32, 21
    s_cselect_b32 s35, 1, 3
    v_lshlrev_b32 v77, 4, v1
    v_mov_b32 v76, v77
    s_mul_i32 s36, s32, 98304
    s_lshl_b32 s24, s20, 13
    s_add_u32 s36, s36, s24
    s_lshl_b32 s37, s20, 13
    v_and_b32 v74, 15, v1
    v_lshrrev_b32 v75, 2, v74
    v_lshl_add_u32 v75, v3, 2, v75
    v_lshlrev_b32 v75, 6, v75
    v_and_b32 v74, 3, v74
    v_lshl_add_u32 v75, v74, 3, v75
    v_lshrrev_b32 v74, 4, v1
    v_and_b32 v74, 1, v74
    v_lshl_add_u32 v75, v74, 5, v75
    s_add_u32 s24, s20, 0
    s_and_b32 s24, s24, 3
    s_lshl_b32 s24, s24, 13
    v_add_u32 v78, s24, v75
    s_add_u32 s24, s20, 1
    s_and_b32 s24, s24, 3
    s_lshl_b32 s24, s24, 13
    v_add_u32 v79, s24, v75
    s_add_u32 s24, s20, 2
    s_and_b32 s24, s24, 3
    s_lshl_b32 s24, s24, 13
    v_add_u32 v80, s24, v75
    s_add_u32 s24, s20, 3
    s_and_b32 s24, s24, 3
    s_lshl_b32 s24, s24, 13
    v_add_u32 v81, s24, v75
    v_cmp_eq_u32 vcc, 0, v3
    s_cmp_eq_u32 s20, 0
    s_cselect_b64 s[26:27], vcc, 0
    v_mov_b32 v74, 0xffff0000
    v_cndmask_b32 v82, -1, v74, s[26:27]
    v_lshlrev_b32 v74, 2, v3
    v_sub_u32 v74, v2, v74
    v_cmp_eq_u32 vcc, 0, v74
    s_nop 1
    v_cndmask_b32 v88, 0, 1.0, vcc
    v_cmp_eq_u32 vcc, 1, v74
    s_nop 1
    v_cndmask_b32 v89, 0, 1.0, vcc
    v_cmp_eq_u32 vcc, 2, v74
    s_nop 1
    v_cndmask_b32 v90, 0, 1.0, vcc
    v_cmp_eq_u32 vcc, 3, v74
    s_nop 1
    v_cndmask_b32 v91, 0, 1.0, vcc
    v_cmp_eq_u32 vcc, 8, v74
    s_nop 1
    v_cndmask_b32 v92, 0, 1.0, vcc
    v_cmp_eq_u32 vcc, 9, v74
    s_nop 1
    v_cndmask_b32 v93, 0, 1.0, vcc
    v_cmp_eq_u32 vcc, 10, v74
    s_nop 1
    v_cndmask_b32 v94, 0, 1.0, vcc
    v_cmp_eq_u32 vcc, 11, v74
    s_nop 1
    v_cndmask_b32 v95, 0, 1.0, vcc
    v_cmp_eq_u32 vcc, 16, v74
    s_nop 1
    v_cndmask_b32 v96, 0, 1.0, vcc
    v_cmp_eq_u32 vcc, 17, v74
    s_nop 1
    v_cndmask_b32 v97, 0, 1.0, vcc
    v_cmp_eq_u32 vcc, 18, v74
    s_nop 1
    v_cndmask_b32 v98, 0, 1.0, vcc
    v_cmp_eq_u32 vcc, 19, v74
    s_nop 1
    v_cndmask_b32 v99, 0, 1.0, vcc
    v_cmp_eq_u32 vcc, 24, v74
    s_nop 1
    v_cndmask_b32 v100, 0, 1.0, vcc
    v_cmp_eq_u32 vcc, 25, v74
    s_nop 1
    v_cndmask_b32 v101, 0, 1.0, vcc
    v_cmp_eq_u32 vcc, 26, v74
    s_nop 1
    v_cndmask_b32 v102, 0, 1.0, vcc
    v_cmp_eq_u32 vcc, 27, v74
    s_nop 1
    v_cndmask_b32 v103, 0, 1.0, vcc
    v_lshlrev_b32 v84, 5, v2
    v_add_u32 v84, 98304, v84
    v_lshl_add_u32 v83, v3, 2, v84
    s_lshl_b32 s24, s20, 3
    v_add_u32 v83, s24, v83
    s_mul_i32 s38, s32, 264192
    s_lshl_b32 s25, s34, 11
    s_add_u32 s38, s38, s25
    s_cmp_ge_u32 s34, 43
    s_cselect_b32 s25, 0x7f000000, 0
    s_add_u32 s38, s38, s25
    s_add_u32 s8, s82, 0x600000
    s_addc_u32 s9, s83, 0
    s_mov_b32 s10, 0x200000
    s_mov_b32 s11, 0x00020000
    s_add_u32 s12, s82, 0xe00000
    s_addc_u32 s13, s83, 0
    s_mov_b32 s14, 0x560000
    s_mov_b32 s15, 0x00020000
    s_add_u32 s16, s82, 0x1a00000
    s_addc_u32 s17, s83, 0
    s_mov_b32 s18, 0x158000
    s_mov_b32 s19, 0x00020000
    s_lshl_b32 s24, s20, 3
    v_xor_b32 v4, s24, v1
    v_lshlrev_b32 v4, 4, v4
    s_mul_i32 s47, s41, 176128
    s_lshl_b32 s24, s42, 10
    s_add_u32 s47, s47, s24
    s_cmp_ge_u32 s20, 2
    s_cselect_b32 s48, 0x7f000000, 0
    s_add_u32 s48, s48, s47
    s_cmp_lg_u32 s20, 0
    s_cbranch_scc1 L_wt2_60
    s_add_u32 s4, s82, 0x1f00000
    s_addc_u32 s5, s83, 0
    s_mov_b32 s6, 0x5000
    s_mov_b32 s7, 0x00020000
    s_and_b32 s24, s22, 15
    s_lshl_b32 s24, s24, 3
    v_and_b32 v250, 7, v1
    v_add_u32 v250, s24, v250
    v_lshlrev_b32 v250, 7, v250
    v_cmp_gt_u32 vcc, 8, v1
    v_mov_b32 v249, 20
    v_mov_b32 v251, 16
    v_cndmask_b32 v249, v249, v251, vcc
    v_add_u32 v250, v250, v249
    v_mov_b32 v249, 32
    v_mov_b32 v251, 32
    v_cndmask_b32 v249, v249, v251, vcc
    s_mov_b64 exec, 0xffff
    s_mov_b32 s31, 0
L_poll_61:
    buffer_load_dword v251, v250, s[4:7], 0 offen sc0 sc1
    s_add_u32 s31, s31, 1
    s_waitcnt vmcnt(0)
    v_cmp_le_u32 vcc, v249, v251
    s_nop 0
    s_cmp_eq_u64 vcc, exec
    s_nop 1
    s_cbranch_scc1 L_polld_62
    s_cmp_lt_u32 s31, 1048576
    s_cbranch_scc1 L_poll_61
L_polld_62:
    s_mov_b64 exec, -1
L_wt2_60:
    s_barrier
    s_add_u32 m0, s37, 0
    s_add_u32 s39, s36, 0
    buffer_load_dwordx4 v76, s[8:11], s39 offen lds
    s_add_u32 m0, s37, 1024
    s_add_u32 s39, s36, 1024
    buffer_load_dwordx4 v76, s[8:11], s39 offen lds
    s_add_u32 m0, s37, 2048
    s_add_u32 s39, s36, 2048
    buffer_load_dwordx4 v76, s[8:11], s39 offen lds
    s_add_u32 m0, s37, 3072
    s_add_u32 s39, s36, 3072
    buffer_load_dwordx4 v76, s[8:11], s39 offen lds
    s_add_u32 m0, s37, 4096
    s_add_u32 s39, s36, 4096
    buffer_load_dwordx4 v76, s[8:11], s39 offen lds
    s_add_u32 m0, s37, 5120
    s_add_u32 s39, s36, 5120
    buffer_load_dwordx4 v76, s[8:11], s39 offen lds
    s_add_u32 m0, s37, 6144
    s_add_u32 s39, s36, 6144
    buffer_load_dwordx4 v76, s[8:11], s39 offen lds
    s_add_u32 m0, s37, 7168
    s_add_u32 s39, s36, 7168
    buffer_load_dwordx4 v76, s[8:11], s39 offen lds
    s_waitcnt vmcnt(4)
    ds_read_b64_tr_b16 v[104:105], v78 offset:0
    ds_read_b64_tr_b16 v[106:107], v78 offset:512
    ds_read_b64_tr_b16 v[108:109], v78 offset:1024
    ds_read_b64_tr_b16 v[110:111], v78 offset:1536
    ds_read_b64_tr_b16 v[112:113], v78 offset:2048
    ds_read_b64_tr_b16 v[114:115], v78 offset:2560
    ds_read_b64_tr_b16 v[116:117], v78 offset:3072
    ds_read_b64_tr_b16 v[118:119], v78 offset:3584
    s_waitcnt lgkmcnt(4)
    v_mfma_f32_32x32x16_bf16 v[124:139], a[0:3], v[104:107], 0
    s_waitcnt vmcnt(3)
    ds_read_b64_tr_b16 v[120:121], v78 offset:4096
    ds_read_b64_tr_b16 v[122:123], v78 offset:4608
    v_mfma_f32_32x32x16_bf16 v[140:155], a[4:7], v[104:107], 0
    v_and_b32 v240, v82, v104
    v_mov_b32 v241, v105
    v_mov_b32 v242, v106
    v_mov_b32 v243, v107
    s_nop 1
    v_mfma_f32_32x32x16_bf16 v[188:203], v[240:243], v[240:243], 0
    v_mfma_f32_32x32x16_bf16 v[124:139], a[8:11], v[108:111], v[124:139]
    s_waitcnt vmcnt(2)
    ds_read_b64_tr_b16 v[104:105], v78 offset:5120
    ds_read_b64_tr_b16 v[106:107], v78 offset:5632
    v_mfma_f32_32x32x16_bf16 v[140:155], a[12:15], v[108:111], v[140:155]
    v_mfma_f32_32x32x16_bf16 v[188:203], v[108:111], v[108:111], v[188:203]
    s_waitcnt lgkmcnt(4)
    v_mfma_f32_32x32x16_bf16 v[124:139], a[16:19], v[112:115], v[124:139]
    s_waitcnt vmcnt(1)
    ds_read_b64_tr_b16 v[108:109], v78 offset:6144
    ds_read_b64_tr_b16 v[110:111], v78 offset:6656
    v_mfma_f32_32x32x16_bf16 v[140:155], a[20:23], v[112:115], v[140:155]
    v_mfma_f32_32x32x16_bf16 v[188:203], v[112:115], v[112:115], v[188:203]
    v_mfma_f32_32x32x16_bf16 v[124:139], a[24:27], v[116:119], v[124:139]
    s_waitcnt vmcnt(0)
    ds_read_b64_tr_b16 v[112:113], v78 offset:7168
    ds_read_b64_tr_b16 v[114:115], v78 offset:7680
    v_mfma_f32_32x32x16_bf16 v[140:155], a[28:31], v[116:119], v[140:155]
    v_mfma_f32_32x32x16_bf16 v[188:203], v[116:119], v[116:119], v[188:203]
    s_waitcnt lgkmcnt(4)
    v_mfma_f32_32x32x16_bf16 v[124:139], a[32:35], v[120:123], v[124:139]
    s_barrier
    ds_read_b64_tr_b16 v[116:117], v79 offset:0
    ds_read_b64_tr_b16 v[118:119], v79 offset:512
    v_mfma_f32_32x32x16_bf16 v[140:155], a[36:39], v[120:123], v[140:155]
    s_add_u32 m0, s37, 32768
    s_add_u32 s39, s36, 32768
    buffer_load_dwordx4 v76, s[8:11], s39 offen lds
    v_mfma_f32_32x32x16_bf16 v[188:203], v[120:123], v[120:123], v[188:203]
    v_mfma_f32_32x32x16_bf16 v[124:139], a[40:43], v[104:107], v[124:139]
    ds_read_b64_tr_b16 v[120:121], v79 offset:1024
    ds_read_b64_tr_b16 v[122:123], v79 offset:1536
    v_mfma_f32_32x32x16_bf16 v[140:155], a[44:47], v[104:107], v[140:155]
    s_add_u32 m0, s37, 33792
    s_add_u32 s39, s36, 33792
    buffer_load_dwordx4 v76, s[8:11], s39 offen lds
    v_mfma_f32_32x32x16_bf16 v[188:203], v[104:107], v[104:107], v[188:203]
    s_waitcnt lgkmcnt(4)
    v_mfma_f32_32x32x16_bf16 v[124:139], a[48:51], v[108:111], v[124:139]
    ds_read_b64_tr_b16 v[104:105], v79 offset:2048
    ds_read_b64_tr_b16 v[106:107], v79 offset:2560
    v_mfma_f32_32x32x16_bf16 v[140:155], a[52:55], v[108:111], v[140:155]
    s_add_u32 m0, s37, 34816
    s_add_u32 s39, s36, 34816
    buffer_load_dwordx4 v76, s[8:11], s39 offen lds
    v_mfma_f32_32x32x16_bf16 v[188:203], v[108:111], v[108:111], v[188:203]
    v_mfma_f32_32x32x16_bf16 v[124:139], a[56:59], v[112:115], v[124:139]
    ds_read_b64_tr_b16 v[108:109], v79 offset:3072
    ds_read_b64_tr_b16 v[110:111], v79 offset:3584
    v_mfma_f32_32x32x16_bf16 v[140:155], a[60:63], v[112:115], v[140:155]
    s_add_u32 m0, s37, 35840
    s_add_u32 s39, s36, 35840
    buffer_load_dwordx4 v76, s[8:11], s39 offen lds
    v_mfma_f32_32x32x16_bf16 v[188:203], v[112:115], v[112:115], v[188:203]
    s_waitcnt lgkmcnt(4)
    v_mfma_f32_32x32x16_bf16 v[124:139], a[64:67], v[116:119], v[124:139]
    ds_read_b64_tr_b16 v[112:113], v79 offset:4096
    ds_read_b64_tr_b16 v[114:115], v79 offset:4608
    v_mfma_f32_32x32x16_bf16 v[140:155], a[68:71], v[116:119], v[140:155]
    s_add_u32 m0, s37, 36864
    s_add_u32 s39, s36, 36864
    buffer_load_dwordx4 v76, s[8:11], s39 offen lds
    v_mfma_f32_32x32x16_bf16 v[124:139], a[72:75], v[120:123], v[124:139]
    ds_read_b64_tr_b16 v[116:117], v79 offset:5120
    ds_read_b64_tr_b16 v[118:119], v79 offset:5632
    v_mfma_f32_32x32x16_bf16 v[140:155], a[76:79], v[120:123], v[140:155]
    s_add_u32 m0, s37, 37888
    s_add_u32 s39, s36, 37888
    buffer_load_dwordx4 v76, s[8:11], s39 offen lds
    s_waitcnt lgkmcnt(4)
    v_mfma_f32_32x32x16_bf16 v[124:139], a[80:83], v[104:107], v[124:139]
    ds_read_b64_tr_b16 v[120:121], v79 offset:6144
    ds_read_b64_tr_b16 v[122:123], v79 offset:6656
    v_mfma_f32_32x32x16_bf16 v[140:155], a[84:87], v[104:107], v[140:155]
    s_add_u32 m0, s37, 38912
    s_add_u32 s39, s36, 38912
    buffer_load_dwordx4 v76, s[8:11], s39 offen lds
    v_mul_f32 v204, v188, v88
    v_mul_f32 v205, v189, v89
    v_fmac_f32 v204, v190, v90
    v_fmac_f32 v205, v191, v91
    v_fmac_f32 v204, v192, v92
    v_fmac_f32 v205, v193, v93
    v_fmac_f32 v204, v194, v94
    v_fmac_f32 v205, v195, v95
    v_fmac_f32 v204, v196, v96
    v_fmac_f32 v205, v197, v97
    v_fmac_f32 v204, v198, v98
    v_fmac_f32 v205, v199, v99
    v_fmac_f32 v204, v200, v100
    v_fmac_f32 v205, v201, v101
    v_fmac_f32 v204, v202, v102
    v_fmac_f32 v205, v203, v103
    v_add_f32 v204, v204, v205
    ds_write_b32 v83, v204 offset:0
    v_mfma_f32_32x32x16_bf16 v[124:139], a[88:91], v[108:111], v[124:139]
    ds_read_b64_tr_b16 v[104:105], v79 offset:7168
    ds_read_b64_tr_b16 v[106:107], v79 offset:7680
    v_mfma_f32_32x32x16_bf16 v[140:155], a[92:95], v[108:111], v[140:155]
    s_add_u32 m0, s37, 39936
    s_add_u32 s39, s36, 39936
    buffer_load_dwordx4 v76, s[8:11], s39 offen lds
    s_waitcnt lgkmcnt(5)
    v_mfma_f32_32x32x16_bf16 v[124:139], a[96:99], v[112:115], v[124:139]
    ds_read_b64_tr_b16 v[108:109], v80 offset:0
    ds_read_b64_tr_b16 v[110:111], v80 offset:512
    v_mfma_f32_32x32x16_bf16 v[140:155], a[100:103], v[112:115], v[140:155]
    s_add_u32 m0, s37, 65536
    s_add_u32 s39, s36, 65536
    buffer_load_dwordx4 v76, s[8:11], s39 offen lds
    v_mfma_f32_32x32x16_bf16 v[124:139], a[104:107], v[116:119], v[124:139]
    ds_read_b64_tr_b16 v[112:113], v80 offset:1024
    ds_read_b64_tr_b16 v[114:115], v80 offset:1536
    v_mfma_f32_32x32x16_bf16 v[140:155], a[108:111], v[116:119], v[140:155]
    s_add_u32 m0, s37, 66560
    s_add_u32 s39, s36, 66560
    buffer_load_dwordx4 v76, s[8:11], s39 offen lds
    s_waitcnt lgkmcnt(4)
    v_mfma_f32_32x32x16_bf16 v[124:139], a[112:115], v[120:123], v[124:139]
    ds_read_b64_tr_b16 v[116:117], v80 offset:2048
    ds_read_b64_tr_b16 v[118:119], v80 offset:2560
    v_mfma_f32_32x32x16_bf16 v[140:155], a[116:119], v[120:123], v[140:155]
    s_add_u32 m0, s37, 67584
    s_add_u32 s39, s36, 67584
    buffer_load_dwordx4 v76, s[8:11], s39 offen lds
    v_mfma_f32_32x32x16_bf16 v[124:139], a[120:123], v[104:107], v[124:139]
    ds_read_b64_tr_b16 v[120:121], v80 offset:3072
    ds_read_b64_tr_b16 v[122:123], v80 offset:3584
    v_mfma_f32_32x32x16_bf16 v[140:155], a[124:127], v[104:107], v[140:155]
    s_add_u32 m0, s37, 68608
    s_add_u32 s39, s36, 68608
    buffer_load_dwordx4 v76, s[8:11], s39 offen lds
    s_waitcnt lgkmcnt(4)
    v_mfma_f32_32x32x16_bf16 v[124:139], a[128:131], v[108:111], v[124:139]
    ds_read_b64_tr_b16 v[104:105], v80 offset:4096
    ds_read_b64_tr_b16 v[106:107], v80 offset:4608
    v_mfma_f32_32x32x16_bf16 v[140:155], a[132:135], v[108:111], v[140:155]
    s_add_u32 m0, s37, 69632
    s_add_u32 s39, s36, 69632
    buffer_load_dwordx4 v76, s[8:11], s39 offen lds
    v_mfma_f32_32x32x16_bf16 v[124:139], a[136:139], v[112:115], v[124:139]
    ds_read_b64_tr_b16 v[108:109], v80 offset:5120
    ds_read_b64_tr_b16 v[110:111], v80 offset:5632
    v_mfma_f32_32x32x16_bf16 v[140:155], a[140:143], v[112:115], v[140:155]
    s_add_u32 m0, s37, 70656
    s_add_u32 s39, s36, 70656
    buffer_load_dwordx4 v76, s[8:11], s39 offen lds
    s_waitcnt lgkmcnt(4)
    v_mfma_f32_32x32x16_bf16 v[124:139], a[144:147], v[116:119], v[124:139]
    ds_read_b64_tr_b16 v[112:113], v80 offset:6144
    ds_read_b64_tr_b16 v[114:115], v80 offset:6656
    v_mfma_f32_32x32x16_bf16 v[140:155], a[148:151], v[116:119], v[140:155]
    s_add_u32 m0, s37, 71680
    s_add_u32 s39, s36, 71680
    buffer_load_dwordx4 v76, s[8:11], s39 offen lds
    v_mfma_f32_32x32x16_bf16 v[124:139], a[152:155], v[120:123], v[124:139]
    ds_read_b64_tr_b16 v[116:117], v80 offset:7168
    ds_read_b64_tr_b16 v[118:119], v80 offset:7680
    v_mfma_f32_32x32x16_bf16 v[140:155], a[156:159], v[120:123], v[140:155]
    s_add_u32 m0, s37, 72704
    s_add_u32 s39, s36, 72704
    buffer_load_dwordx4 v76, s[8:11], s39 offen lds
    s_waitcnt lgkmcnt(4)
    v_mfma_f32_32x32x16_bf16 v[124:139], a[160:163], v[104:107], v[124:139]
    ds_read_b64_tr_b16 v[120:121], v81 offset:0
    ds_read_b64_tr_b16 v[122:123], v81 offset:512
    v_mfma_f32_32x32x16_bf16 v[140:155], a[164:167], v[104:107], v[140:155]
    v_mfma_f32_32x32x16_bf16 v[124:139], a[168:171], v[108:111], v[124:139]
    ds_read_b64_tr_b16 v[104:105], v81 offset:1024
    ds_read_b64_tr_b16 v[106:107], v81 offset:1536
    v_mfma_f32_32x32x16_bf16 v[140:155], a[172:175], v[108:111], v[140:155]
    s_waitcnt lgkmcnt(4)
    v_mfma_f32_32x32x16_bf16 v[124:139], a[176:179], v[112:115], v[124:139]
    ds_read_b64_tr_b16 v[108:109], v81 offset:2048
    ds_read_b64_tr_b16 v[110:111], v81 offset:2560
    v_mfma_f32_32x32x16_bf16 v[140:155], a[180:183], v[112:115], v[140:155]
    v_mfma_f32_32x32x16_bf16 v[124:139], a[184:187], v[116:119], v[124:139]
    ds_read_b64_tr_b16 v[112:113], v81 offset:3072
    ds_read_b64_tr_b16 v[114:115], v81 offset:3584
    v_mfma_f32_32x32x16_bf16 v[140:155], a[188:191], v[116:119], v[140:155]
    s_waitcnt lgkmcnt(4)
    v_mfma_f32_32x32x16_bf16 v[124:139], a[192:195], v[120:123], v[124:139]
    ds_read_b64_tr_b16 v[116:117], v81 offset:4096
    ds_read_b64_tr_b16 v[118:119], v81 offset:4608
    v_mfma_f32_32x32x16_bf16 v[140:155], a[196:199], v[120:123], v[140:155]
    v_mfma_f32_32x32x16_bf16 v[124:139], a[200:203], v[104:107], v[124:139]
    ds_read_b64_tr_b16 v[120:121], v81 offset:5120
    ds_read_b64_tr_b16 v[122:123], v81 offset:5632
    v_mfma_f32_32x32x16_bf16 v[140:155], a[204:207], v[104:107], v[140:155]
    s_waitcnt lgkmcnt(4)
    v_mfma_f32_32x32x16_bf16 v[124:139], a[208:211], v[108:111], v[124:139]
    ds_read_b64_tr_b16 v[104:105], v81 offset:6144
    ds_read_b64_tr_b16 v[106:107], v81 offset:6656
    v_mfma_f32_32x32x16_bf16 v[140:155], a[212:215], v[108:111], v[140:155]
    v_mfma_f32_32x32x16_bf16 v[124:139], a[216:219], v[112:115], v[124:139]
    ds_read_b64_tr_b16 v[108:109], v81 offset:7168
    ds_read_b64_tr_b16 v[110:111], v81 offset:7680
    v_mfma_f32_32x32x16_bf16 v[140:155], a[220:223], v[112:115], v[140:155]
    s_waitcnt vmcnt(8)
    s_barrier
    s_waitcnt lgkmcnt(4)
    v_mfma_f32_32x32x16_bf16 v[124:139], a[224:227], v[116:119], v[124:139]
    ds_read_b64_tr_b16 v[112:113], v78 offset:32768
    ds_read_b64_tr_b16 v[114:115], v78 offset:33280
    v_mfma_f32_32x32x16_bf16 v[140:155], a[228:231], v[116:119], v[140:155]
    v_mfma_f32_32x32x16_bf16 v[124:139], a[232:235], v[120:123], v[124:139]
    ds_read_b64_tr_b16 v[116:117], v78 offset:33792
    ds_read_b64_tr_b16 v[118:119], v78 offset:34304
    v_mfma_f32_32x32x16_bf16 v[140:155], a[236:239], v[120:123], v[140:155]
    s_waitcnt lgkmcnt(4)
    v_mfma_f32_32x32x16_bf16 v[124:139], a[240:243], v[104:107], v[124:139]
    ds_read_b64_tr_b16 v[120:121], v78 offset:34816
    ds_read_b64_tr_b16 v[122:123], v78 offset:35328
    v_mfma_f32_32x32x16_bf16 v[140:155], a[244:247], v[104:107], v[140:155]
    v_mfma_f32_32x32x16_bf16 v[124:139], a[248:251], v[108:111], v[124:139]
    ds_read_b64_tr_b16 v[104:105], v78 offset:35840
    ds_read_b64_tr_b16 v[106:107], v78 offset:36352
    v_mfma_f32_32x32x16_bf16 v[140:155], a[252:255], v[108:111], v[140:155]
    s_cmp_eq_u32 s35, 1
    s_nop 9
    s_cbranch_scc1 L_g4_done_64_1
    s_waitcnt lgkmcnt(4)
    v_mfma_f32_32x32x16_bf16 v[156:171], a[0:3], v[112:115], 0
    ds_read_b64_tr_b16 v[108:109], v78 offset:36864
    ds_read_b64_tr_b16 v[110:111], v78 offset:37376
    s_add_u32 s60, s94, 0
    buffer_load_dwordx4 v[8:11], v72, s[84:87], s60 offen offset:0
    v_mfma_f32_32x32x16_bf16 v[172:187], a[4:7], v[112:115], 0
    v_and_b32 v240, v82, v112
    v_mov_b32 v241, v113
    v_mov_b32 v242, v114
    v_mov_b32 v243, v115
    s_nop 1
    v_mfma_f32_32x32x16_bf16 v[188:203], v[240:243], v[240:243], 0
    v_mfma_f32_32x32x16_bf16 v[156:171], a[8:11], v[116:119], v[156:171]
    ds_read_b64_tr_b16 v[112:113], v78 offset:37888
    ds_read_b64_tr_b16 v[114:115], v78 offset:38400
    v_mfma_f32_32x32x16_bf16 v[172:187], a[12:15], v[116:119], v[172:187]
    v_mfma_f32_32x32x16_bf16 v[188:203], v[116:119], v[116:119], v[188:203]
    s_waitcnt lgkmcnt(4)
    v_mfma_f32_32x32x16_bf16 v[156:171], a[16:19], v[120:123], v[156:171]
    ds_read_b64_tr_b16 v[116:117], v78 offset:38912
    ds_read_b64_tr_b16 v[118:119], v78 offset:39424
    s_add_u32 s60, s94, 0
    buffer_load_dwordx4 v[12:15], v72, s[84:87], s60 offen offset:1024
    ds_read_b128 v[216:219], v84 offset:0
    ds_read_b128 v[220:223], v84 offset:16
    v_mfma_f32_32x32x16_bf16 v[172:187], a[20:23], v[120:123], v[172:187]
    v_mfma_f32_32x32x16_bf16 v[188:203], v[120:123], v[120:123], v[188:203]
    v_mfma_f32_32x32x16_bf16 v[156:171], a[24:27], v[104:107], v[156:171]
    ds_read_b64_tr_b16 v[120:121], v78 offset:39936
    ds_read_b64_tr_b16 v[122:123], v78 offset:40448
    v_mfma_f32_32x32x16_bf16 v[172:187], a[28:31], v[104:107], v[172:187]
    s_waitcnt lgkmcnt(2)
    v_mfma_f32_32x32x16_bf16 v[188:203], v[104:107], v[104:107], v[188:203]
    s_waitcnt lgkmcnt(6)
    v_mfma_f32_32x32x16_bf16 v[156:171], a[32:35], v[108:111], v[156:171]
    ds_read_b64_tr_b16 v[104:105], v79 offset:32768
    ds_read_b64_tr_b16 v[106:107], v79 offset:33280
    s_add_u32 s60, s94, 0
    buffer_load_dwordx4 v[16:19], v72, s[84:87], s60 offen offset:2048
    v_add_f32 v216, v216, v220
    v_add_f32 v217, v217, v221
    v_add_f32 v218, v218, v222
    v_mfma_f32_32x32x16_bf16 v[172:187], a[36:39], v[108:111], v[172:187]
    v_add_f32 v219, v219, v223
    v_add_f32 v216, v216, v217
    v_add_f32 v218, v218, v219
    v_mfma_f32_32x32x16_bf16 v[188:203], v[108:111], v[108:111], v[188:203]
    v_mfma_f32_32x32x16_bf16 v[156:171], a[40:43], v[112:115], v[156:171]
    ds_read_b64_tr_b16 v[108:109], v79 offset:33792
    ds_read_b64_tr_b16 v[110:111], v79 offset:34304
    v_add_f32 v216, v216, v218
    v_mul_f32 v216, 0x3b000000, v216
    v_add_f32 v212, 0x3727c5ac, v216
    v_mfma_f32_32x32x16_bf16 v[172:187], a[44:47], v[112:115], v[172:187]
    v_rsq_f32 v217, v212
    s_nop 0
    v_mul_f32 v208, 0xc0135761, v217
    v_mfma_f32_32x32x16_bf16 v[188:203], v[112:115], v[112:115], v[188:203]
    s_waitcnt lgkmcnt(4)
    v_mfma_f32_32x32x16_bf16 v[156:171], a[48:51], v[116:119], v[156:171]
    ds_read_b64_tr_b16 v[112:113], v79 offset:34816
    ds_read_b64_tr_b16 v[114:115], v79 offset:35328
    s_add_u32 s60, s94, 0
    buffer_load_dwordx4 v[20:23], v72, s[84:87], s60 offen offset:3072
    v_mul_f32 v218, v217, v217
    v_mul_f32 v218, v218, v217
    v_mul_f32 v210, 0xbdd2d3e8, v218
    v_mfma_f32_32x32x16_bf16 v[172:187], a[52:55], v[116:119], v[172:187]
    v_mul_f32 v216, v124, v124
    v_mul_f32 v222, v126, v126
    v_mul_f32 v228, v128, v128
    v_mfma_f32_32x32x16_bf16 v[188:203], v[116:119], v[116:119], v[188:203]
    v_mfma_f32_32x32x16_bf16 v[156:171], a[56:59], v[120:123], v[156:171]
    ds_read_b64_tr_b16 v[116:117], v79 offset:35840
    ds_read_b64_tr_b16 v[118:119], v79 offset:36352
    v_mul_f32 v234, v130, v130
    v_mul_f32 v217, v125, v125
    v_mul_f32 v223, v127, v127
    v_mfma_f32_32x32x16_bf16 v[172:187], a[60:63], v[120:123], v[172:187]
    v_mul_f32 v229, v129, v129
    v_mul_f32 v235, v131, v131
    v_mul_f32 v220, v124, v140
    v_mfma_f32_32x32x16_bf16 v[188:203], v[120:123], v[120:123], v[188:203]
    s_waitcnt lgkmcnt(4)
    v_mfma_f32_32x32x16_bf16 v[156:171], a[64:67], v[104:107], v[156:171]
    ds_read_b64_tr_b16 v[120:121], v79 offset:36864
    ds_read_b64_tr_b16 v[122:123], v79 offset:37376
    s_add_u32 s60, s94, 4096
    buffer_load_dwordx4 v[24:27], v72, s[84:87], s60 offen offset:0
    v_mul_f32 v226, v126, v142
    v_mul_f32 v232, v128, v144
    v_mul_f32 v238, v130, v146
    v_mfma_f32_32x32x16_bf16 v[172:187], a[68:71], v[104:107], v[172:187]
    v_mul_f32 v221, v125, v141
    v_mul_f32 v227, v127, v143
    v_mul_f32 v233, v129, v145
    v_mfma_f32_32x32x16_bf16 v[156:171], a[72:75], v[108:111], v[156:171]
    ds_read_b64_tr_b16 v[104:105], v79 offset:37888
    ds_read_b64_tr_b16 v[106:107], v79 offset:38400
    v_mul_f32 v239, v131, v147
    v_fma_f32 v216, v216, v210, v208
    v_fma_f32 v222, v222, v210, v208
    v_mfma_f32_32x32x16_bf16 v[172:187], a[76:79], v[108:111], v[172:187]
    v_fma_f32 v228, v228, v210, v208
    v_fma_f32 v234, v234, v210, v208
    v_fma_f32 v217, v217, v210, v208
    s_waitcnt lgkmcnt(4)
    v_mfma_f32_32x32x16_bf16 v[156:171], a[80:83], v[112:115], v[156:171]
    ds_read_b64_tr_b16 v[108:109], v79 offset:38912
    ds_read_b64_tr_b16 v[110:111], v79 offset:39424
    s_add_u32 s60, s94, 4096
    buffer_load_dwordx4 v[28:31], v72, s[84:87], s60 offen offset:1024
    v_fma_f32 v223, v223, v210, v208
    v_fma_f32 v229, v229, v210, v208
    v_fma_f32 v235, v235, v210, v208
    v_mfma_f32_32x32x16_bf16 v[172:187], a[84:87], v[112:115], v[172:187]
    v_mul_f32 v216, v216, v124
    v_mul_f32 v222, v222, v126
    v_mul_f32 v228, v228, v128
    v_mul_f32 v204, v188, v88
    v_mul_f32 v205, v189, v89
    v_fmac_f32 v204, v190, v90
    v_fmac_f32 v205, v191, v91
    v_fmac_f32 v204, v192, v92
    v_fmac_f32 v205, v193, v93
    v_fmac_f32 v204, v194, v94
    v_fmac_f32 v205, v195, v95
    v_fmac_f32 v204, v196, v96
    v_fmac_f32 v205, v197, v97
    v_fmac_f32 v204, v198, v98
    v_fmac_f32 v205, v199, v99
    v_fmac_f32 v204, v200, v100
    v_fmac_f32 v205, v201, v101
    v_fmac_f32 v204, v202, v102
    v_fmac_f32 v205, v203, v103
    v_add_f32 v204, v204, v205
    ds_write_b32 v83, v204 offset:1024
    v_mfma_f32_32x32x16_bf16 v[156:171], a[88:91], v[116:119], v[156:171]
    ds_read_b64_tr_b16 v[112:113], v79 offset:39936
    ds_read_b64_tr_b16 v[114:115], v79 offset:40448
    v_mul_f32 v234, v234, v130
    v_mul_f32 v217, v217, v125
    v_mul_f32 v223, v223, v127
    v_mfma_f32_32x32x16_bf16 v[172:187], a[92:95], v[116:119], v[172:187]
    v_mul_f32 v229, v229, v129
    v_mul_f32 v235, v235, v131
    v_exp_f32 v218, v216
    s_waitcnt lgkmcnt(5)
    v_mfma_f32_32x32x16_bf16 v[156:171], a[96:99], v[120:123], v[156:171]
    ds_read_b64_tr_b16 v[116:117], v80 offset:32768
    ds_read_b64_tr_b16 v[118:119], v80 offset:33280
    s_add_u32 s60, s94, 4096
    buffer_load_dwordx4 v[32:35], v72, s[84:87], s60 offen offset:2048
    v_exp_f32 v224, v222
    v_exp_f32 v230, v228
    v_exp_f32 v236, v234
    v_mfma_f32_32x32x16_bf16 v[172:187], a[100:103], v[120:123], v[172:187]
    v_exp_f32 v219, v217
    v_exp_f32 v225, v223
    v_exp_f32 v231, v229
    v_mfma_f32_32x32x16_bf16 v[156:171], a[104:107], v[104:107], v[156:171]
    ds_read_b64_tr_b16 v[120:121], v80 offset:33792
    ds_read_b64_tr_b16 v[122:123], v80 offset:34304
    v_exp_f32 v237, v235
    v_fma_f32 v218, v218, v212, v212
    v_fma_f32 v224, v224, v212, v212
    v_mfma_f32_32x32x16_bf16 v[172:187], a[108:111], v[104:107], v[172:187]
    v_fma_f32 v230, v230, v212, v212
    v_fma_f32 v236, v236, v212, v212
    v_fma_f32 v219, v219, v212, v212
    s_waitcnt lgkmcnt(4)
    v_mfma_f32_32x32x16_bf16 v[156:171], a[112:115], v[108:111], v[156:171]
    ds_read_b64_tr_b16 v[104:105], v80 offset:34816
    ds_read_b64_tr_b16 v[106:107], v80 offset:35328
    s_add_u32 s60, s94, 4096
    buffer_load_dwordx4 v[36:39], v72, s[84:87], s60 offen offset:3072
    v_fma_f32 v225, v225, v212, v212
    v_fma_f32 v231, v231, v212, v212
    v_fma_f32 v237, v237, v212, v212
    v_mfma_f32_32x32x16_bf16 v[172:187], a[116:119], v[108:111], v[172:187]
    v_rcp_f32 v218, v218
    v_rcp_f32 v224, v224
    v_rcp_f32 v230, v230
    v_mfma_f32_32x32x16_bf16 v[156:171], a[120:123], v[112:115], v[156:171]
    ds_read_b64_tr_b16 v[108:109], v80 offset:35840
    ds_read_b64_tr_b16 v[110:111], v80 offset:36352
    v_rcp_f32 v236, v236
    v_rcp_f32 v219, v219
    v_rcp_f32 v225, v225
    v_mfma_f32_32x32x16_bf16 v[172:187], a[124:127], v[112:115], v[172:187]
    v_rcp_f32 v231, v231
    v_rcp_f32 v237, v237
    v_mul_f32 v220, v220, v218
    s_waitcnt lgkmcnt(4)
    v_mfma_f32_32x32x16_bf16 v[156:171], a[128:131], v[116:119], v[156:171]
    ds_read_b64_tr_b16 v[112:113], v80 offset:36864
    ds_read_b64_tr_b16 v[114:115], v80 offset:37376
    s_add_u32 s60, s94, 32768
    buffer_load_dwordx4 v[40:43], v72, s[84:87], s60 offen offset:0
    v_mul_f32 v226, v226, v224
    v_mul_f32 v232, v232, v230
    v_mul_f32 v238, v238, v236
    v_mfma_f32_32x32x16_bf16 v[172:187], a[132:135], v[116:119], v[172:187]
    v_mul_f32 v221, v221, v219
    v_mul_f32 v227, v227, v225
    v_mul_f32 v233, v233, v231
    v_mfma_f32_32x32x16_bf16 v[156:171], a[136:139], v[120:123], v[156:171]
    ds_read_b64_tr_b16 v[116:117], v80 offset:37888
    ds_read_b64_tr_b16 v[118:119], v80 offset:38400
    v_mul_f32 v239, v239, v237
    v_cvt_pk_bf16_f32 v240, v220, v221
    v_cvt_pk_bf16_f32 v241, v226, v227
    v_mfma_f32_32x32x16_bf16 v[172:187], a[140:143], v[120:123], v[172:187]
    v_cvt_pk_bf16_f32 v242, v232, v233
    v_cvt_pk_bf16_f32 v243, v238, v239
    s_add_u32 s24, s38, 0
    s_waitcnt lgkmcnt(4)
    v_mfma_f32_32x32x16_bf16 v[156:171], a[144:147], v[104:107], v[156:171]
    ds_read_b64_tr_b16 v[120:121], v80 offset:38912
    ds_read_b64_tr_b16 v[122:123], v80 offset:39424
    s_add_u32 s60, s94, 32768
    buffer_load_dwordx4 v[44:47], v72, s[84:87], s60 offen offset:1024
    buffer_store_dwordx4 v[240:243], v77, s[12:15], s24 offen sc1
    v_mul_f32 v216, v132, v132
    v_mul_f32 v222, v134, v134
    v_mfma_f32_32x32x16_bf16 v[172:187], a[148:151], v[104:107], v[172:187]
    v_mul_f32 v228, v136, v136
    v_mul_f32 v234, v138, v138
    v_mul_f32 v217, v133, v133
    v_mfma_f32_32x32x16_bf16 v[156:171], a[152:155], v[108:111], v[156:171]
    ds_read_b64_tr_b16 v[104:105], v80 offset:39936
    ds_read_b64_tr_b16 v[106:107], v80 offset:40448
    v_mul_f32 v223, v135, v135
    v_mul_f32 v229, v137, v137
    v_mul_f32 v235, v139, v139
    v_mfma_f32_32x32x16_bf16 v[172:187], a[156:159], v[108:111], v[172:187]
    v_mul_f32 v220, v132, v148
    v_mul_f32 v226, v134, v150
    v_mul_f32 v232, v136, v152
    s_waitcnt lgkmcnt(4)
    v_mfma_f32_32x32x16_bf16 v[156:171], a[160:163], v[112:115], v[156:171]
    ds_read_b64_tr_b16 v[108:109], v81 offset:32768
    ds_read_b64_tr_b16 v[110:111], v81 offset:33280
    s_add_u32 s60, s94, 32768
    buffer_load_dwordx4 v[48:51], v72, s[84:87], s60 offen offset:2048
    v_mul_f32 v238, v138, v154
    v_mul_f32 v221, v133, v149
    v_mul_f32 v227, v135, v151
    v_mfma_f32_32x32x16_bf16 v[172:187], a[164:167], v[112:115], v[172:187]
    v_mul_f32 v233, v137, v153
    v_mul_f32 v239, v139, v155
    v_fma_f32 v216, v216, v210, v208
    v_mfma_f32_32x32x16_bf16 v[156:171], a[168:171], v[116:119], v[156:171]
    ds_read_b64_tr_b16 v[112:113], v81 offset:33792
    ds_read_b64_tr_b16 v[114:115], v81 offset:34304
    v_fma_f32 v222, v222, v210, v208
    v_fma_f32 v228, v228, v210, v208
    v_fma_f32 v234, v234, v210, v208
    v_mfma_f32_32x32x16_bf16 v[172:187], a[172:175], v[116:119], v[172:187]
    v_fma_f32 v217, v217, v210, v208
    v_fma_f32 v223, v223, v210, v208
    v_fma_f32 v229, v229, v210, v208
    s_waitcnt lgkmcnt(4)
    v_mfma_f32_32x32x16_bf16 v[156:171], a[176:179], v[120:123], v[156:171]
    ds_read_b64_tr_b16 v[116:117], v81 offset:34816
    ds_read_b64_tr_b16 v[118:119], v81 offset:35328
    s_add_u32 s60, s94, 32768
    buffer_load_dwordx4 v[52:55], v72, s[84:87], s60 offen offset:3072
    v_fma_f32 v235, v235, v210, v208
    v_mul_f32 v216, v216, v132
    v_mul_f32 v222, v222, v134
    v_mfma_f32_32x32x16_bf16 v[172:187], a[180:183], v[120:123], v[172:187]
    v_mul_f32 v228, v228, v136
    v_mul_f32 v234, v234, v138
    v_mul_f32 v217, v217, v133
    v_mfma_f32_32x32x16_bf16 v[156:171], a[184:187], v[104:107], v[156:171]
    ds_read_b64_tr_b16 v[120:121], v81 offset:35840
    ds_read_b64_tr_b16 v[122:123], v81 offset:36352
    v_mul_f32 v223, v223, v135
    v_mul_f32 v229, v229, v137
    v_mul_f32 v235, v235, v139
    v_mfma_f32_32x32x16_bf16 v[172:187], a[188:191], v[104:107], v[172:187]
    v_exp_f32 v218, v216
    v_exp_f32 v224, v222
    v_exp_f32 v230, v228
    s_waitcnt lgkmcnt(4)
    v_mfma_f32_32x32x16_bf16 v[156:171], a[192:195], v[108:111], v[156:171]
    ds_read_b64_tr_b16 v[104:105], v81 offset:36864
    ds_read_b64_tr_b16 v[106:107], v81 offset:37376
    s_add_u32 s60, s94, 36864
    buffer_load_dwordx4 v[56:59], v72, s[84:87], s60 offen offset:0
    v_exp_f32 v236, v234
    v_exp_f32 v219, v217
    v_exp_f32 v225, v223
    v_mfma_f32_32x32x16_bf16 v[172:187], a[196:199], v[108:111], v[172:187]
    v_exp_f32 v231, v229
    v_exp_f32 v237, v235
    v_fma_f32 v218, v218, v212, v212
    v_mfma_f32_32x32x16_bf16 v[156:171], a[200:203], v[112:115], v[156:171]
    ds_read_b64_tr_b16 v[108:109], v81 offset:37888
    ds_read_b64_tr_b16 v[110:111], v81 offset:38400
    v_fma_f32 v224, v224, v212, v212
    v_fma_f32 v230, v230, v212, v212
    v_fma_f32 v236, v236, v212, v212
    v_mfma_f32_32x32x16_bf16 v[172:187], a[204:207], v[112:115], v[172:187]
    v_fma_f32 v219, v219, v212, v212
    v_fma_f32 v225, v225, v212, v212
    v_fma_f32 v231, v231, v212, v212
    s_waitcnt lgkmcnt(4)
    v_mfma_f32_32x32x16_bf16 v[156:171], a[208:211], v[116:119], v[156:171]
    ds_read_b64_tr_b16 v[112:113], v81 offset:38912
    ds_read_b64_tr_b16 v[114:115], v81 offset:39424
    s_add_u32 s60, s94, 36864
    buffer_load_dwordx4 v[60:63], v72, s[84:87], s60 offen offset:1024
    v_fma_f32 v237, v237, v212, v212
    v_rcp_f32 v218, v218
    v_rcp_f32 v224, v224
    v_mfma_f32_32x32x16_bf16 v[172:187], a[212:215], v[116:119], v[172:187]
    v_rcp_f32 v230, v230
    v_rcp_f32 v236, v236
    v_rcp_f32 v219, v219
    v_mfma_f32_32x32x16_bf16 v[156:171], a[216:219], v[120:123], v[156:171]
    ds_read_b64_tr_b16 v[116:117], v81 offset:39936
    ds_read_b64_tr_b16 v[118:119], v81 offset:40448
    v_rcp_f32 v225, v225
    v_rcp_f32 v231, v231
    v_rcp_f32 v237, v237
    v_mfma_f32_32x32x16_bf16 v[172:187], a[220:223], v[120:123], v[172:187]
    v_mul_f32 v220, v220, v218
    v_mul_f32 v226, v226, v224
    v_mul_f32 v232, v232, v230
    s_waitcnt vmcnt(15)
    s_barrier
    s_waitcnt lgkmcnt(4)
    v_mfma_f32_32x32x16_bf16 v[156:171], a[224:227], v[104:107], v[156:171]
    v_add_u32 v78, 32768, v78
    ds_read_b64_tr_b16 v[120:121], v78 offset:32768
    ds_read_b64_tr_b16 v[122:123], v78 offset:33280
    s_add_u32 s60, s94, 36864
    buffer_load_dwordx4 v[64:67], v72, s[84:87], s60 offen offset:2048
    v_mul_f32 v238, v238, v236
    v_mul_f32 v221, v221, v219
    v_mul_f32 v227, v227, v225
    v_mfma_f32_32x32x16_bf16 v[172:187], a[228:231], v[104:107], v[172:187]
    v_mul_f32 v233, v233, v231
    v_mul_f32 v239, v239, v237
    v_cvt_pk_bf16_f32 v244, v220, v221
    v_mfma_f32_32x32x16_bf16 v[156:171], a[232:235], v[108:111], v[156:171]
    ds_read_b64_tr_b16 v[104:105], v78 offset:33792
    ds_read_b64_tr_b16 v[106:107], v78 offset:34304
    v_cvt_pk_bf16_f32 v245, v226, v227
    v_cvt_pk_bf16_f32 v246, v232, v233
    v_cvt_pk_bf16_f32 v247, v238, v239
    v_mfma_f32_32x32x16_bf16 v[172:187], a[236:239], v[108:111], v[172:187]
    s_add_u32 s24, s38, 1024
    buffer_store_dwordx4 v[244:247], v77, s[12:15], s24 offen sc1
    s_waitcnt lgkmcnt(4)
    v_mfma_f32_32x32x16_bf16 v[156:171], a[240:243], v[112:115], v[156:171]
    ds_read_b64_tr_b16 v[108:109], v78 offset:34816
    ds_read_b64_tr_b16 v[110:111], v78 offset:35328
    s_add_u32 s60, s94, 36864
    buffer_load_dwordx4 v[68:71], v72, s[84:87], s60 offen offset:3072
    v_mfma_f32_32x32x16_bf16 v[172:187], a[244:247], v[112:115], v[172:187]
    v_mfma_f32_32x32x16_bf16 v[156:171], a[248:251], v[116:119], v[156:171]
    ds_read_b64_tr_b16 v[112:113], v78 offset:35840
    ds_read_b64_tr_b16 v[114:115], v78 offset:36352
    v_mfma_f32_32x32x16_bf16 v[172:187], a[252:255], v[116:119], v[172:187]
    s_waitcnt lgkmcnt(4)
    v_mfma_f32_32x32x16_bf16 v[124:139], a[0:3], v[120:123], 0
    ds_read_b64_tr_b16 v[116:117], v78 offset:36864
    ds_read_b64_tr_b16 v[118:119], v78 offset:37376
    s_add_u32 m0, s93, 0
    s_add_u32 s60, s92, 0
    buffer_load_dwordx4 v73, s[8:11], s60 offen lds
    v_mfma_f32_32x32x16_bf16 v[140:155], a[4:7], v[120:123], 0
    s_add_u32 s63, s47, 0
    buffer_load_dwordx4 a[0:3], v4, s[16:19], s63 offen offset:0
    s_add_u32 s63, s47, 88064
    buffer_load_dwordx4 a[4:7], v4, s[16:19], s63 offen offset:0
    v_and_b32 v240, v82, v120
    v_mov_b32 v241, v121
    v_mov_b32 v242, v122
    v_mov_b32 v243, v123
    s_nop 1
    v_mfma_f32_32x32x16_bf16 v[188:203], v[240:243], v[240:243], 0
    v_mfma_f32_32x32x16_bf16 v[124:139], a[8:11], v[104:107], v[124:139]
    ds_read_b64_tr_b16 v[120:121], v78 offset:37888
    ds_read_b64_tr_b16 v[122:123], v78 offset:38400
    v_mfma_f32_32x32x16_bf16 v[140:155], a[12:15], v[104:107], v[140:155]
    s_add_u32 s63, s47, 0
    buffer_load_dwordx4 a[8:11], v4, s[16:19], s63 offen offset:1024
    s_add_u32 s63, s47, 88064
    buffer_load_dwordx4 a[12:15], v4, s[16:19], s63 offen offset:1024
    v_mfma_f32_32x32x16_bf16 v[188:203], v[104:107], v[104:107], v[188:203]
    s_waitcnt lgkmcnt(4)
    v_mfma_f32_32x32x16_bf16 v[124:139], a[16:19], v[108:111], v[124:139]
    ds_read_b64_tr_b16 v[104:105], v78 offset:38912
    ds_read_b64_tr_b16 v[106:107], v78 offset:39424
    s_add_u32 m0, s93, 1024
    s_add_u32 s60, s92, 1024
    buffer_load_dwordx4 v73, s[8:11], s60 offen lds
    ds_read_b128 v[216:219], v84 offset:1024
    ds_read_b128 v[220:223], v84 offset:1040
    v_mfma_f32_32x32x16_bf16 v[140:155], a[20:23], v[108:111], v[140:155]
    s_add_u32 s63, s47, 0
    buffer_load_dwordx4 a[16:19], v4, s[16:19], s63 offen offset:2048
    s_add_u32 s63, s47, 88064
    buffer_load_dwordx4 a[20:23], v4, s[16:19], s63 offen offset:2048
    v_mfma_f32_32x32x16_bf16 v[188:203], v[108:111], v[108:111], v[188:203]
    v_mfma_f32_32x32x16_bf16 v[124:139], a[24:27], v[112:115], v[124:139]
    ds_read_b64_tr_b16 v[108:109], v78 offset:39936
    ds_read_b64_tr_b16 v[110:111], v78 offset:40448
    v_mfma_f32_32x32x16_bf16 v[140:155], a[28:31], v[112:115], v[140:155]
    s_add_u32 s63, s47, 0
    buffer_load_dwordx4 a[24:27], v4, s[16:19], s63 offen offset:3072
    s_add_u32 s63, s47, 88064
    buffer_load_dwordx4 a[28:31], v4, s[16:19], s63 offen offset:3072
    s_waitcnt lgkmcnt(2)
    v_mfma_f32_32x32x16_bf16 v[188:203], v[112:115], v[112:115], v[188:203]
    s_waitcnt lgkmcnt(6)
    v_mfma_f32_32x32x16_bf16 v[124:139], a[32:35], v[116:119], v[124:139]
    v_add_u32 v79, 32768, v79
    ds_read_b64_tr_b16 v[112:113], v79 offset:32768
    ds_read_b64_tr_b16 v[114:115], v79 offset:33280
    s_add_u32 m0, s93, 2048
    s_add_u32 s60, s92, 2048
    buffer_load_dwordx4 v73, s[8:11], s60 offen lds
    v_add_f32 v216, v216, v220
    v_add_f32 v217, v217, v221
    v_add_f32 v218, v218, v222
    v_mfma_f32_32x32x16_bf16 v[140:155], a[36:39], v[116:119], v[140:155]
    s_add_u32 s63, s47, 4096
    buffer_load_dwordx4 a[32:35], v4, s[16:19], s63 offen offset:0
    s_add_u32 s63, s47, 92160
    buffer_load_dwordx4 a[36:39], v4, s[16:19], s63 offen offset:0
    v_add_f32 v219, v219, v223
    v_add_f32 v216, v216, v217
    v_add_f32 v218, v218, v219
    v_mfma_f32_32x32x16_bf16 v[188:203], v[116:119], v[116:119], v[188:203]
    v_mfma_f32_32x32x16_bf16 v[124:139], a[40:43], v[120:123], v[124:139]
    ds_read_b64_tr_b16 v[116:117], v79 offset:33792
    ds_read_b64_tr_b16 v[118:119], v79 offset:34304
    v_add_f32 v216, v216, v218
    v_mul_f32 v216, 0x3b000000, v216
    v_add_f32 v212, 0x3727c5ac, v216
    v_mfma_f32_32x32x16_bf16 v[140:155], a[44:47], v[120:123], v[140:155]
    s_add_u32 s63, s47, 4096
    buffer_load_dwordx4 a[40:43], v4, s[16:19], s63 offen offset:1024
    s_add_u32 s63, s47, 92160
    buffer_load_dwordx4 a[44:47], v4, s[16:19], s63 offen offset:1024
    v_rsq_f32 v217, v212
    s_nop 0
    v_mul_f32 v208, 0xc0135761, v217
    v_mfma_f32_32x32x16_bf16 v[188:203], v[120:123], v[120:123], v[188:203]
    s_waitcnt lgkmcnt(4)
    v_mfma_f32_32x32x16_bf16 v[124:139], a[48:51], v[104:107], v[124:139]
    ds_read_b64_tr_b16 v[120:121], v79 offset:34816
    ds_read_b64_tr_b16 v[122:123], v79 offset:35328
    s_add_u32 m0, s93, 3072
    s_add_u32 s60, s92, 3072
    buffer_load_dwordx4 v73, s[8:11], s60 offen lds
    v_mul_f32 v218, v217, v217
    v_mul_f32 v218, v218, v217
    v_mul_f32 v210, 0xbdd2d3e8, v218
    v_mfma_f32_32x32x16_bf16 v[140:155], a[52:55], v[104:107], v[140:155]
    s_add_u32 s63, s47, 4096
    buffer_load_dwordx4 a[48:51], v4, s[16:19], s63 offen offset:2048
    s_add_u32 s63, s47, 92160
    buffer_load_dwordx4 a[52:55], v4, s[16:19], s63 offen offset:2048
    v_mul_f32 v216, v156, v156
    v_mul_f32 v222, v158, v158
    v_mul_f32 v228, v160, v160
    v_mfma_f32_32x32x16_bf16 v[188:203], v[104:107], v[104:107], v[188:203]
    v_mfma_f32_32x32x16_bf16 v[124:139], a[56:59], v[108:111], v[124:139]
    ds_read_b64_tr_b16 v[104:105], v79 offset:35840
    ds_read_b64_tr_b16 v[106:107], v79 offset:36352
    v_mul_f32 v234, v162, v162
    v_mul_f32 v217, v157, v157
    v_mul_f32 v223, v159, v159
    v_mfma_f32_32x32x16_bf16 v[140:155], a[60:63], v[108:111], v[140:155]
    s_add_u32 s63, s47, 4096
    buffer_load_dwordx4 a[56:59], v4, s[16:19], s63 offen offset:3072
    s_add_u32 s63, s47, 92160
    buffer_load_dwordx4 a[60:63], v4, s[16:19], s63 offen offset:3072
    v_mul_f32 v229, v161, v161
    v_mul_f32 v235, v163, v163
    v_mul_f32 v220, v156, v172
    v_mfma_f32_32x32x16_bf16 v[188:203], v[108:111], v[108:111], v[188:203]
    s_waitcnt lgkmcnt(4)
    v_mfma_f32_32x32x16_bf16 v[124:139], a[64:67], v[112:115], v[124:139]
    ds_read_b64_tr_b16 v[108:109], v79 offset:36864
    ds_read_b64_tr_b16 v[110:111], v79 offset:37376
    s_add_u32 m0, s93, 4096
    s_add_u32 s60, s92, 4096
    buffer_load_dwordx4 v73, s[8:11], s60 offen lds
    v_mul_f32 v226, v158, v174
    v_mul_f32 v232, v160, v176
    v_mul_f32 v238, v162, v178
    v_mfma_f32_32x32x16_bf16 v[140:155], a[68:71], v[112:115], v[140:155]
    v_mul_f32 v221, v157, v173
    v_mul_f32 v227, v159, v175
    v_mul_f32 v233, v161, v177
    v_mfma_f32_32x32x16_bf16 v[124:139], a[72:75], v[116:119], v[124:139]
    ds_read_b64_tr_b16 v[112:113], v79 offset:37888
    ds_read_b64_tr_b16 v[114:115], v79 offset:38400
    v_mul_f32 v239, v163, v179
    v_fma_f32 v216, v216, v210, v208
    v_fma_f32 v222, v222, v210, v208
    v_mfma_f32_32x32x16_bf16 v[140:155], a[76:79], v[116:119], v[140:155]
    v_fma_f32 v228, v228, v210, v208
    v_fma_f32 v234, v234, v210, v208
    v_fma_f32 v217, v217, v210, v208
    s_waitcnt lgkmcnt(4)
    v_mfma_f32_32x32x16_bf16 v[124:139], a[80:83], v[120:123], v[124:139]
    ds_read_b64_tr_b16 v[116:117], v79 offset:38912
    ds_read_b64_tr_b16 v[118:119], v79 offset:39424
    s_add_u32 m0, s93, 5120
    s_add_u32 s60, s92, 5120
    buffer_load_dwordx4 v73, s[8:11], s60 offen lds
    v_fma_f32 v223, v223, v210, v208
    v_fma_f32 v229, v229, v210, v208
    v_fma_f32 v235, v235, v210, v208
    v_mfma_f32_32x32x16_bf16 v[140:155], a[84:87], v[120:123], v[140:155]
    v_mul_f32 v216, v216, v156
    v_mul_f32 v222, v222, v158
    v_mul_f32 v228, v228, v160
    v_mul_f32 v204, v188, v88
    v_mul_f32 v205, v189, v89
    v_fmac_f32 v204, v190, v90
    v_fmac_f32 v205, v191, v91
    v_fmac_f32 v204, v192, v92
    v_fmac_f32 v205, v193, v93
    v_fmac_f32 v204, v194, v94
    v_fmac_f32 v205, v195, v95
    v_fmac_f32 v204, v196, v96
    v_fmac_f32 v205, v197, v97
    v_fmac_f32 v204, v198, v98
    v_fmac_f32 v205, v199, v99
    v_fmac_f32 v204, v200, v100
    v_fmac_f32 v205, v201, v101
    v_fmac_f32 v204, v202, v102
    v_fmac_f32 v205, v203, v103
    v_add_f32 v204, v204, v205
    ds_write_b32 v83, v204 offset:2048
    v_mfma_f32_32x32x16_bf16 v[124:139], a[88:91], v[104:107], v[124:139]
    ds_read_b64_tr_b16 v[120:121], v79 offset:39936
    ds_read_b64_tr_b16 v[122:123], v79 offset:40448
    v_mul_f32 v234, v234, v162
    v_mul_f32 v217, v217, v157
    v_mul_f32 v223, v223, v159
    v_mfma_f32_32x32x16_bf16 v[140:155], a[92:95], v[104:107], v[140:155]
    v_mul_f32 v229, v229, v161
    v_mul_f32 v235, v235, v163
    v_exp_f32 v218, v216
    s_waitcnt lgkmcnt(5)
    v_mfma_f32_32x32x16_bf16 v[124:139], a[96:99], v[108:111], v[124:139]
    v_add_u32 v80, 32768, v80
    ds_read_b64_tr_b16 v[104:105], v80 offset:32768
    ds_read_b64_tr_b16 v[106:107], v80 offset:33280
    s_add_u32 m0, s93, 6144
    s_add_u32 s60, s92, 6144
    buffer_load_dwordx4 v73, s[8:11], s60 offen lds
    v_exp_f32 v224, v222
    v_exp_f32 v230, v228
    v_exp_f32 v236, v234
    v_mfma_f32_32x32x16_bf16 v[140:155], a[100:103], v[108:111], v[140:155]
    v_exp_f32 v219, v217
    v_exp_f32 v225, v223
    v_exp_f32 v231, v229
    v_mfma_f32_32x32x16_bf16 v[124:139], a[104:107], v[112:115], v[124:139]
    ds_read_b64_tr_b16 v[108:109], v80 offset:33792
    ds_read_b64_tr_b16 v[110:111], v80 offset:34304
    v_exp_f32 v237, v235
    v_fma_f32 v218, v218, v212, v212
    v_fma_f32 v224, v224, v212, v212
    v_mfma_f32_32x32x16_bf16 v[140:155], a[108:111], v[112:115], v[140:155]
    v_fma_f32 v230, v230, v212, v212
    v_fma_f32 v236, v236, v212, v212
    v_fma_f32 v219, v219, v212, v212
    s_waitcnt lgkmcnt(4)
    v_mfma_f32_32x32x16_bf16 v[124:139], a[112:115], v[116:119], v[124:139]
    ds_read_b64_tr_b16 v[112:113], v80 offset:34816
    ds_read_b64_tr_b16 v[114:115], v80 offset:35328
    s_add_u32 m0, s93, 7168
    s_add_u32 s60, s92, 7168
    buffer_load_dwordx4 v73, s[8:11], s60 offen lds
    v_fma_f32 v225, v225, v212, v212
    v_fma_f32 v231, v231, v212, v212
    v_fma_f32 v237, v237, v212, v212
    v_mfma_f32_32x32x16_bf16 v[140:155], a[116:119], v[116:119], v[140:155]
    v_rcp_f32 v218, v218
    v_rcp_f32 v224, v224
    v_rcp_f32 v230, v230
    v_mfma_f32_32x32x16_bf16 v[124:139], a[120:123], v[120:123], v[124:139]
    ds_read_b64_tr_b16 v[116:117], v80 offset:35840
    ds_read_b64_tr_b16 v[118:119], v80 offset:36352
    v_rcp_f32 v236, v236
    v_rcp_f32 v219, v219
    v_rcp_f32 v225, v225
    v_mfma_f32_32x32x16_bf16 v[140:155], a[124:127], v[120:123], v[140:155]
    v_rcp_f32 v231, v231
    v_rcp_f32 v237, v237
    v_mul_f32 v220, v220, v218
    s_waitcnt lgkmcnt(4)
    v_mfma_f32_32x32x16_bf16 v[124:139], a[128:131], v[104:107], v[124:139]
    ds_read_b64_tr_b16 v[120:121], v80 offset:36864
    ds_read_b64_tr_b16 v[122:123], v80 offset:37376
    s_add_u32 m0, s93, 8192
    s_add_u32 s60, s92, 32768
    buffer_load_dwordx4 v73, s[8:11], s60 offen lds
    v_mul_f32 v226, v226, v224
    v_mul_f32 v232, v232, v230
    v_mul_f32 v238, v238, v236
    v_mfma_f32_32x32x16_bf16 v[140:155], a[132:135], v[104:107], v[140:155]
    v_mul_f32 v221, v221, v219
    v_mul_f32 v227, v227, v225
    v_mul_f32 v233, v233, v231
    v_mfma_f32_32x32x16_bf16 v[124:139], a[136:139], v[108:111], v[124:139]
    ds_read_b64_tr_b16 v[104:105], v80 offset:37888
    ds_read_b64_tr_b16 v[106:107], v80 offset:38400
    v_mul_f32 v239, v239, v237
    v_cvt_pk_bf16_f32 v240, v220, v221
    v_cvt_pk_bf16_f32 v241, v226, v227
    v_mfma_f32_32x32x16_bf16 v[140:155], a[140:143], v[108:111], v[140:155]
    v_cvt_pk_bf16_f32 v242, v232, v233
    v_cvt_pk_bf16_f32 v243, v238, v239
    s_add_u32 s24, s38, 88064
    s_waitcnt lgkmcnt(4)
    v_mfma_f32_32x32x16_bf16 v[124:139], a[144:147], v[112:115], v[124:139]
    ds_read_b64_tr_b16 v[108:109], v80 offset:38912
    ds_read_b64_tr_b16 v[110:111], v80 offset:39424
    s_add_u32 m0, s93, 9216
    s_add_u32 s60, s92, 33792
    buffer_load_dwordx4 v73, s[8:11], s60 offen lds
    buffer_store_dwordx4 v[240:243], v77, s[12:15], s24 offen sc1
    v_mul_f32 v216, v164, v164
    v_mul_f32 v222, v166, v166
    v_mfma_f32_32x32x16_bf16 v[140:155], a[148:151], v[112:115], v[140:155]
    v_mul_f32 v228, v168, v168
    v_mul_f32 v234, v170, v170
    v_mul_f32 v217, v165, v165
    v_mfma_f32_32x32x16_bf16 v[124:139], a[152:155], v[116:119], v[124:139]
    ds_read_b64_tr_b16 v[112:113], v80 offset:39936
    ds_read_b64_tr_b16 v[114:115], v80 offset:40448
    v_mul_f32 v223, v167, v167
    v_mul_f32 v229, v169, v169
    v_mul_f32 v235, v171, v171
    v_mfma_f32_32x32x16_bf16 v[140:155], a[156:159], v[116:119], v[140:155]
    v_mul_f32 v220, v164, v180
    v_mul_f32 v226, v166, v182
    v_mul_f32 v232, v168, v184
    s_waitcnt lgkmcnt(4)
    v_mfma_f32_32x32x16_bf16 v[124:139], a[160:163], v[120:123], v[124:139]
    v_add_u32 v81, 32768, v81
    ds_read_b64_tr_b16 v[116:117], v81 offset:32768
    ds_read_b64_tr_b16 v[118:119], v81 offset:33280
    s_add_u32 m0, s93, 10240
    s_add_u32 s60, s92, 34816
    buffer_load_dwordx4 v73, s[8:11], s60 offen lds
    v_mul_f32 v238, v170, v186
    v_mul_f32 v221, v165, v181
    v_mul_f32 v227, v167, v183
    v_mfma_f32_32x32x16_bf16 v[140:155], a[164:167], v[120:123], v[140:155]
    v_mul_f32 v233, v169, v185
    v_mul_f32 v239, v171, v187
    v_fma_f32 v216, v216, v210, v208
    v_mfma_f32_32x32x16_bf16 v[124:139], a[168:171], v[104:107], v[124:139]
    ds_read_b64_tr_b16 v[120:121], v81 offset:33792
    ds_read_b64_tr_b16 v[122:123], v81 offset:34304
    v_fma_f32 v222, v222, v210, v208
    v_fma_f32 v228, v228, v210, v208
    v_fma_f32 v234, v234, v210, v208
    v_mfma_f32_32x32x16_bf16 v[140:155], a[172:175], v[104:107], v[140:155]
    v_fma_f32 v217, v217, v210, v208
    v_fma_f32 v223, v223, v210, v208
    v_fma_f32 v229, v229, v210, v208
    s_waitcnt lgkmcnt(4)
    v_mfma_f32_32x32x16_bf16 v[124:139], a[176:179], v[108:111], v[124:139]
    ds_read_b64_tr_b16 v[104:105], v81 offset:34816
    ds_read_b64_tr_b16 v[106:107], v81 offset:35328
    s_add_u32 m0, s93, 11264
    s_add_u32 s60, s92, 35840
    buffer_load_dwordx4 v73, s[8:11], s60 offen lds
    v_fma_f32 v235, v235, v210, v208
    v_mul_f32 v216, v216, v164
    v_mul_f32 v222, v222, v166
    v_mfma_f32_32x32x16_bf16 v[140:155], a[180:183], v[108:111], v[140:155]
    v_mul_f32 v228, v228, v168
    v_mul_f32 v234, v234, v170
    v_mul_f32 v217, v217, v165
    v_mfma_f32_32x32x16_bf16 v[124:139], a[184:187], v[112:115], v[124:139]
    ds_read_b64_tr_b16 v[108:109], v81 offset:35840
    ds_read_b64_tr_b16 v[110:111], v81 offset:36352
    v_mul_f32 v223, v223, v167
    v_mul_f32 v229, v229, v169
    v_mul_f32 v235, v235, v171
    v_mfma_f32_32x32x16_bf16 v[140:155], a[188:191], v[112:115], v[140:155]
    v_exp_f32 v218, v216
    v_exp_f32 v224, v222
    v_exp_f32 v230, v228
    s_waitcnt lgkmcnt(4)
    v_mfma_f32_32x32x16_bf16 v[124:139], a[192:195], v[116:119], v[124:139]
    ds_read_b64_tr_b16 v[112:113], v81 offset:36864
    ds_read_b64_tr_b16 v[114:115], v81 offset:37376
    s_add_u32 m0, s93, 12288
    s_add_u32 s60, s92, 36864
    buffer_load_dwordx4 v73, s[8:11], s60 offen lds
    v_exp_f32 v236, v234
    v_exp_f32 v219, v217
    v_exp_f32 v225, v223
    v_mfma_f32_32x32x16_bf16 v[140:155], a[196:199], v[116:119], v[140:155]
    v_exp_f32 v231, v229
    v_exp_f32 v237, v235
    v_fma_f32 v218, v218, v212, v212
    v_mfma_f32_32x32x16_bf16 v[124:139], a[200:203], v[120:123], v[124:139]
    ds_read_b64_tr_b16 v[116:117], v81 offset:37888
    ds_read_b64_tr_b16 v[118:119], v81 offset:38400
    v_fma_f32 v224, v224, v212, v212
    v_fma_f32 v230, v230, v212, v212
    v_fma_f32 v236, v236, v212, v212
    v_mfma_f32_32x32x16_bf16 v[140:155], a[204:207], v[120:123], v[140:155]
    v_fma_f32 v219, v219, v212, v212
    v_fma_f32 v225, v225, v212, v212
    v_fma_f32 v231, v231, v212, v212
    s_waitcnt lgkmcnt(4)
    v_mfma_f32_32x32x16_bf16 v[124:139], a[208:211], v[104:107], v[124:139]
    ds_read_b64_tr_b16 v[120:121], v81 offset:38912
    ds_read_b64_tr_b16 v[122:123], v81 offset:39424
    s_add_u32 m0, s93, 13312
    s_add_u32 s60, s92, 37888
    buffer_load_dwordx4 v73, s[8:11], s60 offen lds
    v_fma_f32 v237, v237, v212, v212
    v_rcp_f32 v218, v218
    v_rcp_f32 v224, v224
    v_mfma_f32_32x32x16_bf16 v[140:155], a[212:215], v[104:107], v[140:155]
    v_rcp_f32 v230, v230
    v_rcp_f32 v236, v236
    v_rcp_f32 v219, v219
    v_mfma_f32_32x32x16_bf16 v[124:139], a[216:219], v[108:111], v[124:139]
    ds_read_b64_tr_b16 v[104:105], v81 offset:39936
    ds_read_b64_tr_b16 v[106:107], v81 offset:40448
    v_rcp_f32 v225, v225
    v_rcp_f32 v231, v231
    v_rcp_f32 v237, v237
    v_mfma_f32_32x32x16_bf16 v[140:155], a[220:223], v[108:111], v[140:155]
    v_mul_f32 v220, v220, v218
    v_mul_f32 v226, v226, v224
    v_mul_f32 v232, v232, v230
    s_barrier
    s_waitcnt lgkmcnt(4)
    v_mfma_f32_32x32x16_bf16 v[124:139], a[224:227], v[112:115], v[124:139]
    s_add_u32 m0, s93, 14336
    s_add_u32 s60, s92, 38912
    buffer_load_dwordx4 v73, s[8:11], s60 offen lds
    v_mul_f32 v238, v238, v236
    v_mul_f32 v221, v221, v219
    v_mul_f32 v227, v227, v225
    v_mfma_f32_32x32x16_bf16 v[140:155], a[228:231], v[112:115], v[140:155]
    v_mul_f32 v233, v233, v231
    v_mul_f32 v239, v239, v237
    v_cvt_pk_bf16_f32 v244, v220, v221
    v_mfma_f32_32x32x16_bf16 v[124:139], a[232:235], v[116:119], v[124:139]
    v_cvt_pk_bf16_f32 v245, v226, v227
    v_cvt_pk_bf16_f32 v246, v232, v233
    v_cvt_pk_bf16_f32 v247, v238, v239
    v_mfma_f32_32x32x16_bf16 v[140:155], a[236:239], v[116:119], v[140:155]
    s_add_u32 s24, s38, 89088
    buffer_store_dwordx4 v[244:247], v77, s[12:15], s24 offen sc1
    s_waitcnt lgkmcnt(0)
    v_mfma_f32_32x32x16_bf16 v[124:139], a[240:243], v[120:123], v[124:139]
    s_add_u32 m0, s93, 15360
    s_add_u32 s60, s92, 39936
    buffer_load_dwordx4 v73, s[8:11], s60 offen lds
    v_mfma_f32_32x32x16_bf16 v[140:155], a[244:247], v[120:123], v[140:155]
    v_mfma_f32_32x32x16_bf16 v[124:139], a[248:251], v[104:107], v[124:139]
    v_mfma_f32_32x32x16_bf16 v[140:155], a[252:255], v[104:107], v[140:155]
    ds_read_b128 v[216:219], v84 offset:2048
    ds_read_b128 v[220:223], v84 offset:2064
    s_waitcnt lgkmcnt(0)
    v_add_f32 v216, v216, v220
    v_add_f32 v217, v217, v221
    v_add_f32 v218, v218, v222
    v_add_f32 v219, v219, v223
    v_add_f32 v216, v216, v217
    v_add_f32 v218, v218, v219
    v_add_f32 v216, v216, v218
    v_mul_f32 v216, 0x3b000000, v216
    v_add_f32 v212, 0x3727c5ac, v216
    v_rsq_f32 v217, v212
    s_nop 0
    v_mul_f32 v208, 0xc0135761, v217
    v_mul_f32 v218, v217, v217
    v_mul_f32 v218, v218, v217
    v_mul_f32 v210, 0xbdd2d3e8, v218
    v_pk_mul_f32 v[216:217], v[124:125], v[124:125]
    v_pk_mul_f32 v[222:223], v[126:127], v[126:127]
    v_pk_mul_f32 v[228:229], v[128:129], v[128:129]
    v_pk_mul_f32 v[234:235], v[130:131], v[130:131]
    v_pk_mul_f32 v[220:221], v[124:125], v[140:141]
    v_pk_mul_f32 v[226:227], v[126:127], v[142:143]
    v_pk_mul_f32 v[232:233], v[128:129], v[144:145]
    v_pk_mul_f32 v[238:239], v[130:131], v[146:147]
    v_pk_fma_f32 v[216:217], v[216:217], v[210:211], v[208:209] op_sel_hi:[1,0,0]
    v_pk_fma_f32 v[222:223], v[222:223], v[210:211], v[208:209] op_sel_hi:[1,0,0]
    v_pk_fma_f32 v[228:229], v[228:229], v[210:211], v[208:209] op_sel_hi:[1,0,0]
    v_pk_fma_f32 v[234:235], v[234:235], v[210:211], v[208:209] op_sel_hi:[1,0,0]
    v_pk_mul_f32 v[216:217], v[216:217], v[124:125]
    v_pk_mul_f32 v[222:223], v[222:223], v[126:127]
    v_pk_mul_f32 v[228:229], v[228:229], v[128:129]
    v_pk_mul_f32 v[234:235], v[234:235], v[130:131]
    v_exp_f32 v218, v216
    v_exp_f32 v224, v222
    v_exp_f32 v230, v228
    v_exp_f32 v236, v234
    v_exp_f32 v219, v217
    v_exp_f32 v225, v223
    v_exp_f32 v231, v229
    v_exp_f32 v237, v235
    v_pk_fma_f32 v[218:219], v[218:219], v[212:213], v[212:213] op_sel_hi:[1,0,0]
    v_pk_fma_f32 v[224:225], v[224:225], v[212:213], v[212:213] op_sel_hi:[1,0,0]
    v_pk_fma_f32 v[230:231], v[230:231], v[212:213], v[212:213] op_sel_hi:[1,0,0]
    v_pk_fma_f32 v[236:237], v[236:237], v[212:213], v[212:213] op_sel_hi:[1,0,0]
    v_rcp_f32 v218, v218
    v_rcp_f32 v224, v224
    v_rcp_f32 v230, v230
    v_rcp_f32 v236, v236
    v_rcp_f32 v219, v219
    v_rcp_f32 v225, v225
    v_rcp_f32 v231, v231
    v_rcp_f32 v237, v237
    v_pk_mul_f32 v[220:221], v[220:221], v[218:219]
    v_pk_mul_f32 v[226:227], v[226:227], v[224:225]
    v_pk_mul_f32 v[232:233], v[232:233], v[230:231]
    v_pk_mul_f32 v[238:239], v[238:239], v[236:237]
    v_cvt_pk_bf16_f32 v240, v220, v221
    v_cvt_pk_bf16_f32 v241, v226, v227
    v_cvt_pk_bf16_f32 v242, v232, v233
    v_cvt_pk_bf16_f32 v243, v238, v239
    s_add_u32 s24, s38, 176128
    buffer_store_dwordx4 v[240:243], v77, s[12:15], s24 offen sc1
    v_pk_mul_f32 v[216:217], v[132:133], v[132:133]
    v_pk_mul_f32 v[222:223], v[134:135], v[134:135]
    v_pk_mul_f32 v[228:229], v[136:137], v[136:137]
    v_pk_mul_f32 v[234:235], v[138:139], v[138:139]
    v_pk_mul_f32 v[220:221], v[132:133], v[148:149]
    v_pk_mul_f32 v[226:227], v[134:135], v[150:151]
    v_pk_mul_f32 v[232:233], v[136:137], v[152:153]
    v_pk_mul_f32 v[238:239], v[138:139], v[154:155]
    v_pk_fma_f32 v[216:217], v[216:217], v[210:211], v[208:209] op_sel_hi:[1,0,0]
    v_pk_fma_f32 v[222:223], v[222:223], v[210:211], v[208:209] op_sel_hi:[1,0,0]
    v_pk_fma_f32 v[228:229], v[228:229], v[210:211], v[208:209] op_sel_hi:[1,0,0]
    v_pk_fma_f32 v[234:235], v[234:235], v[210:211], v[208:209] op_sel_hi:[1,0,0]
    v_pk_mul_f32 v[216:217], v[216:217], v[132:133]
    v_pk_mul_f32 v[222:223], v[222:223], v[134:135]
    v_pk_mul_f32 v[228:229], v[228:229], v[136:137]
    v_pk_mul_f32 v[234:235], v[234:235], v[138:139]
    v_exp_f32 v218, v216
    v_exp_f32 v224, v222
    v_exp_f32 v230, v228
    v_exp_f32 v236, v234
    v_exp_f32 v219, v217
    v_exp_f32 v225, v223
    v_exp_f32 v231, v229
    v_exp_f32 v237, v235
    v_pk_fma_f32 v[218:219], v[218:219], v[212:213], v[212:213] op_sel_hi:[1,0,0]
    v_pk_fma_f32 v[224:225], v[224:225], v[212:213], v[212:213] op_sel_hi:[1,0,0]
    v_pk_fma_f32 v[230:231], v[230:231], v[212:213], v[212:213] op_sel_hi:[1,0,0]
    v_pk_fma_f32 v[236:237], v[236:237], v[212:213], v[212:213] op_sel_hi:[1,0,0]
    v_rcp_f32 v218, v218
    v_rcp_f32 v224, v224
    v_rcp_f32 v230, v230
    v_rcp_f32 v236, v236
    v_rcp_f32 v219, v219
    v_rcp_f32 v225, v225
    v_rcp_f32 v231, v231
    v_rcp_f32 v237, v237
    v_pk_mul_f32 v[220:221], v[220:221], v[218:219]
    v_pk_mul_f32 v[226:227], v[226:227], v[224:225]
    v_pk_mul_f32 v[232:233], v[232:233], v[230:231]
    v_pk_mul_f32 v[238:239], v[238:239], v[236:237]
    v_cvt_pk_bf16_f32 v244, v220, v221
    v_cvt_pk_bf16_f32 v245, v226, v227
    v_cvt_pk_bf16_f32 v246, v232, v233
    v_cvt_pk_bf16_f32 v247, v238, v239
    s_add_u32 s24, s38, 177152
    buffer_store_dwordx4 v[244:247], v77, s[12:15], s24 offen sc1
    s_nop 0
    s_branch L_g4_done_64
L_g4_done_64_1:
    s_waitcnt lgkmcnt(0)
    ds_read_b128 v[216:219], v84 offset:0
    ds_read_b128 v[220:223], v84 offset:16
    s_waitcnt lgkmcnt(0)
    v_add_f32 v216, v216, v220
    v_add_f32 v217, v217, v221
    v_add_f32 v218, v218, v222
    v_add_f32 v219, v219, v223
    v_add_f32 v216, v216, v217
    v_add_f32 v218, v218, v219
    v_add_f32 v216, v216, v218
    v_mul_f32 v216, 0x3b000000, v216
    v_add_f32 v212, 0x3727c5ac, v216
    v_rsq_f32 v217, v212
    s_nop 0
    v_mul_f32 v208, 0xc0135761, v217
    v_mul_f32 v218, v217, v217
    v_mul_f32 v218, v218, v217
    v_mul_f32 v210, 0xbdd2d3e8, v218
    v_pk_mul_f32 v[216:217], v[124:125], v[124:125]
    v_pk_mul_f32 v[222:223], v[126:127], v[126:127]
    v_pk_mul_f32 v[228:229], v[128:129], v[128:129]
    v_pk_mul_f32 v[234:235], v[130:131], v[130:131]
    v_pk_mul_f32 v[220:221], v[124:125], v[140:141]
    v_pk_mul_f32 v[226:227], v[126:127], v[142:143]
    v_pk_mul_f32 v[232:233], v[128:129], v[144:145]
    v_pk_mul_f32 v[238:239], v[130:131], v[146:147]
    v_pk_fma_f32 v[216:217], v[216:217], v[210:211], v[208:209] op_sel_hi:[1,0,0]
    v_pk_fma_f32 v[222:223], v[222:223], v[210:211], v[208:209] op_sel_hi:[1,0,0]
    v_pk_fma_f32 v[228:229], v[228:229], v[210:211], v[208:209] op_sel_hi:[1,0,0]
    v_pk_fma_f32 v[234:235], v[234:235], v[210:211], v[208:209] op_sel_hi:[1,0,0]
    v_pk_mul_f32 v[216:217], v[216:217], v[124:125]
    v_pk_mul_f32 v[222:223], v[222:223], v[126:127]
    v_pk_mul_f32 v[228:229], v[228:229], v[128:129]
    v_pk_mul_f32 v[234:235], v[234:235], v[130:131]
    v_exp_f32 v218, v216
    v_exp_f32 v224, v222
    v_exp_f32 v230, v228
    v_exp_f32 v236, v234
    v_exp_f32 v219, v217
    v_exp_f32 v225, v223
    v_exp_f32 v231, v229
    v_exp_f32 v237, v235
    v_pk_fma_f32 v[218:219], v[218:219], v[212:213], v[212:213] op_sel_hi:[1,0,0]
    v_pk_fma_f32 v[224:225], v[224:225], v[212:213], v[212:213] op_sel_hi:[1,0,0]
    v_pk_fma_f32 v[230:231], v[230:231], v[212:213], v[212:213] op_sel_hi:[1,0,0]
    v_pk_fma_f32 v[236:237], v[236:237], v[212:213], v[212:213] op_sel_hi:[1,0,0]
    v_rcp_f32 v218, v218
    v_rcp_f32 v224, v224
    v_rcp_f32 v230, v230
    v_rcp_f32 v236, v236
    v_rcp_f32 v219, v219
    v_rcp_f32 v225, v225
    v_rcp_f32 v231, v231
    v_rcp_f32 v237, v237
    v_pk_mul_f32 v[220:221], v[220:221], v[218:219]
    v_pk_mul_f32 v[226:227], v[226:227], v[224:225]
    v_pk_mul_f32 v[232:233], v[232:233], v[230:231]
    v_pk_mul_f32 v[238:239], v[238:239], v[236:237]
    v_cvt_pk_bf16_f32 v240, v220, v221
    v_cvt_pk_bf16_f32 v241, v226, v227
    v_cvt_pk_bf16_f32 v242, v232, v233
    v_cvt_pk_bf16_f32 v243, v238, v239
    s_add_u32 s24, s38, 0
    buffer_store_dwordx4 v[240:243], v77, s[12:15], s24 offen sc1
    v_pk_mul_f32 v[216:217], v[132:133], v[132:133]
    v_pk_mul_f32 v[222:223], v[134:135], v[134:135]
    v_pk_mul_f32 v[228:229], v[136:137], v[136:137]
    v_pk_mul_f32 v[234:235], v[138:139], v[138:139]
    v_pk_mul_f32 v[220:221], v[132:133], v[148:149]
    v_pk_mul_f32 v[226:227], v[134:135], v[150:151]
    v_pk_mul_f32 v[232:233], v[136:137], v[152:153]
    v_pk_mul_f32 v[238:239], v[138:139], v[154:155]
    v_pk_fma_f32 v[216:217], v[216:217], v[210:211], v[208:209] op_sel_hi:[1,0,0]
    v_pk_fma_f32 v[222:223], v[222:223], v[210:211], v[208:209] op_sel_hi:[1,0,0]
    v_pk_fma_f32 v[228:229], v[228:229], v[210:211], v[208:209] op_sel_hi:[1,0,0]
    v_pk_fma_f32 v[234:235], v[234:235], v[210:211], v[208:209] op_sel_hi:[1,0,0]
    v_pk_mul_f32 v[216:217], v[216:217], v[132:133]
    v_pk_mul_f32 v[222:223], v[222:223], v[134:135]
    v_pk_mul_f32 v[228:229], v[228:229], v[136:137]
    v_pk_mul_f32 v[234:235], v[234:235], v[138:139]
    v_exp_f32 v218, v216
    v_exp_f32 v224, v222
    v_exp_f32 v230, v228
    v_exp_f32 v236, v234
    v_exp_f32 v219, v217
    v_exp_f32 v225, v223
    v_exp_f32 v231, v229
    v_exp_f32 v237, v235
    v_pk_fma_f32 v[218:219], v[218:219], v[212:213], v[212:213] op_sel_hi:[1,0,0]
    v_pk_fma_f32 v[224:225], v[224:225], v[212:213], v[212:213] op_sel_hi:[1,0,0]
    v_pk_fma_f32 v[230:231], v[230:231], v[212:213], v[212:213] op_sel_hi:[1,0,0]
    v_pk_fma_f32 v[236:237], v[236:237], v[212:213], v[212:213] op_sel_hi:[1,0,0]
    v_rcp_f32 v218, v218
    v_rcp_f32 v224, v224
    v_rcp_f32 v230, v230
    v_rcp_f32 v236, v236
    v_rcp_f32 v219, v219
    v_rcp_f32 v225, v225
    v_rcp_f32 v231, v231
    v_rcp_f32 v237, v237
    v_pk_mul_f32 v[220:221], v[220:221], v[218:219]
    v_pk_mul_f32 v[226:227], v[226:227], v[224:225]
    v_pk_mul_f32 v[232:233], v[232:233], v[230:231]
    v_pk_mul_f32 v[238:239], v[238:239], v[236:237]
    v_cvt_pk_bf16_f32 v244, v220, v221
    v_cvt_pk_bf16_f32 v245, v226, v227
    v_cvt_pk_bf16_f32 v246, v232, v233
    v_cvt_pk_bf16_f32 v247, v238, v239
    s_add_u32 s24, s38, 1024
    buffer_store_dwordx4 v[244:247], v77, s[12:15], s24 offen sc1
    s_nop 1
L_g4_done_64:
    s_add_u32 s63, s47, 8192
    buffer_load_dwordx4 a[64:67], v4, s[16:19], s63 offen offset:0
    s_add_u32 s63, s47, 96256
    buffer_load_dwordx4 a[68:71], v4, s[16:19], s63 offen offset:0
    s_add_u32 s63, s47, 8192
    buffer_load_dwordx4 a[72:75], v4, s[16:19], s63 offen offset:1024
    s_add_u32 s63, s47, 96256
    buffer_load_dwordx4 a[76:79], v4, s[16:19], s63 offen offset:1024
    s_add_u32 s63, s47, 8192
    buffer_load_dwordx4 a[80:83], v4, s[16:19], s63 offen offset:2048
    s_add_u32 s63, s47, 96256
    buffer_load_dwordx4 a[84:87], v4, s[16:19], s63 offen offset:2048
    s_add_u32 s63, s47, 8192
    buffer_load_dwordx4 a[88:91], v4, s[16:19], s63 offen offset:3072
    s_add_u32 s63, s47, 96256
    buffer_load_dwordx4 a[92:95], v4, s[16:19], s63 offen offset:3072
    s_add_u32 s63, s47, 12288
    buffer_load_dwordx4 a[96:99], v4, s[16:19], s63 offen offset:0
    s_add_u32 s63, s47, 100352
    buffer_load_dwordx4 a[100:103], v4, s[16:19], s63 offen offset:0
    s_add_u32 s63, s47, 12288
    buffer_load_dwordx4 a[104:107], v4, s[16:19], s63 offen offset:1024
    s_add_u32 s63, s47, 100352
    buffer_load_dwordx4 a[108:111], v4, s[16:19], s63 offen offset:1024
    s_add_u32 s63, s47, 12288
    buffer_load_dwordx4 a[112:115], v4, s[16:19], s63 offen offset:2048
    s_add_u32 s63, s47, 100352
    buffer_load_dwordx4 a[116:119], v4, s[16:19], s63 offen offset:2048
    s_add_u32 s63, s47, 12288
    buffer_load_dwordx4 a[120:123], v4, s[16:19], s63 offen offset:3072
    s_add_u32 s63, s47, 100352
    buffer_load_dwordx4 a[124:127], v4, s[16:19], s63 offen offset:3072
    s_add_u32 s4, s82, 0x1f04000
    s_addc_u32 s5, s83, 0
    s_mov_b32 s6, 0x1000
    s_mov_b32 s7, 0x00020000
    s_lshl_b32 s24, s32, 7
    v_mov_b32 v250, s24
    v_mov_b32 v251, 1
    s_waitcnt vmcnt(16) lgkmcnt(0)
    s_barrier
    s_cmp_lg_u32 s20, 0
    s_cbranch_scc1 L_arr_65
    s_mov_b64 exec, 1
    buffer_atomic_add v251, v250, s[4:7], 0 offen offset:4 sc1
    s_mov_b64 exec, -1
L_arr_65:
    s_add_u32 s63, s47, 16384
    buffer_load_dwordx4 a[128:131], v4, s[16:19], s63 offen offset:0
    s_add_u32 s63, s47, 104448
    buffer_load_dwordx4 a[132:135], v4, s[16:19], s63 offen offset:0
    s_add_u32 s63, s47, 16384
    buffer_load_dwordx4 a[136:139], v4, s[16:19], s63 offen offset:1024
    s_add_u32 s63, s47, 104448
    buffer_load_dwordx4 a[140:143], v4, s[16:19], s63 offen offset:1024
    s_add_u32 s63, s47, 16384
    buffer_load_dwordx4 a[144:147], v4, s[16:19], s63 offen offset:2048
    s_add_u32 s63, s47, 104448
    buffer_load_dwordx4 a[148:151], v4, s[16:19], s63 offen offset:2048
    s_add_u32 s63, s47, 16384
    buffer_load_dwordx4 a[152:155], v4, s[16:19], s63 offen offset:3072
    s_add_u32 s63, s47, 104448
    buffer_load_dwordx4 a[156:159], v4, s[16:19], s63 offen offset:3072
    s_add_u32 s63, s47, 20480
    buffer_load_dwordx4 a[160:163], v4, s[16:19], s63 offen offset:0
    s_add_u32 s63, s47, 108544
    buffer_load_dwordx4 a[164:167], v4, s[16:19], s63 offen offset:0
    s_add_u32 s63, s48, 20480
    buffer_load_dwordx4 a[168:171], v4, s[16:19], s63 offen offset:1024
    s_add_u32 s63, s48, 108544
    buffer_load_dwordx4 a[172:175], v4, s[16:19], s63 offen offset:1024
    s_cmp_lg_u32 s32, 21
    s_cbranch_scc1 L_g4join_58
    s_add_u32 s63, s47, 0
    buffer_load_dwordx4 a[0:3], v4, s[16:19], s63 offen offset:0
    s_add_u32 s63, s47, 88064
    buffer_load_dwordx4 a[4:7], v4, s[16:19], s63 offen offset:0
    s_add_u32 s63, s47, 0
    buffer_load_dwordx4 a[8:11], v4, s[16:19], s63 offen offset:1024
    s_add_u32 s63, s47, 88064
    buffer_load_dwordx4 a[12:15], v4, s[16:19], s63 offen offset:1024
    s_add_u32 s63, s47, 0
    buffer_load_dwordx4 a[16:19], v4, s[16:19], s63 offen offset:2048
    s_add_u32 s63, s47, 88064
    buffer_load_dwordx4 a[20:23], v4, s[16:19], s63 offen offset:2048
    s_add_u32 s63, s47, 0
    buffer_load_dwordx4 a[24:27], v4, s[16:19], s63 offen offset:3072
    s_add_u32 s63, s47, 88064
    buffer_load_dwordx4 a[28:31], v4, s[16:19], s63 offen offset:3072
    s_add_u32 s63, s47, 4096
    buffer_load_dwordx4 a[32:35], v4, s[16:19], s63 offen offset:0
    s_add_u32 s63, s47, 92160
    buffer_load_dwordx4 a[36:39], v4, s[16:19], s63 offen offset:0
    s_add_u32 s63, s47, 4096
    buffer_load_dwordx4 a[40:43], v4, s[16:19], s63 offen offset:1024
    s_add_u32 s63, s47, 92160
    buffer_load_dwordx4 a[44:47], v4, s[16:19], s63 offen offset:1024
    s_add_u32 s63, s47, 4096
    buffer_load_dwordx4 a[48:51], v4, s[16:19], s63 offen offset:2048
    s_add_u32 s63, s47, 92160
    buffer_load_dwordx4 a[52:55], v4, s[16:19], s63 offen offset:2048
    s_add_u32 s63, s47, 4096
    buffer_load_dwordx4 a[56:59], v4, s[16:19], s63 offen offset:3072
    s_add_u32 s63, s47, 92160
    buffer_load_dwordx4 a[60:63], v4, s[16:19], s63 offen offset:3072
    s_add_u32 s60, s94, 0
    buffer_load_dwordx4 v[8:11], v72, s[84:87], s60 offen offset:0
    s_add_u32 s60, s94, 0
    buffer_load_dwordx4 v[12:15], v72, s[84:87], s60 offen offset:1024
    s_add_u32 s60, s94, 0
    buffer_load_dwordx4 v[16:19], v72, s[84:87], s60 offen offset:2048
    s_add_u32 s60, s94, 0
    buffer_load_dwordx4 v[20:23], v72, s[84:87], s60 offen offset:3072
    s_add_u32 s60, s94, 4096
    buffer_load_dwordx4 v[24:27], v72, s[84:87], s60 offen offset:0
    s_add_u32 s60, s94, 4096
    buffer_load_dwordx4 v[28:31], v72, s[84:87], s60 offen offset:1024
    s_add_u32 s60, s94, 4096
    buffer_load_dwordx4 v[32:35], v72, s[84:87], s60 offen offset:2048
    s_add_u32 s60, s94, 4096
    buffer_load_dwordx4 v[36:39], v72, s[84:87], s60 offen offset:3072
    s_add_u32 s60, s94, 32768
    buffer_load_dwordx4 v[40:43], v72, s[84:87], s60 offen offset:0
    s_add_u32 s60, s94, 32768
    buffer_load_dwordx4 v[44:47], v72, s[84:87], s60 offen offset:1024
    s_add_u32 s60, s94, 32768
    buffer_load_dwordx4 v[48:51], v72, s[84:87], s60 offen offset:2048
    s_add_u32 s60, s94, 32768
    buffer_load_dwordx4 v[52:55], v72, s[84:87], s60 offen offset:3072
    s_add_u32 s60, s94, 36864
    buffer_load_dwordx4 v[56:59], v72, s[84:87], s60 offen offset:0
    s_add_u32 s60, s94, 36864
    buffer_load_dwordx4 v[60:63], v72, s[84:87], s60 offen offset:1024
    s_add_u32 s60, s94, 36864
    buffer_load_dwordx4 v[64:67], v72, s[84:87], s60 offen offset:2048
    s_add_u32 s60, s94, 36864
    buffer_load_dwordx4 v[68:71], v72, s[84:87], s60 offen offset:3072
    s_add_u32 m0, s93, 0
    s_add_u32 s60, s92, 0
    buffer_load_dwordx4 v73, s[8:11], s60 offen lds
    s_add_u32 m0, s93, 1024
    s_add_u32 s60, s92, 1024
    buffer_load_dwordx4 v73, s[8:11], s60 offen lds
    s_add_u32 m0, s93, 2048
    s_add_u32 s60, s92, 2048
    buffer_load_dwordx4 v73, s[8:11], s60 offen lds
    s_add_u32 m0, s93, 3072
    s_add_u32 s60, s92, 3072
    buffer_load_dwordx4 v73, s[8:11], s60 offen lds
    s_add_u32 m0, s93, 4096
    s_add_u32 s60, s92, 4096
    buffer_load_dwordx4 v73, s[8:11], s60 offen lds
    s_add_u32 m0, s93, 5120
    s_add_u32 s60, s92, 5120
    buffer_load_dwordx4 v73, s[8:11], s60 offen lds
    s_add_u32 m0, s93, 6144
    s_add_u32 s60, s92, 6144
    buffer_load_dwordx4 v73, s[8:11], s60 offen lds
    s_add_u32 m0, s93, 7168
    s_add_u32 s60, s92, 7168
    buffer_load_dwordx4 v73, s[8:11], s60 offen lds
    s_add_u32 m0, s93, 8192
    s_add_u32 s60, s92, 32768
    buffer_load_dwordx4 v73, s[8:11], s60 offen lds
    s_add_u32 m0, s93, 9216
    s_add_u32 s60, s92, 33792
    buffer_load_dwordx4 v73, s[8:11], s60 offen lds
    s_add_u32 m0, s93, 10240
    s_add_u32 s60, s92, 34816
    buffer_load_dwordx4 v73, s[8:11], s60 offen lds
    s_add_u32 m0, s93, 11264
    s_add_u32 s60, s92, 35840
    buffer_load_dwordx4 v73, s[8:11], s60 offen lds
    s_add_u32 m0, s93, 12288
    s_add_u32 s60, s92, 36864
    buffer_load_dwordx4 v73, s[8:11], s60 offen lds
    s_add_u32 m0, s93, 13312
    s_add_u32 s60, s92, 37888
    buffer_load_dwordx4 v73, s[8:11], s60 offen lds
    s_add_u32 m0, s93, 14336
    s_add_u32 s60, s92, 38912
    buffer_load_dwordx4 v73, s[8:11], s60 offen lds
    s_add_u32 m0, s93, 15360
    s_add_u32 s60, s92, 39936
    buffer_load_dwordx4 v73, s[8:11], s60 offen lds
    s_branch L_g4join_58
L_g4skip_57:
    s_cmp_lg_u32 s20, 0
    s_cbranch_scc1 L_wt2_66
    s_add_u32 s4, s82, 0x1f00000
    s_addc_u32 s5, s83, 0
    s_mov_b32 s6, 0x5000
    s_mov_b32 s7, 0x00020000
    s_and_b32 s24, s22, 15
    s_lshl_b32 s24, s24, 3
    v_and_b32 v250, 7, v1
    v_add_u32 v250, s24, v250
    v_lshlrev_b32 v250, 7, v250
    v_cmp_gt_u32 vcc, 8, v1
    v_mov_b32 v249, 20
    v_mov_b32 v251, 16
    v_cndmask_b32 v249, v249, v251, vcc
    v_add_u32 v250, v250, v249
    v_mov_b32 v249, 32
    v_mov_b32 v251, 32
    v_cndmask_b32 v249, v249, v251, vcc
    s_mov_b64 exec, 0xffff
    s_mov_b32 s31, 0
L_poll_67:
    buffer_load_dword v251, v250, s[4:7], 0 offen sc0 sc1
    s_add_u32 s31, s31, 1
    s_waitcnt vmcnt(0)
    v_cmp_le_u32 vcc, v249, v251
    s_nop 0
    s_cmp_eq_u64 vcc, exec
    s_nop 1
    s_cbranch_scc1 L_polld_68
    s_cmp_lt_u32 s31, 1048576
    s_cbranch_scc1 L_poll_67
L_polld_68:
    s_mov_b64 exec, -1
L_wt2_66:
    s_barrier
    s_add_u32 s16, s82, 0x1a00000
    s_addc_u32 s17, s83, 0
    s_mov_b32 s18, 0x158000
    s_mov_b32 s19, 0x00020000
    s_lshl_b32 s24, s20, 3
    v_xor_b32 v4, s24, v1
    v_lshlrev_b32 v4, 4, v4
    s_mul_i32 s47, s41, 176128
    s_lshl_b32 s24, s42, 10
    s_add_u32 s47, s47, s24
    s_cmp_ge_u32 s20, 2
    s_cselect_b32 s48, 0x7f000000, 0
    s_add_u32 s48, s48, s47
    s_add_u32 s63, s47, 0
    buffer_load_dwordx4 a[0:3], v4, s[16:19], s63 offen offset:0
    s_add_u32 s63, s47, 88064
    buffer_load_dwordx4 a[4:7], v4, s[16:19], s63 offen offset:0
    s_add_u32 s63, s47, 0
    buffer_load_dwordx4 a[8:11], v4, s[16:19], s63 offen offset:1024
    s_add_u32 s63, s47, 88064
    buffer_load_dwordx4 a[12:15], v4, s[16:19], s63 offen offset:1024
    s_add_u32 s63, s47, 0
    buffer_load_dwordx4 a[16:19], v4, s[16:19], s63 offen offset:2048
    s_add_u32 s63, s47, 88064
    buffer_load_dwordx4 a[20:23], v4, s[16:19], s63 offen offset:2048
    s_add_u32 s63, s47, 0
    buffer_load_dwordx4 a[24:27], v4, s[16:19], s63 offen offset:3072
    s_add_u32 s63, s47, 88064
    buffer_load_dwordx4 a[28:31], v4, s[16:19], s63 offen offset:3072
    s_add_u32 s63, s47, 4096
    buffer_load_dwordx4 a[32:35], v4, s[16:19], s63 offen offset:0
    s_add_u32 s63, s47, 92160
    buffer_load_dwordx4 a[36:39], v4, s[16:19], s63 offen offset:0
    s_add_u32 s63, s47, 4096
    buffer_load_dwordx4 a[40:43], v4, s[16:19], s63 offen offset:1024
    s_add_u32 s63, s47, 92160
    buffer_load_dwordx4 a[44:47], v4, s[16:19], s63 offen offset:1024
    s_add_u32 s63, s47, 4096
    buffer_load_dwordx4 a[48:51], v4, s[16:19], s63 offen offset:2048
    s_add_u32 s63, s47, 92160
    buffer_load_dwordx4 a[52:55], v4, s[16:19], s63 offen offset:2048
    s_add_u32 s63, s47, 4096
    buffer_load_dwordx4 a[56:59], v4, s[16:19], s63 offen offset:3072
    s_add_u32 s63, s47, 92160
    buffer_load_dwordx4 a[60:63], v4, s[16:19], s63 offen offset:3072
    s_add_u32 s63, s47, 8192
    buffer_load_dwordx4 a[64:67], v4, s[16:19], s63 offen offset:0
    s_add_u32 s63, s47, 96256
    buffer_load_dwordx4 a[68:71], v4, s[16:19], s63 offen offset:0
    s_add_u32 s63, s47, 8192
    buffer_load_dwordx4 a[72:75], v4, s[16:19], s63 offen offset:1024
    s_add_u32 s63, s47, 96256
    buffer_load_dwordx4 a[76:79], v4, s[16:19], s63 offen offset:1024
    s_add_u32 s63, s47, 8192
    buffer_load_dwordx4 a[80:83], v4, s[16:19], s63 offen offset:2048
    s_add_u32 s63, s47, 96256
    buffer_load_dwordx4 a[84:87], v4, s[16:19], s63 offen offset:2048
    s_add_u32 s63, s47, 8192
    buffer_load_dwordx4 a[88:91], v4, s[16:19], s63 offen offset:3072
    s_add_u32 s63, s47, 96256
    buffer_load_dwordx4 a[92:95], v4, s[16:19], s63 offen offset:3072
    s_add_u32 s63, s47, 12288
    buffer_load_dwordx4 a[96:99], v4, s[16:19], s63 offen offset:0
    s_add_u32 s63, s47, 100352
    buffer_load_dwordx4 a[100:103], v4, s[16:19], s63 offen offset:0
    s_add_u32 s63, s47, 12288
    buffer_load_dwordx4 a[104:107], v4, s[16:19], s63 offen offset:1024
    s_add_u32 s63, s47, 100352
    buffer_load_dwordx4 a[108:111], v4, s[16:19], s63 offen offset:1024
    s_add_u32 s63, s47, 12288
    buffer_load_dwordx4 a[112:115], v4, s[16:19], s63 offen offset:2048
    s_add_u32 s63, s47, 100352
    buffer_load_dwordx4 a[116:119], v4, s[16:19], s63 offen offset:2048
    s_add_u32 s63, s47, 12288
    buffer_load_dwordx4 a[120:123], v4, s[16:19], s63 offen offset:3072
    s_add_u32 s63, s47, 100352
    buffer_load_dwordx4 a[124:127], v4, s[16:19], s63 offen offset:3072
    s_add_u32 s63, s47, 16384
    buffer_load_dwordx4 a[128:131], v4, s[16:19], s63 offen offset:0
    s_add_u32 s63, s47, 104448
    buffer_load_dwordx4 a[132:135], v4, s[16:19], s63 offen offset:0
    s_add_u32 s63, s47, 16384
    buffer_load_dwordx4 a[136:139], v4, s[16:19], s63 offen offset:1024
    s_add_u32 s63, s47, 104448
    buffer_load_dwordx4 a[140:143], v4, s[16:19], s63 offen offset:1024
    s_add_u32 s63, s47, 16384
    buffer_load_dwordx4 a[144:147], v4, s[16:19], s63 offen offset:2048
    s_add_u32 s63, s47, 104448
    buffer_load_dwordx4 a[148:151], v4, s[16:19], s63 offen offset:2048
    s_add_u32 s63, s47, 16384
    buffer_load_dwordx4 a[152:155], v4, s[16:19], s63 offen offset:3072
    s_add_u32 s63, s47, 104448
    buffer_load_dwordx4 a[156:159], v4, s[16:19], s63 offen offset:3072
    s_add_u32 s63, s47, 20480
    buffer_load_dwordx4 a[160:163], v4, s[16:19], s63 offen offset:0
    s_add_u32 s63, s47, 108544
    buffer_load_dwordx4 a[164:167], v4, s[16:19], s63 offen offset:0
    s_add_u32 s63, s48, 20480
    buffer_load_dwordx4 a[168:171], v4, s[16:19], s63 offen offset:1024
    s_add_u32 s63, s48, 108544
    buffer_load_dwordx4 a[172:175], v4, s[16:19], s63 offen offset:1024
    s_add_u32 s8, s82, 0x600000
    s_addc_u32 s9, s83, 0
    s_mov_b32 s10, 0x200000
    s_mov_b32 s11, 0x00020000
    s_add_u32 s60, s94, 0
    buffer_load_dwordx4 v[8:11], v72, s[84:87], s60 offen offset:0
    s_add_u32 s60, s94, 0
    buffer_load_dwordx4 v[12:15], v72, s[84:87], s60 offen offset:1024
    s_add_u32 s60, s94, 0
    buffer_load_dwordx4 v[16:19], v72, s[84:87], s60 offen offset:2048
    s_add_u32 s60, s94, 0
    buffer_load_dwordx4 v[20:23], v72, s[84:87], s60 offen offset:3072
    s_add_u32 s60, s94, 4096
    buffer_load_dwordx4 v[24:27], v72, s[84:87], s60 offen offset:0
    s_add_u32 s60, s94, 4096
    buffer_load_dwordx4 v[28:31], v72, s[84:87], s60 offen offset:1024
    s_add_u32 s60, s94, 4096
    buffer_load_dwordx4 v[32:35], v72, s[84:87], s60 offen offset:2048
    s_add_u32 s60, s94, 4096
    buffer_load_dwordx4 v[36:39], v72, s[84:87], s60 offen offset:3072
    s_add_u32 s60, s94, 32768
    buffer_load_dwordx4 v[40:43], v72, s[84:87], s60 offen offset:0
    s_add_u32 s60, s94, 32768
    buffer_load_dwordx4 v[44:47], v72, s[84:87], s60 offen offset:1024
    s_add_u32 s60, s94, 32768
    buffer_load_dwordx4 v[48:51], v72, s[84:87], s60 offen offset:2048
    s_add_u32 s60, s94, 32768
    buffer_load_dwordx4 v[52:55], v72, s[84:87], s60 offen offset:3072
    s_add_u32 s60, s94, 36864
    buffer_load_dwordx4 v[56:59], v72, s[84:87], s60 offen offset:0
    s_add_u32 s60, s94, 36864
    buffer_load_dwordx4 v[60:63], v72, s[84:87], s60 offen offset:1024
    s_add_u32 s60, s94, 36864
    buffer_load_dwordx4 v[64:67], v72, s[84:87], s60 offen offset:2048
    s_add_u32 s60, s94, 36864
    buffer_load_dwordx4 v[68:71], v72, s[84:87], s60 offen offset:3072
    s_add_u32 m0, s93, 0
    s_add_u32 s60, s92, 0
    buffer_load_dwordx4 v73, s[8:11], s60 offen lds
    s_add_u32 m0, s93, 1024
    s_add_u32 s60, s92, 1024
    buffer_load_dwordx4 v73, s[8:11], s60 offen lds
    s_add_u32 m0, s93, 2048
    s_add_u32 s60, s92, 2048
    buffer_load_dwordx4 v73, s[8:11], s60 offen lds
    s_add_u32 m0, s93, 3072
    s_add_u32 s60, s92, 3072
    buffer_load_dwordx4 v73, s[8:11], s60 offen lds
    s_add_u32 m0, s93, 4096
    s_add_u32 s60, s92, 4096
    buffer_load_dwordx4 v73, s[8:11], s60 offen lds
    s_add_u32 m0, s93, 5120
    s_add_u32 s60, s92, 5120
    buffer_load_dwordx4 v73, s[8:11], s60 offen lds
    s_add_u32 m0, s93, 6144
    s_add_u32 s60, s92, 6144
    buffer_load_dwordx4 v73, s[8:11], s60 offen lds
    s_add_u32 m0, s93, 7168
    s_add_u32 s60, s92, 7168
    buffer_load_dwordx4 v73, s[8:11], s60 offen lds
    s_add_u32 m0, s93, 8192
    s_add_u32 s60, s92, 32768
    buffer_load_dwordx4 v73, s[8:11], s60 offen lds
    s_add_u32 m0, s93, 9216
    s_add_u32 s60, s92, 33792
    buffer_load_dwordx4 v73, s[8:11], s60 offen lds
    s_add_u32 m0, s93, 10240
    s_add_u32 s60, s92, 34816
    buffer_load_dwordx4 v73, s[8:11], s60 offen lds
    s_add_u32 m0, s93, 11264
    s_add_u32 s60, s92, 35840
    buffer_load_dwordx4 v73, s[8:11], s60 offen lds
    s_add_u32 m0, s93, 12288
    s_add_u32 s60, s92, 36864
    buffer_load_dwordx4 v73, s[8:11], s60 offen lds
    s_add_u32 m0, s93, 13312
    s_add_u32 s60, s92, 37888
    buffer_load_dwordx4 v73, s[8:11], s60 offen lds
    s_add_u32 m0, s93, 14336
    s_add_u32 s60, s92, 38912
    buffer_load_dwordx4 v73, s[8:11], s60 offen lds
    s_add_u32 m0, s93, 15360
    s_add_u32 s60, s92, 39936
    buffer_load_dwordx4 v73, s[8:11], s60 offen lds
L_g4join_58:
    s_waitcnt vmcnt(0)
    v_and_b32 v141, 15, v1
    v_lshrrev_b32 v140, 2, v141
    v_lshl_add_u32 v140, v3, 2, v140
    v_lshlrev_b32 v140, 6, v140
    v_and_b32 v141, 3, v141
    v_lshl_add_u32 v140, v141, 3, v140
    v_lshrrev_b32 v141, 4, v1
    v_and_b32 v141, 1, v141
    v_lshl_add_u32 v140, v141, 5, v140
    v_add_u32 v140, s93, v140
    ds_read_b64_tr_b16 v[76:77], v140 offset:0
    ds_read_b64_tr_b16 v[78:79], v140 offset:512
    ds_read_b64_tr_b16 v[108:109], v140 offset:8192
    ds_read_b64_tr_b16 v[110:111], v140 offset:8704
    ds_read_b64_tr_b16 v[80:81], v140 offset:1024
    ds_read_b64_tr_b16 v[82:83], v140 offset:1536
    ds_read_b64_tr_b16 v[112:113], v140 offset:9216
    ds_read_b64_tr_b16 v[114:115], v140 offset:9728
    ds_read_b64_tr_b16 v[84:85], v140 offset:2048
    ds_read_b64_tr_b16 v[86:87], v140 offset:2560
    ds_read_b64_tr_b16 v[116:117], v140 offset:10240
    ds_read_b64_tr_b16 v[118:119], v140 offset:10752
    ds_read_b64_tr_b16 v[88:89], v140 offset:3072
    ds_read_b64_tr_b16 v[90:91], v140 offset:3584
    ds_read_b64_tr_b16 v[120:121], v140 offset:11264
    ds_read_b64_tr_b16 v[122:123], v140 offset:11776
    ds_read_b64_tr_b16 v[92:93], v140 offset:4096
    ds_read_b64_tr_b16 v[94:95], v140 offset:4608
    ds_read_b64_tr_b16 v[124:125], v140 offset:12288
    ds_read_b64_tr_b16 v[126:127], v140 offset:12800
    ds_read_b64_tr_b16 v[96:97], v140 offset:5120
    ds_read_b64_tr_b16 v[98:99], v140 offset:5632
    ds_read_b64_tr_b16 v[128:129], v140 offset:13312
    ds_read_b64_tr_b16 v[130:131], v140 offset:13824
    ds_read_b64_tr_b16 v[100:101], v140 offset:6144
    ds_read_b64_tr_b16 v[102:103], v140 offset:6656
    ds_read_b64_tr_b16 v[132:133], v140 offset:14336
    ds_read_b64_tr_b16 v[134:135], v140 offset:14848
    ds_read_b64_tr_b16 v[104:105], v140 offset:7168
    ds_read_b64_tr_b16 v[106:107], v140 offset:7680
    ds_read_b64_tr_b16 v[136:137], v140 offset:15360
    ds_read_b64_tr_b16 v[138:139], v140 offset:15872
    s_waitcnt lgkmcnt(15)
    v_mfma_f32_32x32x16_bf16 a[176:191], v[8:11], v[76:79], 0
    v_mfma_f32_32x32x16_bf16 a[192:207], v[8:11], v[108:111], 0
    v_mfma_f32_32x32x16_bf16 a[208:223], v[40:43], v[76:79], 0
    v_mfma_f32_32x32x16_bf16 a[224:239], v[40:43], v[108:111], 0
    s_waitcnt lgkmcnt(15)
    v_mfma_f32_32x32x16_bf16 a[176:191], v[12:15], v[80:83], a[176:191]
    v_mfma_f32_32x32x16_bf16 a[192:207], v[12:15], v[112:115], a[192:207]
    v_mfma_f32_32x32x16_bf16 a[208:223], v[44:47], v[80:83], a[208:223]
    v_mfma_f32_32x32x16_bf16 a[224:239], v[44:47], v[112:115], a[224:239]
    s_waitcnt lgkmcnt(15)
    v_mfma_f32_32x32x16_bf16 a[176:191], v[16:19], v[84:87], a[176:191]
    v_mfma_f32_32x32x16_bf16 a[192:207], v[16:19], v[116:119], a[192:207]
    v_mfma_f32_32x32x16_bf16 a[208:223], v[48:51], v[84:87], a[208:223]
    v_mfma_f32_32x32x16_bf16 a[224:239], v[48:51], v[116:119], a[224:239]
    s_waitcnt lgkmcnt(15)
    v_mfma_f32_32x32x16_bf16 a[176:191], v[20:23], v[88:91], a[176:191]
    v_mfma_f32_32x32x16_bf16 a[192:207], v[20:23], v[120:123], a[192:207]
    v_mfma_f32_32x32x16_bf16 a[208:223], v[52:55], v[88:91], a[208:223]
    v_mfma_f32_32x32x16_bf16 a[224:239], v[52:55], v[120:123], a[224:239]
    s_waitcnt lgkmcnt(12)
    v_mfma_f32_32x32x16_bf16 a[176:191], v[24:27], v[92:95], a[176:191]
    v_mfma_f32_32x32x16_bf16 a[192:207], v[24:27], v[124:127], a[192:207]
    v_mfma_f32_32x32x16_bf16 a[208:223], v[56:59], v[92:95], a[208:223]
    v_mfma_f32_32x32x16_bf16 a[224:239], v[56:59], v[124:127], a[224:239]
    s_waitcnt lgkmcnt(8)
    v_mfma_f32_32x32x16_bf16 a[176:191], v[28:31], v[96:99], a[176:191]
    v_mfma_f32_32x32x16_bf16 a[192:207], v[28:31], v[128:131], a[192:207]
    v_mfma_f32_32x32x16_bf16 a[208:223], v[60:63], v[96:99], a[208:223]
    v_mfma_f32_32x32x16_bf16 a[224:239], v[60:63], v[128:131], a[224:239]
    s_waitcnt lgkmcnt(4)
    v_mfma_f32_32x32x16_bf16 a[176:191], v[32:35], v[100:103], a[176:191]
    v_mfma_f32_32x32x16_bf16 a[192:207], v[32:35], v[132:135], a[192:207]
    v_mfma_f32_32x32x16_bf16 a[208:223], v[64:67], v[100:103], a[208:223]
    v_mfma_f32_32x32x16_bf16 a[224:239], v[64:67], v[132:135], a[224:239]
    s_waitcnt lgkmcnt(0)
    v_mfma_f32_32x32x16_bf16 a[176:191], v[36:39], v[104:107], a[176:191]
    v_mfma_f32_32x32x16_bf16 a[192:207], v[36:39], v[136:139], a[192:207]
    v_mfma_f32_32x32x16_bf16 a[208:223], v[68:71], v[104:107], a[208:223]
    v_mfma_f32_32x32x16_bf16 a[224:239], v[68:71], v[136:139], a[224:239]
    s_waitcnt lgkmcnt(0)
    s_barrier
    s_add_u32 s8, s82, 0xe00000
    s_addc_u32 s9, s83, 0
    s_mov_b32 s10, 0x560000
    s_mov_b32 s11, 0x00020000
    v_lshlrev_b32 v184, 4, v1
    s_mul_i32 s25, s40, 176128
    s_lshl_b32 s24, s42, 10
    s_add_u32 s25, s25, s24
    s_cmp_lg_u32 s20, 0
    s_cbranch_scc1 L_wt_69
    s_add_u32 s4, s82, 0x1f04004
    s_addc_u32 s5, s83, 0
    s_mov_b32 s6, 0xffc
    s_mov_b32 s7, 0x00020000
    s_lshl_b32 s24, s40, 1
    v_add_u32 v250, s24, v1
    v_mul_u32_u24 v250, 43691, v250
    v_lshrrev_b32 v250, 17, v250
    v_lshlrev_b32 v250, 7, v250
    s_mov_b64 exec, 0x3
    s_mov_b32 s31, 0
L_poll_70:
    buffer_load_dword v251, v250, s[4:7], 0 offen sc0 sc1
    s_add_u32 s31, s31, 1
    s_waitcnt vmcnt(0)
    v_cmp_le_u32 vcc, 0xb, v251
    s_nop 0
    s_cmp_eq_u64 vcc, exec
    s_nop 1
    s_cbranch_scc1 L_polld_71
    s_cmp_lt_u32 s31, 1048576
    s_cbranch_scc1 L_poll_70
L_polld_71:
    s_mov_b64 exec, -1
L_wt_69:
    s_barrier
    s_cmp_ge_u32 s20, 2
    s_cbranch_scc1 L_g5l_72
    s_add_u32 s24, s25, 20480
    buffer_load_dwordx4 v[176:179], v184, s[8:11], s24 offen offset:1024
    s_add_u32 s24, s25, 108544
    buffer_load_dwordx4 v[180:183], v184, s[8:11], s24 offen offset:1024
L_g5l_72:
    s_add_u32 s24, s25, 0
    buffer_load_dwordx4 v[8:11], v184, s[8:11], s24 offen offset:0
    s_add_u32 s24, s25, 88064
    buffer_load_dwordx4 v[12:15], v184, s[8:11], s24 offen offset:0
    s_add_u32 s24, s25, 0
    buffer_load_dwordx4 v[16:19], v184, s[8:11], s24 offen offset:1024
    s_add_u32 s24, s25, 88064
    buffer_load_dwordx4 v[20:23], v184, s[8:11], s24 offen offset:1024
    s_add_u32 s24, s25, 0
    buffer_load_dwordx4 v[24:27], v184, s[8:11], s24 offen offset:2048
    s_add_u32 s24, s25, 88064
    buffer_load_dwordx4 v[28:31], v184, s[8:11], s24 offen offset:2048
    s_add_u32 s24, s25, 0
    buffer_load_dwordx4 v[32:35], v184, s[8:11], s24 offen offset:3072
    s_add_u32 s24, s25, 88064
    buffer_load_dwordx4 v[36:39], v184, s[8:11], s24 offen offset:3072
    s_add_u32 s24, s25, 4096
    buffer_load_dwordx4 v[40:43], v184, s[8:11], s24 offen offset:0
    s_add_u32 s24, s25, 92160
    buffer_load_dwordx4 v[44:47], v184, s[8:11], s24 offen offset:0
    s_add_u32 s24, s25, 4096
    buffer_load_dwordx4 v[48:51], v184, s[8:11], s24 offen offset:1024
    s_add_u32 s24, s25, 92160
    buffer_load_dwordx4 v[52:55], v184, s[8:11], s24 offen offset:1024
    s_waitcnt vmcnt(10)
    v_mfma_f32_32x32x16_bf16 a[176:191], a[0:3], v[8:11], a[176:191]
    v_mfma_f32_32x32x16_bf16 a[192:207], a[0:3], v[12:15], a[192:207]
    s_add_u32 s24, s25, 4096
    buffer_load_dwordx4 v[56:59], v184, s[8:11], s24 offen offset:2048
    s_add_u32 s24, s25, 92160
    buffer_load_dwordx4 v[60:63], v184, s[8:11], s24 offen offset:2048
    v_mfma_f32_32x32x16_bf16 a[208:223], a[4:7], v[8:11], a[208:223]
    v_mfma_f32_32x32x16_bf16 a[224:239], a[4:7], v[12:15], a[224:239]
    s_waitcnt vmcnt(10)
    v_mfma_f32_32x32x16_bf16 a[176:191], a[8:11], v[16:19], a[176:191]
    v_mfma_f32_32x32x16_bf16 a[192:207], a[8:11], v[20:23], a[192:207]
    s_add_u32 s24, s25, 4096
    buffer_load_dwordx4 v[64:67], v184, s[8:11], s24 offen offset:3072
    s_add_u32 s24, s25, 92160
    buffer_load_dwordx4 v[68:71], v184, s[8:11], s24 offen offset:3072
    v_mfma_f32_32x32x16_bf16 a[208:223], a[12:15], v[16:19], a[208:223]
    v_mfma_f32_32x32x16_bf16 a[224:239], a[12:15], v[20:23], a[224:239]
    s_waitcnt vmcnt(10)
    v_mfma_f32_32x32x16_bf16 a[176:191], a[16:19], v[24:27], a[176:191]
    v_mfma_f32_32x32x16_bf16 a[192:207], a[16:19], v[28:31], a[192:207]
    s_add_u32 s24, s25, 8192
    buffer_load_dwordx4 v[72:75], v184, s[8:11], s24 offen offset:0
    s_add_u32 s24, s25, 96256
    buffer_load_dwordx4 v[76:79], v184, s[8:11], s24 offen offset:0
    v_mfma_f32_32x32x16_bf16 a[208:223], a[20:23], v[24:27], a[208:223]
    v_mfma_f32_32x32x16_bf16 a[224:239], a[20:23], v[28:31], a[224:239]
    s_waitcnt vmcnt(10)
    v_mfma_f32_32x32x16_bf16 a[176:191], a[24:27], v[32:35], a[176:191]
    v_mfma_f32_32x32x16_bf16 a[192:207], a[24:27], v[36:39], a[192:207]
    s_add_u32 s24, s25, 8192
    buffer_load_dwordx4 v[80:83], v184, s[8:11], s24 offen offset:1024
    s_add_u32 s24, s25, 96256
    buffer_load_dwordx4 v[84:87], v184, s[8:11], s24 offen offset:1024
    v_mfma_f32_32x32x16_bf16 a[208:223], a[28:31], v[32:35], a[208:223]
    v_mfma_f32_32x32x16_bf16 a[224:239], a[28:31], v[36:39], a[224:239]
    s_waitcnt vmcnt(10)
    v_mfma_f32_32x32x16_bf16 a[176:191], a[32:35], v[40:43], a[176:191]
    v_mfma_f32_32x32x16_bf16 a[192:207], a[32:35], v[44:47], a[192:207]
    s_add_u32 s24, s25, 8192
    buffer_load_dwordx4 v[88:91], v184, s[8:11], s24 offen offset:2048
    s_add_u32 s24, s25, 96256
    buffer_load_dwordx4 v[92:95], v184, s[8:11], s24 offen offset:2048
    v_mfma_f32_32x32x16_bf16 a[208:223], a[36:39], v[40:43], a[208:223]
    v_mfma_f32_32x32x16_bf16 a[224:239], a[36:39], v[44:47], a[224:239]
    s_waitcnt vmcnt(10)
    v_mfma_f32_32x32x16_bf16 a[176:191], a[40:43], v[48:51], a[176:191]
    v_mfma_f32_32x32x16_bf16 a[192:207], a[40:43], v[52:55], a[192:207]
    s_add_u32 s24, s25, 8192
    buffer_load_dwordx4 v[96:99], v184, s[8:11], s24 offen offset:3072
    s_add_u32 s24, s25, 96256
    buffer_load_dwordx4 v[100:103], v184, s[8:11], s24 offen offset:3072
    v_mfma_f32_32x32x16_bf16 a[208:223], a[44:47], v[48:51], a[208:223]
    v_mfma_f32_32x32x16_bf16 a[224:239], a[44:47], v[52:55], a[224:239]
    s_waitcnt vmcnt(10)
    v_mfma_f32_32x32x16_bf16 a[176:191], a[48:51], v[56:59], a[176:191]
    v_mfma_f32_32x32x16_bf16 a[192:207], a[48:51], v[60:63], a[192:207]
    s_add_u32 s24, s25, 12288
    buffer_load_dwordx4 v[104:107], v184, s[8:11], s24 offen offset:0
    s_add_u32 s24, s25, 100352
    buffer_load_dwordx4 v[108:111], v184, s[8:11], s24 offen offset:0
    v_mfma_f32_32x32x16_bf16 a[208:223], a[52:55], v[56:59], a[208:223]
    v_mfma_f32_32x32x16_bf16 a[224:239], a[52:55], v[60:63], a[224:239]
    s_waitcnt vmcnt(10)
    v_mfma_f32_32x32x16_bf16 a[176:191], a[56:59], v[64:67], a[176:191]
    v_mfma_f32_32x32x16_bf16 a[192:207], a[56:59], v[68:71], a[192:207]
    s_add_u32 s24, s25, 12288
    buffer_load_dwordx4 v[112:115], v184, s[8:11], s24 offen offset:1024
    s_add_u32 s24, s25, 100352
    buffer_load_dwordx4 v[116:119], v184, s[8:11], s24 offen offset:1024
    v_mfma_f32_32x32x16_bf16 a[208:223], a[60:63], v[64:67], a[208:223]
    v_mfma_f32_32x32x16_bf16 a[224:239], a[60:63], v[68:71], a[224:239]
    s_waitcnt vmcnt(10)
    v_mfma_f32_32x32x16_bf16 a[176:191], a[64:67], v[72:75], a[176:191]
    v_mfma_f32_32x32x16_bf16 a[192:207], a[64:67], v[76:79], a[192:207]
    s_add_u32 s24, s25, 12288
    buffer_load_dwordx4 v[120:123], v184, s[8:11], s24 offen offset:2048
    s_add_u32 s24, s25, 100352
    buffer_load_dwordx4 v[124:127], v184, s[8:11], s24 offen offset:2048
    v_mfma_f32_32x32x16_bf16 a[208:223], a[68:71], v[72:75], a[208:223]
    v_mfma_f32_32x32x16_bf16 a[224:239], a[68:71], v[76:79], a[224:239]
    s_waitcnt vmcnt(10)
    v_mfma_f32_32x32x16_bf16 a[176:191], a[72:75], v[80:83], a[176:191]
    v_mfma_f32_32x32x16_bf16 a[192:207], a[72:75], v[84:87], a[192:207]
    s_add_u32 s24, s25, 12288
    buffer_load_dwordx4 v[128:131], v184, s[8:11], s24 offen offset:3072
    s_add_u32 s24, s25, 100352
    buffer_load_dwordx4 v[132:135], v184, s[8:11], s24 offen offset:3072
    v_mfma_f32_32x32x16_bf16 a[208:223], a[76:79], v[80:83], a[208:223]
    v_mfma_f32_32x32x16_bf16 a[224:239], a[76:79], v[84:87], a[224:239]
    s_waitcnt vmcnt(10)
    v_mfma_f32_32x32x16_bf16 a[176:191], a[80:83], v[88:91], a[176:191]
    v_mfma_f32_32x32x16_bf16 a[192:207], a[80:83], v[92:95], a[192:207]
    s_add_u32 s24, s25, 16384
    buffer_load_dwordx4 v[136:139], v184, s[8:11], s24 offen offset:0
    s_add_u32 s24, s25, 104448
    buffer_load_dwordx4 v[140:143], v184, s[8:11], s24 offen offset:0
    v_mfma_f32_32x32x16_bf16 a[208:223], a[84:87], v[88:91], a[208:223]
    v_mfma_f32_32x32x16_bf16 a[224:239], a[84:87], v[92:95], a[224:239]
    s_waitcnt vmcnt(10)
    v_mfma_f32_32x32x16_bf16 a[176:191], a[88:91], v[96:99], a[176:191]
    v_mfma_f32_32x32x16_bf16 a[192:207], a[88:91], v[100:103], a[192:207]
    s_add_u32 s24, s25, 16384
    buffer_load_dwordx4 v[144:147], v184, s[8:11], s24 offen offset:1024
    s_add_u32 s24, s25, 104448
    buffer_load_dwordx4 v[148:151], v184, s[8:11], s24 offen offset:1024
    v_mfma_f32_32x32x16_bf16 a[208:223], a[92:95], v[96:99], a[208:223]
    v_mfma_f32_32x32x16_bf16 a[224:239], a[92:95], v[100:103], a[224:239]
    s_waitcnt vmcnt(10)
    v_mfma_f32_32x32x16_bf16 a[176:191], a[96:99], v[104:107], a[176:191]
    v_mfma_f32_32x32x16_bf16 a[192:207], a[96:99], v[108:111], a[192:207]
    s_add_u32 s24, s25, 16384
    buffer_load_dwordx4 v[152:155], v184, s[8:11], s24 offen offset:2048
    s_add_u32 s24, s25, 104448
    buffer_load_dwordx4 v[156:159], v184, s[8:11], s24 offen offset:2048
    v_mfma_f32_32x32x16_bf16 a[208:223], a[100:103], v[104:107], a[208:223]
    v_mfma_f32_32x32x16_bf16 a[224:239], a[100:103], v[108:111], a[224:239]
    s_waitcnt vmcnt(10)
    v_mfma_f32_32x32x16_bf16 a[176:191], a[104:107], v[112:115], a[176:191]
    v_mfma_f32_32x32x16_bf16 a[192:207], a[104:107], v[116:119], a[192:207]
    s_add_u32 s24, s25, 16384
    buffer_load_dwordx4 v[160:163], v184, s[8:11], s24 offen offset:3072
    s_add_u32 s24, s25, 104448
    buffer_load_dwordx4 v[164:167], v184, s[8:11], s24 offen offset:3072
    v_mfma_f32_32x32x16_bf16 a[208:223], a[108:111], v[112:115], a[208:223]
    v_mfma_f32_32x32x16_bf16 a[224:239], a[108:111], v[116:119], a[224:239]
    s_waitcnt vmcnt(10)
    v_mfma_f32_32x32x16_bf16 a[176:191], a[112:115], v[120:123], a[176:191]
    v_mfma_f32_32x32x16_bf16 a[192:207], a[112:115], v[124:127], a[192:207]
    s_add_u32 s24, s25, 20480
    buffer_load_dwordx4 v[168:171], v184, s[8:11], s24 offen offset:0
    s_add_u32 s24, s25, 108544
    buffer_load_dwordx4 v[172:175], v184, s[8:11], s24 offen offset:0
    v_mfma_f32_32x32x16_bf16 a[208:223], a[116:119], v[120:123], a[208:223]
    v_mfma_f32_32x32x16_bf16 a[224:239], a[116:119], v[124:127], a[224:239]
    s_waitcnt vmcnt(10)
    v_mfma_f32_32x32x16_bf16 a[176:191], a[120:123], v[128:131], a[176:191]
    v_mfma_f32_32x32x16_bf16 a[192:207], a[120:123], v[132:135], a[192:207]
    v_mfma_f32_32x32x16_bf16 a[208:223], a[124:127], v[128:131], a[208:223]
    v_mfma_f32_32x32x16_bf16 a[224:239], a[124:127], v[132:135], a[224:239]
    s_waitcnt vmcnt(8)
    v_mfma_f32_32x32x16_bf16 a[176:191], a[128:131], v[136:139], a[176:191]
    v_mfma_f32_32x32x16_bf16 a[192:207], a[128:131], v[140:143], a[192:207]
    v_mfma_f32_32x32x16_bf16 a[208:223], a[132:135], v[136:139], a[208:223]
    v_mfma_f32_32x32x16_bf16 a[224:239], a[132:135], v[140:143], a[224:239]
    s_waitcnt vmcnt(6)
    v_mfma_f32_32x32x16_bf16 a[176:191], a[136:139], v[144:147], a[176:191]
    v_mfma_f32_32x32x16_bf16 a[192:207], a[136:139], v[148:151], a[192:207]
    v_mfma_f32_32x32x16_bf16 a[208:223], a[140:143], v[144:147], a[208:223]
    v_mfma_f32_32x32x16_bf16 a[224:239], a[140:143], v[148:151], a[224:239]
    s_waitcnt vmcnt(4)
    v_mfma_f32_32x32x16_bf16 a[176:191], a[144:147], v[152:155], a[176:191]
    v_mfma_f32_32x32x16_bf16 a[192:207], a[144:147], v[156:159], a[192:207]
    v_mfma_f32_32x32x16_bf16 a[208:223], a[148:151], v[152:155], a[208:223]
    v_mfma_f32_32x32x16_bf16 a[224:239], a[148:151], v[156:159], a[224:239]
    s_waitcnt vmcnt(2)
    v_mfma_f32_32x32x16_bf16 a[176:191], a[152:155], v[160:163], a[176:191]
    v_mfma_f32_32x32x16_bf16 a[192:207], a[152:155], v[164:167], a[192:207]
    v_mfma_f32_32x32x16_bf16 a[208:223], a[156:159], v[160:163], a[208:223]
    v_mfma_f32_32x32x16_bf16 a[224:239], a[156:159], v[164:167], a[224:239]
    s_waitcnt vmcnt(0)
    v_mfma_f32_32x32x16_bf16 a[176:191], a[160:163], v[168:171], a[176:191]
    v_mfma_f32_32x32x16_bf16 a[192:207], a[160:163], v[172:175], a[192:207]
    v_mfma_f32_32x32x16_bf16 a[208:223], a[164:167], v[168:171], a[208:223]
    v_mfma_f32_32x32x16_bf16 a[224:239], a[164:167], v[172:175], a[224:239]
    s_cmp_ge_u32 s20, 2
    s_nop 9
    s_cbranch_scc1 L_g5m_73
    v_mfma_f32_32x32x16_bf16 a[176:191], a[168:171], v[176:179], a[176:191]
    v_mfma_f32_32x32x16_bf16 a[192:207], a[168:171], v[180:183], a[192:207]
    v_mfma_f32_32x32x16_bf16 a[208:223], a[172:175], v[176:179], a[208:223]
    v_mfma_f32_32x32x16_bf16 a[224:239], a[172:175], v[180:183], a[224:239]
    s_nop 11
L_g5m_73:
    v_lshlrev_b32 v188, 4, v1
    s_xor_b32 s24, s20, 1
    s_mul_i32 s24, s24, 12288
    s_add_u32 s24, s24, 0
    v_add_u32 v185, s24, v188
    s_xor_b32 s24, s20, 2
    s_mul_i32 s24, s24, 12288
    s_add_u32 s24, s24, 4096
    v_add_u32 v186, s24, v188
    s_xor_b32 s24, s20, 3
    s_mul_i32 s24, s24, 12288
    s_add_u32 s24, s24, 8192
    v_add_u32 v187, s24, v188
    ds_write_b128 v185, a[180:183] offset:0
    ds_write_b128 v185, a[196:199] offset:1024
    ds_write_b128 v185, a[212:215] offset:2048
    ds_write_b128 v185, a[228:231] offset:3072
    ds_write_b128 v186, a[184:187] offset:0
    ds_write_b128 v186, a[200:203] offset:1024
    ds_write_b128 v186, a[216:219] offset:2048
    ds_write_b128 v186, a[232:235] offset:3072
    ds_write_b128 v187, a[188:191] offset:0
    ds_write_b128 v187, a[204:207] offset:1024
    ds_write_b128 v187, a[220:223] offset:2048
    ds_write_b128 v187, a[236:239] offset:3072
    s_waitcnt lgkmcnt(0)
    s_barrier
    s_mul_i32 s24, s20, 12288
    s_add_u32 s24, s24, 0
    v_lshlrev_b32 v189, 4, v1
    v_add_u32 v189, s24, v189
    ds_read_b128 v[8:11], v189 offset:0
    ds_read_b128 v[12:15], v189 offset:1024
    ds_read_b128 v[16:19], v189 offset:2048
    ds_read_b128 v[20:23], v189 offset:3072
    ds_read_b128 v[24:27], v189 offset:4096
    ds_read_b128 v[28:31], v189 offset:5120
    ds_read_b128 v[32:35], v189 offset:6144
    ds_read_b128 v[36:39], v189 offset:7168
    ds_read_b128 v[40:43], v189 offset:8192
    ds_read_b128 v[44:47], v189 offset:9216
    ds_read_b128 v[48:51], v189 offset:10240
    ds_read_b128 v[52:55], v189 offset:11264
    v_accvgpr_read_b32 v72, a176
    v_accvgpr_read_b32 v73, a177
    v_accvgpr_read_b32 v74, a178
    v_accvgpr_read_b32 v75, a179
    v_accvgpr_read_b32 v76, a192
    v_accvgpr_read_b32 v77, a193
    v_accvgpr_read_b32 v78, a194
    v_accvgpr_read_b32 v79, a195
    v_accvgpr_read_b32 v80, a208
    v_accvgpr_read_b32 v81, a209
    v_accvgpr_read_b32 v82, a210
    v_accvgpr_read_b32 v83, a211
    v_accvgpr_read_b32 v84, a224
    v_accvgpr_read_b32 v85, a225
    v_accvgpr_read_b32 v86, a226
    v_accvgpr_read_b32 v87, a227
    s_waitcnt lgkmcnt(0)
    v_pk_add_f32 v[56:57], v[72:73], v[8:9]
    v_pk_add_f32 v[24:25], v[24:25], v[40:41]
    v_pk_add_f32 v[58:59], v[74:75], v[10:11]
    v_pk_add_f32 v[26:27], v[26:27], v[42:43]
    v_pk_add_f32 v[60:61], v[76:77], v[12:13]
    v_pk_add_f32 v[28:29], v[28:29], v[44:45]
    v_pk_add_f32 v[62:63], v[78:79], v[14:15]
    v_pk_add_f32 v[30:31], v[30:31], v[46:47]
    v_pk_add_f32 v[64:65], v[80:81], v[16:17]
    v_pk_add_f32 v[32:33], v[32:33], v[48:49]
    v_pk_add_f32 v[66:67], v[82:83], v[18:19]
    v_pk_add_f32 v[34:35], v[34:35], v[50:51]
    v_pk_add_f32 v[68:69], v[84:85], v[20:21]
    v_pk_add_f32 v[36:37], v[36:37], v[52:53]
    v_pk_add_f32 v[70:71], v[86:87], v[22:23]
    v_pk_add_f32 v[38:39], v[38:39], v[54:55]
    v_pk_add_f32 v[56:57], v[56:57], v[24:25]
    v_pk_add_f32 v[58:59], v[58:59], v[26:27]
    v_pk_add_f32 v[60:61], v[60:61], v[28:29]
    v_pk_add_f32 v[62:63], v[62:63], v[30:31]
    v_pk_add_f32 v[64:65], v[64:65], v[32:33]
    v_pk_add_f32 v[66:67], v[66:67], v[34:35]
    v_pk_add_f32 v[68:69], v[68:69], v[36:37]
    v_pk_add_f32 v[70:71], v[70:71], v[38:39]
    s_mov_b32 s8, s78
    s_mov_b32 s9, s79
    s_mov_b32 s10, 0x200000
    s_mov_b32 s11, 0x00020000
    v_cvt_pk_bf16_f32 v104, v56, v57
    v_cvt_pk_bf16_f32 v105, v58, v59
    v_cvt_pk_bf16_f32 v106, v60, v61
    v_cvt_pk_bf16_f32 v107, v62, v63
    v_cvt_pk_bf16_f32 v108, v64, v65
    v_cvt_pk_bf16_f32 v109, v66, v67
    v_cvt_pk_bf16_f32 v110, v68, v69
    v_cvt_pk_bf16_f32 v111, v70, v71
    v_mul_u32_u24 v112, 144, v2
    v_lshl_add_u32 v112, v3, 3, v112
    s_lshl_b32 s24, s20, 4
    s_add_u32 s24, s24, 49152
    v_add_u32 v112, s24, v112
    ds_write_b64 v112, v[104:105] offset:0
    ds_write_b64 v112, v[106:107] offset:4608
    ds_write_b64 v112, v[108:109] offset:64
    ds_write_b64 v112, v[110:111] offset:4672
    s_waitcnt lgkmcnt(0)
    s_barrier
    v_lshrrev_b32 v113, 3, v0
    v_mul_u32_u24 v114, 144, v113
    v_and_b32 v113, 7, v0
    v_lshl_add_u32 v114, v113, 4, v114
    v_add_u32 v114, 49152, v114
    ds_read_b128 v[116:119], v114
    ds_read_b128 v[120:123], v114 offset:4608
    v_lshrrev_b32 v125, 3, v0
    v_lshlrev_b32 v124, 15, v125
    v_and_b32 v125, 7, v0
    v_lshl_add_u32 v124, v125, 4, v124
    s_lshl_b32 s24, s40, 10
    s_lshl_b32 s25, s41, 7
    s_add_u32 s24, s24, s25
    s_add_u32 s25, s24, 1048576
    s_waitcnt lgkmcnt(1)
    buffer_store_dwordx4 v[116:119], v124, s[8:11], s24 offen
    s_waitcnt lgkmcnt(0)
    buffer_store_dwordx4 v[120:123], v124, s[8:11], s25 offen
    s_nop 1
L_end:
    s_endpgm

.section .rodata,"a"
.p2align 6
.amdhsa_kernel interleave_layers__spectral_gfnet__glu_gated_geglu__prompt_kernel
  .amdhsa_next_free_vgpr 512
  .amdhsa_next_free_sgpr 102
  .amdhsa_accum_offset 256
  .amdhsa_group_segment_fixed_size 0
  .amdhsa_kernarg_size 80
  .amdhsa_user_sgpr_count 2
  .amdhsa_user_sgpr_kernarg_segment_ptr 1
  .amdhsa_system_sgpr_workgroup_id_x 1
  .amdhsa_float_denorm_mode_32 3
.end_amdhsa_kernel
```
